```python
import torch

def _softmax(x, axis=-1):
    return torch.softmax(x, dim=axis)
def _gelu(x):
    return torch.nn.functional.gelu(x, approximate="tanh")
def _silu(x):
    return torch.nn.functional.silu(x)
def _sigmoid(x):
    return torch.sigmoid(x)
def _layernorm(x, axis=-1, eps=1e-5):
    m = x.mean(dim=axis, keepdim=True)
    v = x.var(dim=axis, keepdim=True, unbiased=False)
    return (x - m) / torch.sqrt(v + eps)
def _scatter_add(tgt, idx, src, axis=0):
    return tgt.clone().index_add_(axis, idx, src)
def _segment_sum(src, seg, n):
    out = torch.zeros((n,) + src.shape[1:], dtype=src.dtype)
    return out.index_add_(0, seg, src)
def _pad(x, pw):
    flat = tuple(v for pair in reversed(pw) for v in pair)
    return torch.nn.functional.pad(x, flat)

kernel_name = 'sequential_preLN__softmax_full_mha__mixer_token_mlp__prompt'

def setup_inputs():

    _w = (lambda a: (lambda t: t.to(torch.bfloat16) if t.is_floating_point() else t)(torch.as_tensor(a)))
    def _A_setup():
        B, S, D = 1, 2048, 448
        return {
            "x": _w((lambda *s: torch.randn(*s, dtype=torch.bfloat16) * 0.05)(B, S, D)),
            "wqkv": _w((lambda *s: torch.randn(*s, dtype=torch.bfloat16) * 0.05)(D, 3 * D)),
            "wo": _w((lambda *s: torch.randn(*s, dtype=torch.bfloat16) * 0.05)(D, D)),
        }
    _A_in = _A_setup()

    def _B_setup():
        B, S, D, F = 1, 2048, 448, 1792
        return {
            "x": _w((lambda *s: torch.randn(*s, dtype=torch.bfloat16) * 0.05)(B, S, D)),
            "w1": _w((lambda *s: torch.randn(*s, dtype=torch.bfloat16) * 0.8)(S, F) * (S ** -0.5)),
            "b1": _w((lambda *s: torch.randn(*s, dtype=torch.bfloat16) * 12.8)(F) * 0.02),
            "w2": _w((lambda *s: torch.randn(*s, dtype=torch.bfloat16) * 0.2)(F, S) * (F ** -0.5)),
            "b2": _w((lambda *s: torch.randn(*s, dtype=torch.bfloat16) * 1.6)(S) * 0.02),
        }
    _B_in = _B_setup()

    return {
        "A_x": _A_in["x"],
        "A_wqkv": _A_in["wqkv"],
        "A_wo": _A_in["wo"],
        "B_x": _B_in["x"],
        "B_w1": _B_in["w1"],
        "B_b1": _B_in["b1"],
        "B_w2": _B_in["w2"],
        "B_b2": _B_in["b2"],
    }

def reference(A_x, A_wqkv, A_wo, B_x, B_w1, B_b1, B_w2, B_b2):
    def _A_ref(x, wqkv, wo):
        B, S, D = x.shape
        H = 16; Dh = D // H
        qkv = (lambda x, *d: x.permute(*d))((x @ wqkv).reshape(B, S, 3, H, Dh), 2, 0, 3, 1, 4)
        q, k, v = qkv[0], qkv[1], qkv[2]
        scale = Dh ** -0.5
        scores = torch.einsum("bhqd,bhkd->bhqk", q, k) * scale
        p = _softmax(scores, axis=-1)
        o = torch.einsum("bhqk,bhkd->bhqd", p, v)
        return (lambda x, *d: x.permute(*d))(o, 0, 2, 1, 3).reshape(B, S, D) @ wo

    def _B_ref(x, w1, b1, w2, b2):
        B, S, D = x.shape
        h = _layernorm(x, axis=-1)
        u = torch.einsum("bsd,sf->bdf", h, w1) + b1
        u = _gelu(u)
        y = torch.einsum("bdf,fs->bds", u, w2) + b2
        return (lambda x, *d: x.permute(*d))(y, 0, 2, 1)

    x = A_x
    h = x + _A_ref(_layernorm(x, axis=-1), A_wqkv, A_wo)
    h2 = h + _B_ref(_layernorm(h, axis=-1), B_w1, B_b1, B_w2, B_b2)
    return h2
```

```asm
; @launch grid=(256,1,1) block=(256,1,1) lds=163840
.amdgcn_target "amdgcn-amd-amdhsa--gfx950"
.text
.globl sequential_preLN__softmax_full_mha__mixer_token_mlp__prompt_kernel
.p2align 8
.type sequential_preLN__softmax_full_mha__mixer_token_mlp__prompt_kernel,@function
sequential_preLN__softmax_full_mha__mixer_token_mlp__prompt_kernel:
  s_cmp_ge_u32 s2, 256
  s_cbranch_scc1 L_end
  s_load_dwordx16 s[64:79], s[0:1], 0
  s_load_dwordx4 s[80:83], s[0:1], 64
  s_load_dwordx2 s[84:85], s[0:1], 80
  s_lshr_b32 s57, s2, 3
  s_lshl_b32 s3, s57, 11
  v_lshrrev_b32 v9, 4, v0
  v_lshl_add_u32 v9, v9, 7, s3
  s_getpc_b64 s[62:63]
L_pc:
  v_min_u32 v9, L_last-L_pc-4, v9
  global_load_dword v10, v9, s[62:63]
  v_lshrrev_b32 v2, 6, v0
  v_and_b32 v1, 63, v0
  v_readfirstlane_b32 s4, v2
  v_lshlrev_b32 v7, 4, v1
  s_nop 0
  s_cmp_ge_u32 s4, 2
  s_cbranch_scc1 L_et
  v_lshrrev_b32 v2, 1, v0
  v_min_u32 v3, 55, v2
  v_min_u32 v2, 36, v2
  s_mul_i32 s3, s2, 56
  v_add_lshl_u32 v3, v3, s3, 7
  s_mul_i32 s3, s2, 37
  v_add_u32 v2, s3, v2
  v_min_u32 v2, 9407, v2
  v_lshlrev_b32 v2, 7, v2
  v_lshrrev_b32 v4, 3, v0
  s_lshl_b32 s3, s2, 4
  v_add_u32 v4, s3, v4
  v_min_u32 v4, 3135, v4
  v_lshlrev_b32 v4, 7, v4
  v_lshlrev_b32 v5, 2, v0
  v_and_b32 v5, 0x180, v5
  s_and_b32 s3, s2, 7
  s_lshl_b32 s3, s3, 9
  v_add_u32 v5, s3, v5
  v_min_u32 v6, 3456, v5
  s_waitcnt lgkmcnt(0)
  global_load_dword v10, v3, s[64:65]
  global_load_dword v10, v2, s[66:67]
  global_load_dword v10, v4, s[68:69]
  global_load_dword v10, v6, s[74:75]
  global_load_dword v10, v5, s[78:79]
  s_branch L_et
.p2align 12
L_et:
  s_and_b32 s56, s2, 7
  s_and_b32 s58, s57, 3
  s_lshr_b32 s53, s57, 2
  s_lshr_b32 s3, s56, 1
  s_lshl2_add_u32 s6, s3, s58
  s_and_b32 s3, s56, 1
  s_lshl3_add_u32 s5, s3, s53
  s_lshr_b32 s3, s56, 2
  s_lshl2_add_u32 s7, s3, s58
  s_and_b32 s3, s53, 1
  s_lshl_b32 s3, s3, 2
  s_cmp_eq_u32 s58, 3
  s_cselect_b32 s3, s3, 0
  s_xor_b32 s7, s7, s3
  s_lshl2_add_u32 s3, s5, s4
  s_mul_i32 s3, s3, 28672
  v_lshrrev_b32 v5, 3, v1
  v_mul_u32_u24 v2, 896, v5
  v_add_u32 v2, s3, v2
  v_lshrrev_b32 v3, 4, v1
  v_and_b32 v4, 7, v1
  v_xor_b32 v3, v3, v4
  v_lshl_add_u32 v176, v3, 4, v2
  v_xor_b32 v3, 4, v3
  v_lshl_add_u32 v3, v3, 4, v2
  v_add_u32 v177, 6144, v3
  v_add_u32 v178, 12288, v176
  v_add_u32 v179, 12288, v177
  s_lshl_b32 s54, s4, 14
  s_add_u32 s54, s54, 87040
  v_mul_u32_u24 v180, 2688, v5
  v_lshrrev_b32 v2, 2, v1
  v_and_b32 v2, 4, v2
  v_xor_b32 v2, v2, v4
  v_lshl_add_u32 v180, v2, 4, v180
  v_cmp_ne_u32 vcc, 7, v2
  v_add_u32 v202, 20480, v180
  s_xor_b32 s3, s6, 8
  s_mul_i32 s55, s3, 112
  s_mul_i32 s60, s4, 43008
  s_add_u32 s55, s55, s60
  s_lshl_b32 s59, s4, 11
  s_waitcnt lgkmcnt(0)
  s_mov_b64 s[16:17], s[64:65]
  s_mov_b32 s18, 1835008
  s_mov_b32 s19, 0x20000
  s_mov_b64 s[20:21], s[66:67]
  s_mov_b32 s22, 1204224
  s_mov_b32 s23, 0x20000
  s_add_u32 s58, s55, 896
  s_add_u32 m0, s59, 0
  s_mov_b64 exec, vcc
  buffer_load_dwordx4 v180, s[20:23], s58 offen lds
  s_mov_b64 exec, -1
  s_mov_b64 exec, vcc
  buffer_load_dwordx4 v202, s[20:23], s58 offen offset:1024 lds
  s_mov_b64 exec, -1
  s_add_u32 m0, s54, 0
  s_nop 0
  buffer_load_dwordx4 v176, s[16:19], 0 offen lds
  buffer_load_dwordx4 v177, s[16:19], 0 offen offset:1024 lds
  buffer_load_dwordx4 v178, s[16:19], 0 offen offset:2048 lds
  buffer_load_dwordx4 v179, s[16:19], 0 offen offset:3072 lds
  s_mov_b32 s95, s7
  s_and_b32 s3, s57, 3
  s_lshl2_add_u32 s8, s56, s3
  s_cmp_gt_u32 s53, 3
  s_subb_u32 s7, s53, 0
  s_and_b32 s3, s56, 3
  s_mul_i32 s3, s3, 7
  s_add_u32 s9, s3, s7
  s_cmp_eq_u32 s53, 3
  s_cselect_b32 s7, 7, s7
  s_and_b32 s10, s4, 1
  s_lshr_b32 s11, s4, 1
  s_lshl1_add_u32 s52, s8, s10
  s_mov_b32 s96, 0x100000
  s_mov_b64 s[12:13], s[84:85]
  s_mov_b32 s14, 268435456
  s_mov_b32 s15, 0x20000
  s_mov_b64 s[48:49], s[82:83]
  s_mov_b32 s50, 256
  s_mov_b32 s51, 0x20000
  s_mov_b64 s[24:25], s[68:69]
  s_mov_b32 s26, 401408
  s_mov_b32 s27, 0x20000
  s_mov_b64 s[28:29], s[72:73]
  s_mov_b32 s30, 7340032
  s_mov_b32 s31, 0x20000
  s_mov_b64 s[32:33], s[76:77]
  s_mov_b32 s34, 7340032
  s_mov_b32 s35, 0x20000
  s_mov_b64 s[36:37], s[74:75]
  s_mov_b32 s38, 3584
  s_mov_b32 s39, 0x20000
  s_mov_b64 s[40:41], s[78:79]
  s_mov_b32 s42, 4096
  s_mov_b32 s43, 0x20000
  s_mov_b64 s[44:45], s[80:81]
  s_mov_b32 s46, 1835008
  s_mov_b32 s47, 0x20000
  s_mov_b64 s[80:81], s[12:13]
  s_mov_b32 s83, 0x20000
  s_mov_b64 s[84:85], s[12:13]
  s_mov_b32 s87, 0x20000
  s_cmp_lt_u32 s7, 7
  s_cselect_b32 s82, s14, 0
  s_cselect_b32 s26, s26, 0
  s_cselect_b32 s30, s30, 0
  s_cmp_lt_u32 s95, 7
  s_cselect_b32 s86, s82, 0
  s_cselect_b32 s30, s30, 0
  v_mov_b32 v224, -1
  v_mov_b32 v225, -1
  v_mov_b32 v226, -1
  v_mov_b32 v227, -1
  s_and_b32 s3, s6, 7
  s_lshl_b32 s3, s3, 7
  s_lshl2_add_u32 s3, s5, s3
  s_add_u32 s3, s3, s4
  s_lshl_b32 s61, s3, 12
  s_cmp_lg_u32 s6, 0
  s_cbranch_scc1 L_nz
  v_mov_b32 v2, 0
  v_mov_b32 v3, 0
  v_lshlrev_b32 v12, 3, v0
  s_lshl_b32 s3, s5, 11
  s_add_u32 s3, s3, 8912896
  buffer_store_dwordx2 v[2:3], v12, s[12:15], s3 offen sc1
L_nz:
  s_and_b32 s3, s5, 3
  s_cbranch_scc1 L_np
  s_xor_b32 s3, s6, 8
  s_lshr_b32 s3, s3, 3
  s_lshl_b32 s3, s3, 11
  s_add_u32 s3, s3, s61
  buffer_store_dwordx4 v[224:227], v7, s[12:15], s3 offen offset:0 sc1
  buffer_store_dwordx4 v[224:227], v7, s[12:15], s3 offen offset:1024 sc1
  s_add_u32 s3, s3, 262144
  buffer_store_dwordx4 v[224:227], v7, s[12:15], s3 offen offset:0 sc1
  buffer_store_dwordx4 v[224:227], v7, s[12:15], s3 offen offset:1024 sc1
L_np:
  v_mov_b32 v160, 0x3f803f80
  v_mov_b32 v161, 0x3f803f80
  v_mov_b32 v162, 0x3f803f80
  v_mov_b32 v163, 0x3f803f80
  v_lshrrev_b32 v2, 1, v0
  v_and_b32 v2, 1, v2
  v_lshlrev_b32 v2, 6, v2
  v_xor_b32 v2, 0x70, v2
  v_lshl_add_u32 v2, v0, 7, v2
  ds_write_b128 v2, v[160:163] offset:0
  ds_write_b128 v2, v[160:163] offset:24576
  v_and_b32 v2, 31, v1
  v_lshlrev_b32 v3, 7, v2
  v_add_u32 v3, s54, v3
  v_lshrrev_b32 v4, 1, v2
  v_and_b32 v4, 7, v4
  v_lshrrev_b32 v5, 5, v1
  v_xor_b32 v4, v4, v5
  s_lshl_b32 s3, s4, 1
  v_xor_b32 v4, s3, v4
  v_xor_b32 v6, 0, v4
  v_lshl_add_u32 v182, v6, 4, v3
  v_xor_b32 v6, 2, v4
  v_lshl_add_u32 v183, v6, 4, v3
  v_xor_b32 v6, 4, v4
  v_lshl_add_u32 v184, v6, 4, v3
  v_xor_b32 v6, 6, v4
  v_lshl_add_u32 v185, v6, 4, v3
  v_add_u32 v199, 160768, v7
  s_lshl_b32 s3, s4, 2
  v_add_u32 v198, s3, v199
  v_mul_u32_u24 v208, 72, v2
  v_lshl_add_u32 v208, v5, 3, v208
  v_add_u32 v208, s54, v208
  v_bfe_u32 v2, v1, 2, 2
  v_lshl_add_u32 v3, v5, 3, v2
  v_bfe_u32 v4, v1, 4, 1
  v_lshlrev_b32 v4, 5, v4
  v_and_b32 v6, 3, v1
  v_lshl_add_u32 v4, v6, 3, v4
  v_lshl_add_u32 v5, v5, 2, v2
  v_mul_u32_u24 v5, 72, v5
  v_add3_u32 v209, v5, v4, s54
  v_lshrrev_b32 v2, 1, v2
  v_lshlrev_b32 v2, 6, v2
  v_xor_b32 v6, v4, v2
  v_lshl_add_u32 v6, v3, 7, v6
  v_add_u32 v186, s59, v6
  v_add_u32 v6, 56, v4
  v_xor_b32 v6, v6, v2
  v_lshl_add_u32 v6, v3, 7, v6
  v_add_u32 v190, s59, v6
  s_lshl_b32 s63, s4, 10
  v_lshl_add_u32 v6, v3, 6, v4
  v_add_u32 v6, s63, v6
  v_xor_b32 v187, 2048, v186
  v_xor_b32 v191, 2048, v190
  v_xor_b32 v188, 4096, v186
  v_xor_b32 v192, 4096, v190
  v_xor_b32 v189, 6144, v186
  v_xor_b32 v193, 6144, v190
  s_add_u32 s58, s55, 172928
  s_add_u32 m0, s59, 8192
  s_mov_b64 exec, vcc
  buffer_load_dwordx4 v180, s[20:23], s58 offen lds
  s_mov_b64 exec, -1
  s_mov_b64 exec, vcc
  buffer_load_dwordx4 v202, s[20:23], s58 offen offset:1024 lds
  s_mov_b64 exec, -1
  s_add_u32 m0, s54, 3968
  s_nop 0
  buffer_load_dwordx4 v176, s[16:19], 0 offen offset:128 lds
  buffer_load_dwordx4 v177, s[16:19], 0 offen offset:1152 lds
  buffer_load_dwordx4 v178, s[16:19], 0 offen offset:2176 lds
  buffer_load_dwordx4 v179, s[16:19], 0 offen offset:3200 lds
  s_mov_b64 exec, 0
  s_cmp_eq_u32 s4, 1
  s_cbranch_scc1 L_pad1
  s_cmp_eq_u32 s4, 2
  s_cbranch_scc1 L_pad2
  s_cmp_eq_u32 s4, 3
  s_cbranch_scc1 L_pad3
  s_branch L_pad0
L_tour0:
  s_mov_b64 exec, -1
  s_waitcnt lgkmcnt(0)
  s_waitcnt vmcnt(6)
  s_barrier
  ds_read_b64_tr_b16 v[128:129], v186 offset:0
  ds_read_b64_tr_b16 v[130:131], v186 offset:512
  ds_read_b64_tr_b16 v[132:133], v190 offset:0
  ds_read_b64_tr_b16 v[134:135], v190 offset:512
  ds_read_b128 a[0:3], v182 offset:0
  ds_read_b64_tr_b16 v[136:137], v187 offset:0
  ds_read_b64_tr_b16 v[138:139], v187 offset:512
  ds_read_b64_tr_b16 v[140:141], v191 offset:0
  ds_read_b64_tr_b16 v[142:143], v191 offset:512
  ds_read_b128 a[4:7], v183 offset:0
  s_add_u32 s58, s55, 344960
  s_add_u32 m0, s59, 16384
  s_mov_b64 exec, vcc
  buffer_load_dwordx4 v180, s[20:23], s58 offen lds
  s_mov_b64 exec, -1
  s_mov_b64 exec, vcc
  buffer_load_dwordx4 v202, s[20:23], s58 offen offset:1024 lds
  s_mov_b64 exec, -1
  s_add_u32 m0, s54, 7936
  s_nop 0
  buffer_load_dwordx4 v176, s[16:19], 0 offen offset:256 lds
  s_waitcnt lgkmcnt(5)
  v_mfma_f32_4x4x4_16b_bf16 v[96:99], v[160:161], v[128:129], 0
  v_mfma_f32_4x4x4_16b_bf16 v[100:103], v[160:161], v[130:131], 0
  ds_read_b64_tr_b16 v[144:145], v188 offset:0
  ds_read_b64_tr_b16 v[146:147], v188 offset:512
  v_xor_b32 v194, 0, v6
  v_add_u32 v194, 58368, v194
  v_mfma_f32_4x4x4_16b_bf16 v[112:115], v[160:161], v[132:133], 0
  v_mfma_f32_4x4x4_16b_bf16 v[116:119], v[160:161], v[134:135], 0
  ds_read_b64_tr_b16 v[148:149], v192 offset:0
  ds_read_b64_tr_b16 v[150:151], v192 offset:512
  buffer_load_dwordx4 v177, s[16:19], 0 offen offset:1280 lds
  v_mfma_f32_32x32x16_bf16 v[64:79], v[132:135], a[0:3], 0
  ds_read_b128 a[8:11], v184 offset:0
  v_xor_b32 v195, 1024, v6
  v_add_u32 v195, 58368, v195
  v_mfma_f32_4x4x4_16b_bf16 v[80:83], a[0:1], a[0:1], 0
  v_mfma_f32_4x4x4_16b_bf16 v[84:87], a[2:3], a[2:3], 0
  buffer_load_dwordx4 v178, s[16:19], 0 offen offset:2304 lds
  v_mfma_f32_32x32x16_bf16 v[48:63], v[128:131], a[0:3], 0
  v_xor_b32 v196, 2048, v6
  v_add_u32 v196, 58368, v196
  s_waitcnt lgkmcnt(5)
  v_mfma_f32_32x32x16_bf16 v[64:79], v[140:143], a[4:7], v[64:79]
  ds_read_b64_tr_b16 v[152:153], v189 offset:0
  ds_read_b64_tr_b16 v[154:155], v189 offset:512
  v_xor_b32 v197, 3072, v6
  v_add_u32 v197, 58368, v197
  v_mfma_f32_4x4x4_16b_bf16 v[80:83], a[4:5], a[4:5], v[80:83]
  v_mfma_f32_4x4x4_16b_bf16 v[84:87], a[6:7], a[6:7], v[84:87]
  ds_read_b64_tr_b16 v[156:157], v193 offset:0
  ds_read_b64_tr_b16 v[158:159], v193 offset:512
  buffer_load_dwordx4 v179, s[16:19], 0 offen offset:3328 lds
  v_mfma_f32_32x32x16_bf16 v[48:63], v[136:139], a[4:7], v[48:63]
  ds_read_b128 a[12:15], v185 offset:0
  v_lshrrev_b32 v2, 2, v1
  v_mul_u32_u24 v2, 2688, v2
  v_and_b32 v3, 3, v1
  v_lshl_add_u32 v181, v3, 4, v2
  s_waitcnt vmcnt(6)
  s_barrier
  s_waitcnt lgkmcnt(5)
  v_mfma_f32_32x32x16_bf16 v[64:79], v[148:151], a[8:11], v[64:79]
  ds_read_b64_tr_b16 v[128:129], v186 offset:8192
  ds_read_b64_tr_b16 v[130:131], v186 offset:8704
  s_mul_i32 s3, s6, 56
  s_add_u32 s60, s60, s3
  s_mov_b32 s62, 0x07060302
  s_mov_b32 s74, 0
  s_mov_b32 s75, -1
  v_mfma_f32_4x4x4_16b_bf16 v[80:83], a[8:9], a[8:9], v[80:83]
  v_mfma_f32_4x4x4_16b_bf16 v[84:87], a[10:11], a[10:11], v[84:87]
  ds_read_b64_tr_b16 v[132:133], v190 offset:8192
  ds_read_b64_tr_b16 v[134:135], v190 offset:8704
  s_add_u32 s58, s55, 516992
  s_add_u32 m0, s59, 24576
  s_mov_b64 exec, vcc
  buffer_load_dwordx4 v180, s[20:23], s58 offen lds
  s_mov_b64 exec, -1
  v_mfma_f32_32x32x16_bf16 v[48:63], v[144:147], a[8:11], v[48:63]
  ds_read_b128 a[16:19], v182 offset:4096
  s_mov_b64 exec, vcc
  buffer_load_dwordx4 v202, s[20:23], s58 offen offset:1024 lds
  s_mov_b64 exec, -1
  s_add_u32 m0, s54, 11904
  s_waitcnt lgkmcnt(5)
  v_mfma_f32_32x32x16_bf16 v[64:79], v[156:159], a[12:15], v[64:79]
  ds_read_b64_tr_b16 v[136:137], v187 offset:8192
  ds_read_b64_tr_b16 v[138:139], v187 offset:8704
  v_mov_b32 v167, 0
  v_mov_b32 v171, 0
  v_mov_b32 v175, 0
  v_and_b32 v201, 15, v1
  v_lshlrev_b32 v201, 2, v201
  v_mfma_f32_4x4x4_16b_bf16 v[80:83], a[12:13], a[12:13], v[80:83]
  v_mfma_f32_4x4x4_16b_bf16 v[84:87], a[14:15], a[14:15], v[84:87]
  ds_read_b64_tr_b16 v[140:141], v191 offset:8192
  ds_read_b64_tr_b16 v[142:143], v191 offset:8704
  buffer_load_dwordx4 v176, s[16:19], 0 offen offset:384 lds
  v_mfma_f32_32x32x16_bf16 v[48:63], v[152:155], a[12:15], v[48:63]
  ds_read_b128 a[20:23], v183 offset:4096
  buffer_load_dwordx4 v177, s[16:19], 0 offen offset:1408 lds
  s_waitcnt lgkmcnt(5)
  v_mfma_f32_4x4x4_16b_bf16 v[96:99], v[160:161], v[128:129], v[96:99]
  v_mfma_f32_4x4x4_16b_bf16 v[100:103], v[160:161], v[130:131], v[100:103]
  ds_read_b64_tr_b16 v[144:145], v188 offset:8192
  ds_read_b64_tr_b16 v[146:147], v188 offset:8704
  s_lshl2_add_u32 s3, s5, s4
  s_lshl4_add_u32 s3, s3, s6
  s_lshl_b32 s3, s3, 11
  s_add_u32 s97, s3, 6291456
  v_mfma_f32_4x4x4_16b_bf16 v[112:115], v[160:161], v[132:133], v[112:115]
  v_mfma_f32_4x4x4_16b_bf16 v[116:119], v[160:161], v[134:135], v[116:119]
  ds_read_b64_tr_b16 v[148:149], v192 offset:8192
  ds_read_b64_tr_b16 v[150:151], v192 offset:8704
  buffer_load_dwordx4 v178, s[16:19], 0 offen offset:2432 lds
  v_mfma_f32_32x32x16_bf16 v[64:79], v[132:135], a[16:19], v[64:79]
  ds_read_b128 a[24:27], v184 offset:4096
  s_lshl1_add_u32 s3, s7, s11
  s_lshl4_add_u32 s3, s52, s3
  s_lshl_b32 s3, s3, 8
  s_add_u32 s98, s3, 8388608
  v_mfma_f32_4x4x4_16b_bf16 v[80:83], a[16:17], a[16:17], v[80:83]
  v_mfma_f32_4x4x4_16b_bf16 v[84:87], a[18:19], a[18:19], v[84:87]
  buffer_load_dwordx4 v179, s[16:19], 0 offen offset:3456 lds
  v_mfma_f32_32x32x16_bf16 v[48:63], v[128:131], a[16:19], v[48:63]
  v_lshlrev_b32 v228, 2, v1
  v_bfe_u32 v2, v1, 4, 1
  v_lshlrev_b32 v2, 17, v2
  v_lshrrev_b32 v3, 5, v1
  s_waitcnt lgkmcnt(5)
  v_mfma_f32_32x32x16_bf16 v[64:79], v[140:143], a[20:23], v[64:79]
  ds_read_b64_tr_b16 v[152:153], v189 offset:8192
  ds_read_b64_tr_b16 v[154:155], v189 offset:8704
  v_lshl_add_u32 v2, v3, 9, v2
  v_and_b32 v3, 15, v1
  v_lshl_add_u32 v14, v3, 4, v2
  v_mfma_f32_4x4x4_16b_bf16 v[80:83], a[20:21], a[20:21], v[80:83]
  v_mfma_f32_4x4x4_16b_bf16 v[84:87], a[22:23], a[22:23], v[84:87]
  ds_read_b64_tr_b16 v[156:157], v193 offset:8192
  ds_read_b64_tr_b16 v[158:159], v193 offset:8704
  v_mov_b32 v11, 1
  s_or_b32 s3, s6, s4
  s_cselect_b32 s50, 0, s50
  s_lshl_b32 s3, s5, 2
  s_mov_b64 exec, 1
  buffer_store_dword v11, off, s[48:51], s3 sc1
  s_mov_b64 exec, -1
  s_mov_b32 s50, 256
  v_mfma_f32_32x32x16_bf16 v[48:63], v[136:139], a[20:23], v[48:63]
  ds_read_b128 a[28:31], v185 offset:4096
  s_lshl_b32 s3, s7, 7
  s_add_u32 s3, s3, s52
  s_lshl3_add_u32 s3, s3, s11
  s_lshl_b32 s3, s3, 8
  s_add_u32 s99, s3, 9437184
  s_waitcnt vmcnt(7)
  s_barrier
  s_waitcnt lgkmcnt(5)
  v_mfma_f32_32x32x16_bf16 v[64:79], v[148:151], a[24:27], v[64:79]
  ds_read_b64_tr_b16 v[128:129], v186 offset:16384
  ds_read_b64_tr_b16 v[130:131], v186 offset:16896
  s_mul_i32 s3, s95, 56
  s_add_u32 s3, s3, s9
  s_lshl2_add_u32 s3, s3, s4
  s_lshl_b32 s3, s3, 10
  s_add_u32 s100, s3, 11534336
  v_mfma_f32_4x4x4_16b_bf16 v[80:83], a[24:25], a[24:25], v[80:83]
  v_mfma_f32_4x4x4_16b_bf16 v[84:87], a[26:27], a[26:27], v[84:87]
  ds_read_b64_tr_b16 v[132:133], v190 offset:16384
  ds_read_b64_tr_b16 v[134:135], v190 offset:16896
  s_add_u32 s58, s55, 689024
  s_add_u32 m0, s59, 32768
  s_mov_b64 exec, vcc
  buffer_load_dwordx4 v180, s[20:23], s58 offen lds
  s_mov_b64 exec, -1
  v_mfma_f32_32x32x16_bf16 v[48:63], v[144:147], a[24:27], v[48:63]
  ds_read_b128 a[32:35], v182 offset:8192
  s_mov_b64 exec, vcc
  buffer_load_dwordx4 v202, s[20:23], s58 offen offset:1024 lds
  s_mov_b64 exec, -1
  s_add_u32 m0, s54, -512
  s_waitcnt lgkmcnt(5)
  v_mfma_f32_32x32x16_bf16 v[64:79], v[156:159], a[28:31], v[64:79]
  ds_read_b64_tr_b16 v[136:137], v187 offset:16384
  ds_read_b64_tr_b16 v[138:139], v187 offset:16896
  s_add_u32 s78, s100, 114688
  s_lshl_b32 s101, s4, 2
  s_lshl2_add_u32 s64, s6, s4
  s_lshl_b32 s64, s64, 16
  v_mfma_f32_4x4x4_16b_bf16 v[80:83], a[28:29], a[28:29], v[80:83]
  v_mfma_f32_4x4x4_16b_bf16 v[84:87], a[30:31], a[30:31], v[84:87]
  ds_read_b64_tr_b16 v[140:141], v191 offset:16384
  ds_read_b64_tr_b16 v[142:143], v191 offset:16896
  buffer_load_dwordx4 v176, s[16:19], 0 offen offset:512 lds
  v_mfma_f32_32x32x16_bf16 v[48:63], v[152:155], a[28:31], v[48:63]
  ds_read_b128 a[36:39], v183 offset:8192
  s_lshl4_add_u32 s3, s5, s6
  s_lshl_b32 s3, s3, 7
  s_add_u32 s3, s3, s101
  s_add_u32 s2, s3, 9043968
  s_waitcnt lgkmcnt(5)
  v_mfma_f32_4x4x4_16b_bf16 v[96:99], v[160:161], v[128:129], v[96:99]
  v_mfma_f32_4x4x4_16b_bf16 v[100:103], v[160:161], v[130:131], v[100:103]
  ds_read_b64_tr_b16 v[144:145], v188 offset:16384
  ds_read_b64_tr_b16 v[146:147], v188 offset:16896
  s_lshl_b32 s56, s7, 5
  s_add_u32 s56, s56, s8
  s_lshl_b32 s56, s56, 7
  s_add_u32 s3, s56, s101
  s_add_u32 s57, s3, 9076736
  v_mfma_f32_4x4x4_16b_bf16 v[112:115], v[160:161], v[132:133], v[112:115]
  v_mfma_f32_4x4x4_16b_bf16 v[116:119], v[160:161], v[134:135], v[116:119]
  ds_read_b64_tr_b16 v[148:149], v192 offset:16384
  ds_read_b64_tr_b16 v[150:151], v192 offset:16896
  buffer_load_dwordx4 v177, s[16:19], 0 offen offset:1536 lds
  v_mfma_f32_32x32x16_bf16 v[64:79], v[132:135], a[32:35], v[64:79]
  ds_read_b128 a[40:43], v184 offset:8192
  v_min_u32 v2, 4, v1
  v_lshlrev_b32 v2, 15, v2
  s_sub_u32 s3, s57, 32768
  v_add_u32 v230, s3, v2
  v_writelane_b32 v230, s2, 0
  v_mfma_f32_4x4x4_16b_bf16 v[80:83], a[32:33], a[32:33], v[80:83]
  v_mfma_f32_4x4x4_16b_bf16 v[84:87], a[34:35], a[34:35], v[84:87]
  buffer_load_dwordx4 v178, s[16:19], 0 offen offset:2560 lds
  v_mfma_f32_32x32x16_bf16 v[48:63], v[128:131], a[32:35], v[48:63]
  s_add_u32 s3, s56, 8912912
  v_mov_b32 v233, s3
  s_lshl4_add_u32 s3, s6, s5
  s_lshl_b32 s3, s3, 7
  s_add_u32 s3, s3, 8912896
  v_writelane_b32 v233, s3, 0
  s_add_u32 s73, s3, s101
  s_waitcnt lgkmcnt(5)
  v_mfma_f32_32x32x16_bf16 v[64:79], v[140:143], a[36:39], v[64:79]
  ds_read_b64_tr_b16 v[152:153], v189 offset:16384
  ds_read_b64_tr_b16 v[154:155], v189 offset:16896
  s_bfe_u32 s3, s8, 0x20002
  s_lshl2_add_u32 s3, s95, s3
  s_lshl3_add_u32 s3, s3, s53
  s_lshl_b32 s56, s3, 7
  s_add_u32 s3, s56, 8912944
  v_writelane_b32 v233, s3, 2
  v_mfma_f32_4x4x4_16b_bf16 v[80:83], a[36:37], a[36:37], v[80:83]
  v_mfma_f32_4x4x4_16b_bf16 v[84:87], a[38:39], a[38:39], v[84:87]
  ds_read_b64_tr_b16 v[156:157], v193 offset:16384
  ds_read_b64_tr_b16 v[158:159], v193 offset:16896
  buffer_load_dwordx4 v179, s[16:19], 0 offen offset:3584 lds
  v_mfma_f32_32x32x16_bf16 v[48:63], v[136:139], a[36:39], v[48:63]
  ds_read_b128 a[44:47], v185 offset:8192
  s_add_u32 s3, s56, 9142272
  v_writelane_b32 v230, s3, 3
  s_add_u32 s3, s3, 32768
  v_writelane_b32 v230, s3, 4
  s_add_u32 s3, s3, 32768
  v_writelane_b32 v230, s3, 5
  s_waitcnt vmcnt(7)
  s_barrier
  s_waitcnt lgkmcnt(5)
  v_mfma_f32_32x32x16_bf16 v[64:79], v[148:151], a[40:43], v[64:79]
  ds_read_b64_tr_b16 v[128:129], v186 offset:24576
  ds_read_b64_tr_b16 v[130:131], v186 offset:25088
  s_cmp_eq_u32 s95, 7
  s_cselect_b32 s3, 3, s95
  s_lshl_b32 s69, s3, 12
  s_add_u32 s69, s69, 8912928
  s_lshl_b32 s3, s7, 12
  s_add_u32 s3, s3, 8912960
  s_cmp_eq_u32 s4, 2
  s_cselect_b32 s69, s3, s69
  v_mfma_f32_4x4x4_16b_bf16 v[80:83], a[40:41], a[40:41], v[80:83]
  v_mfma_f32_4x4x4_16b_bf16 v[84:87], a[42:43], a[42:43], v[84:87]
  ds_read_b64_tr_b16 v[132:133], v190 offset:24576
  ds_read_b64_tr_b16 v[134:135], v190 offset:25088
  s_add_u32 s58, s55, 861056
  s_add_u32 m0, s59, 40960
  s_mov_b64 exec, vcc
  buffer_load_dwordx4 v180, s[20:23], s58 offen lds
  s_mov_b64 exec, -1
  v_mfma_f32_32x32x16_bf16 v[48:63], v[144:147], a[40:43], v[48:63]
  ds_read_b128 a[48:51], v182 offset:12288
  s_mov_b64 exec, vcc
  buffer_load_dwordx4 v202, s[20:23], s58 offen offset:1024 lds
  s_mov_b64 exec, -1
  s_add_u32 m0, s54, 3456
  s_waitcnt lgkmcnt(5)
  v_mfma_f32_32x32x16_bf16 v[64:79], v[156:159], a[44:47], v[64:79]
  ds_read_b64_tr_b16 v[136:137], v187 offset:24576
  ds_read_b64_tr_b16 v[138:139], v187 offset:25088
  s_lshr_b32 s3, s8, 1
  s_lshl_b32 s3, s3, 7
  s_add_u32 s3, s3, 8912912
  s_cmp_eq_u32 s4, 0
  s_cselect_b32 s69, s3, s69
  s_cselect_b32 s56, 11, 7
  s_cselect_b32 s3, 15, 31
  v_min_u32 v2, s3, v1
  v_mfma_f32_4x4x4_16b_bf16 v[80:83], a[44:45], a[44:45], v[80:83]
  v_mfma_f32_4x4x4_16b_bf16 v[84:87], a[46:47], a[46:47], v[84:87]
  ds_read_b64_tr_b16 v[140:141], v191 offset:24576
  ds_read_b64_tr_b16 v[142:143], v191 offset:25088
  buffer_load_dwordx4 v176, s[16:19], 0 offen offset:640 lds
  v_mfma_f32_32x32x16_bf16 v[48:63], v[152:155], a[44:47], v[48:63]
  ds_read_b128 a[52:55], v183 offset:12288
  s_lshl_b32 s3, s8, 7
  s_add_u32 s3, s3, 8912928
  s_cmp_eq_u32 s4, 3
  s_cselect_b32 s69, s3, s69
  s_cselect_b32 s56, 12, s56
  s_cselect_b32 s3, 6, 31
  v_min_u32 v2, s3, v2
  s_waitcnt lgkmcnt(5)
  v_mfma_f32_4x4x4_16b_bf16 v[96:99], v[160:161], v[128:129], v[96:99]
  v_mfma_f32_4x4x4_16b_bf16 v[100:103], v[160:161], v[130:131], v[100:103]
  ds_read_b64_tr_b16 v[144:145], v188 offset:24576
  ds_read_b64_tr_b16 v[146:147], v188 offset:25088
  v_lshlrev_b32 v229, s56, v2
  v_and_b32 v3, 3, v1
  v_mfma_f32_4x4x4_16b_bf16 v[112:115], v[160:161], v[132:133], v[112:115]
  v_mfma_f32_4x4x4_16b_bf16 v[116:119], v[160:161], v[134:135], v[116:119]
  ds_read_b64_tr_b16 v[148:149], v192 offset:24576
  ds_read_b64_tr_b16 v[150:151], v192 offset:25088
  buffer_load_dwordx4 v177, s[16:19], 0 offen offset:1664 lds
  v_mfma_f32_32x32x16_bf16 v[64:79], v[132:135], a[48:51], v[64:79]
  ds_read_b128 a[56:59], v184 offset:12288
  s_lshr_b32 s3, s6, 1
  s_lshl2_add_u32 s3, s3, s4
  s_lshl_b32 s3, s3, 9
  s_add_u32 s3, s3, 8912896
  v_bfe_u32 v2, v1, 2, 1
  v_lshl_add_u32 v2, v2, 14, s3
  v_mfma_f32_4x4x4_16b_bf16 v[80:83], a[48:49], a[48:49], v[80:83]
  v_mfma_f32_4x4x4_16b_bf16 v[84:87], a[50:51], a[50:51], v[84:87]
  buffer_load_dwordx4 v178, s[16:19], 0 offen offset:2688 lds
  v_mfma_f32_32x32x16_bf16 v[48:63], v[128:131], a[48:51], v[48:63]
  v_mov_b32 v207, v2
  v_lshl_add_u32 v253, v3, 7, v2
  s_waitcnt lgkmcnt(5)
  v_mfma_f32_32x32x16_bf16 v[64:79], v[140:143], a[52:55], v[64:79]
  ds_read_b64_tr_b16 v[152:153], v189 offset:24576
  ds_read_b64_tr_b16 v[154:155], v189 offset:25088
  s_mul_i32 s0, s4, 24576
  s_add_u32 s0, s0, 59392
  s_mul_i32 s1, s4, 1835008
  s_lshl_b32 s3, s9, 7
  s_add_u32 s1, s1, s3
  v_mfma_f32_4x4x4_16b_bf16 v[80:83], a[52:53], a[52:53], v[80:83]
  v_mfma_f32_4x4x4_16b_bf16 v[84:87], a[54:55], a[54:55], v[84:87]
  ds_read_b64_tr_b16 v[156:157], v193 offset:24576
  ds_read_b64_tr_b16 v[158:159], v193 offset:25088
  buffer_load_dwordx4 v179, s[16:19], 0 offen offset:3712 lds
  v_mfma_f32_32x32x16_bf16 v[48:63], v[136:139], a[52:55], v[48:63]
  ds_read_b128 a[60:63], v185 offset:12288
  v_lshrrev_b32 v2, 2, v1
  v_and_b32 v2, 4, v2
  v_and_b32 v3, 7, v1
  v_lshlrev_b32 v231, 7, v3
  v_xor_b32 v2, v2, v3
  s_waitcnt vmcnt(6)
  s_barrier
  s_waitcnt lgkmcnt(5)
  v_mfma_f32_32x32x16_bf16 v[64:79], v[148:151], a[56:59], v[64:79]
  ds_read_b64_tr_b16 v[128:129], v186 offset:32768
  ds_read_b64_tr_b16 v[130:131], v186 offset:33280
  v_lshrrev_b32 v3, 3, v1
  v_mul_u32_u24 v4, 3584, v3
  v_lshl_add_u32 v216, v2, 4, v4
  v_mul_u32_u24 v4, 896, v3
  v_mfma_f32_4x4x4_16b_bf16 v[80:83], a[56:57], a[56:57], v[80:83]
  v_mfma_f32_4x4x4_16b_bf16 v[84:87], a[58:59], a[58:59], v[84:87]
  ds_read_b64_tr_b16 v[132:133], v190 offset:32768
  ds_read_b64_tr_b16 v[134:135], v190 offset:33280
  s_add_u32 s58, s55, 1033088
  s_add_u32 m0, s59, 49152
  s_mov_b64 exec, vcc
  buffer_load_dwordx4 v180, s[20:23], s58 offen lds
  s_mov_b64 exec, -1
  v_mfma_f32_32x32x16_bf16 v[48:63], v[144:147], a[56:59], v[48:63]
  ds_read_b128 a[64:67], v182 offset:0
  s_mov_b64 exec, vcc
  buffer_load_dwordx4 v202, s[20:23], s58 offen offset:1024 lds
  s_mov_b64 exec, -1
  s_add_u32 m0, s54, 7424
  s_waitcnt lgkmcnt(5)
  v_mfma_f32_32x32x16_bf16 v[64:79], v[156:159], a[60:63], v[64:79]
  ds_read_b64_tr_b16 v[136:137], v187 offset:32768
  ds_read_b64_tr_b16 v[138:139], v187 offset:33280
  v_and_b32 v3, 2, v3
  v_and_b32 v2, 7, v1
  v_xor_b32 v2, v2, v3
  v_lshl_add_u32 v212, v2, 4, v4
  v_mfma_f32_4x4x4_16b_bf16 v[80:83], a[60:61], a[60:61], v[80:83]
  v_mfma_f32_4x4x4_16b_bf16 v[84:87], a[62:63], a[62:63], v[84:87]
  ds_read_b64_tr_b16 v[140:141], v191 offset:32768
  ds_read_b64_tr_b16 v[142:143], v191 offset:33280
  buffer_load_dwordx4 v176, s[16:19], 0 offen offset:768 lds
  v_mfma_f32_32x32x16_bf16 v[48:63], v[152:155], a[60:63], v[48:63]
  ds_read_b128 a[68:71], v183 offset:0
  v_add_u32 v217, 27648, v216
  v_add_u32 v218, 55296, v216
  v_add_u32 v219, 82944, v216
  s_waitcnt lgkmcnt(5)
  v_mfma_f32_4x4x4_16b_bf16 v[96:99], v[160:161], v[128:129], v[96:99]
  v_mfma_f32_4x4x4_16b_bf16 v[100:103], v[160:161], v[130:131], v[100:103]
  ds_read_b64_tr_b16 v[144:145], v188 offset:32768
  ds_read_b64_tr_b16 v[146:147], v188 offset:33280
  v_add_u32 v213, 6144, v212
  v_add_u32 v214, 12288, v212
  v_add_u32 v215, 18432, v212
  v_mfma_f32_4x4x4_16b_bf16 v[112:115], v[160:161], v[132:133], v[112:115]
  v_mfma_f32_4x4x4_16b_bf16 v[116:119], v[160:161], v[134:135], v[116:119]
  ds_read_b64_tr_b16 v[148:149], v192 offset:32768
  ds_read_b64_tr_b16 v[150:151], v192 offset:33280
  buffer_load_dwordx4 v177, s[16:19], 0 offen offset:1792 lds
  v_mfma_f32_32x32x16_bf16 v[64:79], v[132:135], a[64:67], v[64:79]
  ds_read_b128 a[72:75], v184 offset:0
  v_bfe_u32 v4, v1, 4, 1
  v_xor_b32 v4, s4, v4
  v_lshlrev_b32 v4, 5, v4
  v_and_b32 v5, 3, v1
  v_lshl_add_u32 v4, v5, 3, v4
  v_mfma_f32_4x4x4_16b_bf16 v[80:83], a[64:65], a[64:65], v[80:83]
  v_mfma_f32_4x4x4_16b_bf16 v[84:87], a[66:67], a[66:67], v[84:87]
  buffer_load_dwordx4 v178, s[16:19], 0 offen offset:2816 lds
  v_mfma_f32_32x32x16_bf16 v[48:63], v[128:131], a[64:67], v[48:63]
L_pad0:
  s_cbranch_execz L_padx0_4
  v_bfe_u32 v2, v1, 2, 2
  v_lshrrev_b32 v3, 5, v1
  v_lshl_add_u32 v3, v3, 3, v2
  s_waitcnt lgkmcnt(5)
  v_mfma_f32_32x32x16_bf16 v[64:79], v[140:143], a[68:71], v[64:79]
  ds_read_b64_tr_b16 v[152:153], v189 offset:32768
  ds_read_b64_tr_b16 v[154:155], v189 offset:33280
  v_lshrrev_b32 v2, 1, v2
  v_lshlrev_b32 v2, 6, v2
  v_xor_b32 v2, v2, v4
  v_lshl_add_u32 v220, v3, 7, v2
  v_mfma_f32_4x4x4_16b_bf16 v[80:83], a[68:69], a[68:69], v[80:83]
  v_mfma_f32_4x4x4_16b_bf16 v[84:87], a[70:71], a[70:71], v[84:87]
  ds_read_b64_tr_b16 v[156:157], v193 offset:32768
  ds_read_b64_tr_b16 v[158:159], v193 offset:33280
  buffer_load_dwordx4 v179, s[16:19], 0 offen offset:3840 lds
  v_mfma_f32_32x32x16_bf16 v[48:63], v[136:139], a[68:71], v[48:63]
  ds_read_b128 a[76:79], v185 offset:0
  v_add_u32 v220, s0, v220
  v_xor_b32 v221, 64, v220
  s_mul_i32 s79, s4, 14336
  s_waitcnt vmcnt(6)
  s_barrier
  s_waitcnt lgkmcnt(5)
  v_mfma_f32_32x32x16_bf16 v[64:79], v[148:151], a[72:75], v[64:79]
  ds_read_b64_tr_b16 v[128:129], v186 offset:40960
  ds_read_b64_tr_b16 v[130:131], v186 offset:41472
  v_and_b32 v2, 31, v1
  v_mul_u32_u24 v4, 896, v2
  v_lshrrev_b32 v3, 5, v1
  v_lshl_add_u32 v244, v3, 4, v4
  v_mfma_f32_4x4x4_16b_bf16 v[80:83], a[72:73], a[72:73], v[80:83]
  v_mfma_f32_4x4x4_16b_bf16 v[84:87], a[74:75], a[74:75], v[84:87]
  ds_read_b64_tr_b16 v[132:133], v190 offset:40960
  ds_read_b64_tr_b16 v[134:135], v190 offset:41472
  buffer_load_dword v200, v201, s[48:51], 0 offen sc1
  v_mfma_f32_32x32x16_bf16 v[48:63], v[144:147], a[72:75], v[48:63]
  ds_read_b128 a[80:83], v182 offset:4096
  s_add_u32 m0, s63, 58368
  s_add_u32 s58, s60, 0
  buffer_load_dwordx4 v181, s[20:23], s58 offen lds
  s_waitcnt lgkmcnt(5)
  v_mfma_f32_32x32x16_bf16 v[64:79], v[156:159], a[76:79], v[64:79]
  ds_read_b64_tr_b16 v[136:137], v187 offset:40960
  ds_read_b64_tr_b16 v[138:139], v187 offset:41472
  v_lshlrev_b32 v250, 3, v3
  v_lshlrev_b32 v252, 1, v2
  s_lshl2_add_u32 s66, s9, s4
  s_lshl_b32 s66, s66, 5
  s_lshl_b32 s68, s52, 6
  v_mfma_f32_4x4x4_16b_bf16 v[80:83], a[76:77], a[76:77], v[80:83]
  v_mfma_f32_4x4x4_16b_bf16 v[84:87], a[78:79], a[78:79], v[84:87]
  ds_read_b64_tr_b16 v[140:141], v191 offset:40960
  ds_read_b64_tr_b16 v[142:143], v191 offset:41472
  s_add_u32 m0, s63, 62464
  s_add_u32 s58, s60, 172032
  buffer_load_dwordx4 v181, s[20:23], s58 offen lds
  v_mfma_f32_32x32x16_bf16 v[48:63], v[152:155], a[76:79], v[48:63]
  ds_read_b128 a[84:87], v183 offset:4096
  s_mul_i32 s65, s52, 28672
  s_lshl_b32 s3, s7, 7
  s_add_u32 s65, s65, s3
  s_lshl_b32 s3, s11, 5
  s_add_u32 s65, s65, s3
  s_waitcnt lgkmcnt(5)
  v_mfma_f32_4x4x4_16b_bf16 v[96:99], v[160:161], v[128:129], v[96:99]
  v_mfma_f32_4x4x4_16b_bf16 v[100:103], v[160:161], v[130:131], v[100:103]
  ds_read_b64_tr_b16 v[144:145], v188 offset:40960
  ds_read_b64_tr_b16 v[146:147], v188 offset:41472
  s_add_u32 s56, s4, 1
  s_and_b32 s56, s56, 3
  s_mul_i32 s3, s56, 24576
  s_add_u32 s3, s3, 71680
  v_add_u32 v236, s3, v7
  v_mfma_f32_4x4x4_16b_bf16 v[112:115], v[160:161], v[132:133], v[112:115]
  v_mfma_f32_4x4x4_16b_bf16 v[116:119], v[160:161], v[134:135], v[116:119]
  ds_read_b64_tr_b16 v[148:149], v192 offset:40960
  ds_read_b64_tr_b16 v[150:151], v192 offset:41472
  s_add_u32 m0, s63, 66560
  s_add_u32 s58, s60, 344064
  buffer_load_dwordx4 v181, s[20:23], s58 offen lds
  v_mfma_f32_32x32x16_bf16 v[64:79], v[132:135], a[80:83], v[64:79]
  ds_read_b128 a[88:91], v184 offset:4096
  s_lshl_b32 s3, s56, 11
  s_add_u32 s3, s3, 145408
  v_add_u32 v20, s3, v7
  v_mfma_f32_4x4x4_16b_bf16 v[80:83], a[80:81], a[80:81], v[80:83]
  v_mfma_f32_4x4x4_16b_bf16 v[84:87], a[82:83], a[82:83], v[84:87]
  s_add_u32 m0, s63, 70656
  s_add_u32 s58, s60, 516096
  buffer_load_dwordx4 v181, s[20:23], s58 offen lds
  v_mfma_f32_32x32x16_bf16 v[48:63], v[128:131], a[80:83], v[48:63]
  s_add_u32 s56, s4, 2
  s_and_b32 s56, s56, 3
  s_mul_i32 s3, s56, 24576
  s_add_u32 s3, s3, 71680
  v_add_u32 v237, s3, v7
  s_waitcnt lgkmcnt(5)
  v_mfma_f32_32x32x16_bf16 v[64:79], v[140:143], a[84:87], v[64:79]
  ds_read_b64_tr_b16 v[152:153], v189 offset:40960
  ds_read_b64_tr_b16 v[154:155], v189 offset:41472
  s_lshl_b32 s3, s56, 11
  s_add_u32 s3, s3, 145408
  v_add_u32 v28, s3, v7
  v_mfma_f32_4x4x4_16b_bf16 v[80:83], a[84:85], a[84:85], v[80:83]
  v_mfma_f32_4x4x4_16b_bf16 v[84:87], a[86:87], a[86:87], v[84:87]
  ds_read_b64_tr_b16 v[156:157], v193 offset:40960
  ds_read_b64_tr_b16 v[158:159], v193 offset:41472
  s_add_u32 s56, s4, 3
  s_and_b32 s56, s56, 3
  s_mul_i32 s3, s56, 24576
  s_add_u32 s3, s3, 71680
  v_add_u32 v238, s3, v7
  v_mfma_f32_32x32x16_bf16 v[48:63], v[136:139], a[84:87], v[48:63]
  ds_read_b128 a[92:95], v185 offset:4096
  s_lshl_b32 s3, s56, 11
  s_add_u32 s3, s3, 145408
  v_add_u32 v36, s3, v7
  s_waitcnt vmcnt(5)
  s_barrier
  s_waitcnt lgkmcnt(5)
  v_mfma_f32_32x32x16_bf16 v[64:79], v[148:151], a[88:91], v[64:79]
  ds_read_b64_tr_b16 v[128:129], v186 offset:49152
  ds_read_b64_tr_b16 v[130:131], v186 offset:49664
  v_add_u32 v239, s0, v7
  s_lshl_b32 s3, s4, 11
  s_add_u32 s3, s3, 145408
  v_add_u32 v210, s3, v7
  v_mfma_f32_4x4x4_16b_bf16 v[80:83], a[88:89], a[88:89], v[80:83]
  v_mfma_f32_4x4x4_16b_bf16 v[84:87], a[90:91], a[90:91], v[84:87]
  ds_read_b64_tr_b16 v[132:133], v190 offset:49152
  ds_read_b64_tr_b16 v[134:135], v190 offset:49664
  s_add_u32 m0, s63, 74752
  s_add_u32 s58, s60, 688128
  buffer_load_dwordx4 v181, s[20:23], s58 offen lds
  v_mfma_f32_32x32x16_bf16 v[48:63], v[144:147], a[88:91], v[48:63]
  ds_read_b128 a[96:99], v182 offset:8192
  s_add_u32 s3, s95, 8
  s_cmp_eq_u32 s95, 7
  s_cselect_b32 s3, s53, s3
  s_mul_i32 s70, s3, 32256
  s_mul_i32 s3, s4, 1835008
  s_add_u32 s70, s70, s3
  s_waitcnt lgkmcnt(5)
  v_mfma_f32_32x32x16_bf16 v[64:79], v[156:159], a[92:95], v[64:79]
  ds_read_b64_tr_b16 v[136:137], v187 offset:49152
  ds_read_b64_tr_b16 v[138:139], v187 offset:49664
  s_bfe_u32 s3, s8, 0x20002
  s_mul_i32 s3, s3, 896
  s_add_u32 s70, s70, s3
  s_mov_b32 s72, 0x30800000
  v_mfma_f32_4x4x4_16b_bf16 v[80:83], a[92:93], a[92:93], v[80:83]
  v_mfma_f32_4x4x4_16b_bf16 v[84:87], a[94:95], a[94:95], v[84:87]
  ds_read_b64_tr_b16 v[140:141], v191 offset:49152
  ds_read_b64_tr_b16 v[142:143], v191 offset:49664
  s_add_u32 m0, s63, 78848
  s_add_u32 s58, s60, 860160
  buffer_load_dwordx4 v181, s[20:23], s58 offen lds
  v_mfma_f32_32x32x16_bf16 v[48:63], v[152:155], a[92:95], v[48:63]
  ds_read_b128 a[100:103], v183 offset:8192
  s_lshr_b32 s3, s53, 2
  s_and_b32 s3, s3, s53
  s_lshr_b32 s56, s53, 1
  s_sub_u32 s56, s56, s3
  s_add_u32 s56, s56, 4
  s_and_b32 s3, s8, 3
  s_cmp_eq_u32 s53, 3
  s_cselect_b32 s56, s3, s56
  s_waitcnt lgkmcnt(5)
  v_mfma_f32_4x4x4_16b_bf16 v[96:99], v[160:161], v[128:129], v[96:99]
  v_mfma_f32_4x4x4_16b_bf16 v[100:103], v[160:161], v[130:131], v[100:103]
  ds_read_b64_tr_b16 v[144:145], v188 offset:49152
  ds_read_b64_tr_b16 v[146:147], v188 offset:49664
  s_mul_i32 s3, s4, 28
  s_add_u32 s3, s3, s56
  s_lshl_b32 s71, s3, 16
  s_lshr_b32 s3, s8, 2
  s_lshl_b32 s3, s3, 9
  s_add_u32 s71, s71, s3
  v_mfma_f32_4x4x4_16b_bf16 v[112:115], v[160:161], v[132:133], v[112:115]
  v_mfma_f32_4x4x4_16b_bf16 v[116:119], v[160:161], v[134:135], v[116:119]
  ds_read_b64_tr_b16 v[148:149], v192 offset:49152
  ds_read_b64_tr_b16 v[150:151], v192 offset:49664
  s_add_u32 m0, s63, 82944
  s_add_u32 s58, s60, 1032192
  buffer_load_dwordx4 v181, s[20:23], s58 offen lds
  v_mfma_f32_32x32x16_bf16 v[64:79], v[132:135], a[96:99], v[64:79]
  ds_read_b128 a[104:107], v184 offset:8192
  v_min_u32 v2, 62, v1
  v_mul_u32_u24 v3, 37, v2
  v_lshrrev_b32 v3, 8, v3
  v_mul_u32_u24 v3, 2688, v3
  v_lshl_add_u32 v222, v2, 7, v3
  v_mfma_f32_4x4x4_16b_bf16 v[80:83], a[96:97], a[96:97], v[80:83]
  v_mfma_f32_4x4x4_16b_bf16 v[84:87], a[98:99], a[98:99], v[84:87]
  v_lshrrev_b32 v2, 2, v1
  v_and_b32 v3, 3, v1
  v_lshlrev_b32 v3, 7, v3
  v_lshl_add_u32 v223, v2, 12, v3
  v_mfma_f32_32x32x16_bf16 v[48:63], v[128:131], a[96:99], v[48:63]
  s_lshr_b32 s3, s52, 2
  s_lshl1_add_u32 s3, s3, s11
  s_lshl_b32 s3, s3, 10
  s_add_u32 s67, s3, 9043968
  s_waitcnt lgkmcnt(5)
  v_mfma_f32_32x32x16_bf16 v[64:79], v[140:143], a[100:103], v[64:79]
  ds_read_b64_tr_b16 v[152:153], v189 offset:49152
  ds_read_b64_tr_b16 v[154:155], v189 offset:49664
  v_mfma_f32_4x4x4_16b_bf16 v[80:83], a[100:101], a[100:101], v[80:83]
  v_mfma_f32_4x4x4_16b_bf16 v[84:87], a[102:103], a[102:103], v[84:87]
  ds_read_b64_tr_b16 v[156:157], v193 offset:49152
  ds_read_b64_tr_b16 v[158:159], v193 offset:49664
  v_mfma_f32_32x32x16_bf16 v[48:63], v[136:139], a[100:103], v[48:63]
  ds_read_b128 a[108:111], v185 offset:8192
  v_add_f32 v96, v96, v100
  v_add_f32 v112, v112, v116
  ds_write_b32 v198, v96
  ds_write_b32 v198, v112 offset:1024
  s_waitcnt vmcnt(7)
  v_cmp_ne_u32 vcc, 1, v200
  s_waitcnt lgkmcnt(7)
  v_mfma_f32_32x32x16_bf16 v[64:79], v[148:151], a[104:107], v[64:79]
  v_mfma_f32_4x4x4_16b_bf16 v[80:83], a[104:105], a[104:105], v[80:83]
  v_mfma_f32_4x4x4_16b_bf16 v[84:87], a[106:107], a[106:107], v[84:87]
  v_mfma_f32_32x32x16_bf16 v[48:63], v[144:147], a[104:107], v[48:63]
  s_cbranch_vccnz L_gw
L_go:
  s_mov_b64 s[48:49], s[12:13]
  s_and_b32 s3, s5, 0
  s_cselect_b32 s50, 0, s14
  s_mov_b64 s[20:21], s[12:13]
  s_and_b32 s3, s5, 3
  s_or_b32 s3, s3, s4
  s_cselect_b32 s22, 0, s14
  s_waitcnt lgkmcnt(0)
  s_barrier
  ds_read_b128 v[96:99], v199
  ds_read_b128 v[112:115], v199 offset:1024
  s_waitcnt lgkmcnt(4)
  v_mfma_f32_32x32x16_bf16 v[64:79], v[156:159], a[108:111], v[64:79]
  v_mfma_f32_4x4x4_16b_bf16 v[80:83], a[108:109], a[108:109], v[80:83]
  v_mfma_f32_4x4x4_16b_bf16 v[84:87], a[110:111], a[110:111], v[84:87]
  v_mfma_f32_32x32x16_bf16 v[48:63], v[152:155], a[108:111], v[48:63]
  s_waitcnt lgkmcnt(0)
  v_pk_add_f32 v[2:3], v[96:97], v[98:99]
  v_pk_add_f32 v[4:5], v[112:113], v[114:115]
  v_add_f32 v2, v2, v3
  v_add_f32 v4, v4, v5
  v_and_b32 v8, 0xffff0000, v2
  v_sub_f32 v8, v2, v8
  v_and_b32 v9, 0xffff0000, v8
  v_sub_f32 v9, v8, v9
  v_perm_b32 v164, v2, v2, s62
  v_perm_b32 v165, v8, v8, s62
  v_perm_b32 v166, v9, v2, s62
  v_and_b32 v10, 0xffff0000, v4
  v_sub_f32 v10, v4, v10
  v_and_b32 v11, 0xffff0000, v10
  v_sub_f32 v11, v10, v11
  v_perm_b32 v168, v4, v4, s62
  v_perm_b32 v169, v10, v10, s62
  v_perm_b32 v170, v11, v4, s62
  v_mov_b32 v2, v76
  v_mov_b32 v3, v76
  s_mov_b32 vcc_lo, 0xaaaaaaaa
  s_mov_b32 vcc_hi, 0xaaaaaaaa
  v_permlane32_swap_b32 v2, v3
  v_mul_f32 v6, 0xbb124925, v3
  v_and_b32 v8, 0xffff0000, v6
  v_sub_f32 v8, v6, v8
  v_and_b32 v9, 0xffff0000, v8
  v_sub_f32 v9, v8, v9
  v_perm_b32 v172, v8, v6, s62
  v_perm_b32 v173, v8, v6, s62
  v_perm_b32 v174, v6, v9, s62
  v_pk_add_f32 v[80:81], v[80:81], v[84:85]
  v_pk_add_f32 v[82:83], v[82:83], v[86:87]
  v_mfma_f32_32x32x16_bf16 v[48:63], v[164:167], v[172:175], v[48:63]
  v_cndmask_b32 v80, v80, v81, vcc
  v_cndmask_b32 v81, v82, v83, vcc
  s_mov_b32 vcc_lo, 0xcccccccc
  s_mov_b32 vcc_hi, 0xcccccccc
  v_mfma_f32_32x32x16_bf16 v[64:79], v[168:171], v[172:175], v[64:79]
  v_cndmask_b32 v2, v80, v81, vcc
  v_mov_b32 v3, v2
  s_nop 1
  v_permlane32_swap_b32 v3, v2
  v_add_f32 v2, v3, v2
  v_mul_f32 v2, 0x3b124925, v2
  v_fma_f32 v2, -v6, v6, v2
  v_max_f32 v2, 0, v2
  v_add_f32 v2, 0x3727c5ac, v2
  v_rsq_f32 v204, v2
  s_mov_b64 exec, 1
  buffer_store_dword v200, off, s[20:23], s73 sc1
  s_mov_b64 exec, -1
  v_mov_b32 v2, 0x3f80
  s_cmp_ge_u32 s6, 8
  s_cbranch_scc0 L_v
  s_add_u32 s60, s61, 262144
  v_pk_mul_f32 v[48:49], v[48:49], v[204:205] op_sel_hi:[1,0]
  v_pk_mul_f32 v[50:51], v[50:51], v[204:205] op_sel_hi:[1,0]
  v_pk_mul_f32 v[52:53], v[52:53], v[204:205] op_sel_hi:[1,0]
  v_pk_mul_f32 v[54:55], v[54:55], v[204:205] op_sel_hi:[1,0]
  v_pk_mul_f32 v[56:57], v[56:57], v[204:205] op_sel_hi:[1,0]
  v_pk_mul_f32 v[58:59], v[58:59], v[204:205] op_sel_hi:[1,0]
  v_pk_mul_f32 v[60:61], v[60:61], v[204:205] op_sel_hi:[1,0]
  v_pk_mul_f32 v[62:63], v[62:63], v[204:205] op_sel_hi:[1,0]
  v_cvt_pk_bf16_f32 v96, v48, v49
  v_cvt_pk_bf16_f32 v97, v50, v51
  v_cvt_pk_bf16_f32 v98, v52, v53
  v_cvt_pk_bf16_f32 v99, v54, v55
  v_cvt_pk_bf16_f32 v100, v56, v57
  v_cvt_pk_bf16_f32 v101, v58, v59
  v_cvt_pk_bf16_f32 v102, v60, v61
  v_cvt_pk_bf16_f32 v103, v62, v63
  v_cndmask_b32 v102, v102, v160, s[74:75]
  v_cndmask_b32 v103, v103, v2, s[74:75]
  v_min_u32 v96, -2, v96
  v_min_u32 v100, -2, v100
  buffer_store_dwordx4 v[96:99], v7, s[48:51], s61 offen offset:0 sc1
  buffer_store_dwordx4 v[100:103], v7, s[48:51], s61 offen offset:1024 sc1
  v_pk_mul_f32 v[64:65], v[64:65], v[204:205] op_sel_hi:[1,0]
  v_pk_mul_f32 v[66:67], v[66:67], v[204:205] op_sel_hi:[1,0]
  v_pk_mul_f32 v[68:69], v[68:69], v[204:205] op_sel_hi:[1,0]
  v_pk_mul_f32 v[70:71], v[70:71], v[204:205] op_sel_hi:[1,0]
  v_pk_mul_f32 v[72:73], v[72:73], v[204:205] op_sel_hi:[1,0]
  v_pk_mul_f32 v[74:75], v[74:75], v[204:205] op_sel_hi:[1,0]
  v_pk_mul_f32 v[76:77], v[76:77], v[204:205] op_sel_hi:[1,0]
  v_pk_mul_f32 v[78:79], v[78:79], v[204:205] op_sel_hi:[1,0]
  v_cvt_pk_bf16_f32 v104, v64, v65
  v_cvt_pk_bf16_f32 v105, v66, v67
  v_cvt_pk_bf16_f32 v106, v68, v69
  v_cvt_pk_bf16_f32 v107, v70, v71
  v_cvt_pk_bf16_f32 v108, v72, v73
  v_cvt_pk_bf16_f32 v109, v74, v75
  v_cvt_pk_bf16_f32 v110, v76, v77
  v_cvt_pk_bf16_f32 v111, v78, v79
  v_cndmask_b32 v110, v110, v160, s[74:75]
  v_cndmask_b32 v111, v111, v2, s[74:75]
  v_min_u32 v104, -2, v104
  v_min_u32 v108, -2, v108
  buffer_store_dwordx4 v[104:107], v7, s[48:51], s60 offen offset:0 sc1
  buffer_store_dwordx4 v[108:111], v7, s[48:51], s60 offen offset:1024 sc1
  s_branch L_q
L_v:
  s_add_u32 s61, s61, 2048
  s_add_u32 s60, s61, 262144
  v_pk_mul_f32 v[48:49], v[48:49], v[204:205] op_sel_hi:[1,0]
  v_pk_mul_f32 v[50:51], v[50:51], v[204:205] op_sel_hi:[1,0]
  v_pk_mul_f32 v[52:53], v[52:53], v[204:205] op_sel_hi:[1,0]
  v_pk_mul_f32 v[54:55], v[54:55], v[204:205] op_sel_hi:[1,0]
  v_pk_mul_f32 v[56:57], v[56:57], v[204:205] op_sel_hi:[1,0]
  v_pk_mul_f32 v[58:59], v[58:59], v[204:205] op_sel_hi:[1,0]
  v_pk_mul_f32 v[60:61], v[60:61], v[204:205] op_sel_hi:[1,0]
  v_pk_mul_f32 v[62:63], v[62:63], v[204:205] op_sel_hi:[1,0]
  v_cvt_pk_bf16_f32 v80, v48, v49
  v_cvt_pk_bf16_f32 v81, v50, v51
  v_cvt_pk_bf16_f32 v82, v52, v53
  v_cvt_pk_bf16_f32 v83, v54, v55
  v_cvt_pk_bf16_f32 v84, v56, v57
  v_cvt_pk_bf16_f32 v85, v58, v59
  v_cvt_pk_bf16_f32 v86, v60, v61
  v_cvt_pk_bf16_f32 v87, v62, v63
  v_cndmask_b32 v86, v86, v2, s[74:75]
  v_cndmask_b32 v87, v87, v175, s[74:75]
  ds_write_b64 v208, v[80:81] offset:0
  ds_write_b64 v208, v[82:83] offset:16
  ds_write_b64 v208, v[84:85] offset:32
  ds_write_b64 v208, v[86:87] offset:48
  ds_read_b64_tr_b16 v[96:97], v209 offset:0
  ds_read_b64_tr_b16 v[98:99], v209 offset:576
  ds_read_b64_tr_b16 v[100:101], v209 offset:1152
  ds_read_b64_tr_b16 v[102:103], v209 offset:1728
  v_pk_mul_f32 v[64:65], v[64:65], v[204:205] op_sel_hi:[1,0]
  v_pk_mul_f32 v[66:67], v[66:67], v[204:205] op_sel_hi:[1,0]
  v_pk_mul_f32 v[68:69], v[68:69], v[204:205] op_sel_hi:[1,0]
  v_pk_mul_f32 v[70:71], v[70:71], v[204:205] op_sel_hi:[1,0]
  v_pk_mul_f32 v[72:73], v[72:73], v[204:205] op_sel_hi:[1,0]
  v_pk_mul_f32 v[74:75], v[74:75], v[204:205] op_sel_hi:[1,0]
  v_pk_mul_f32 v[76:77], v[76:77], v[204:205] op_sel_hi:[1,0]
  v_pk_mul_f32 v[78:79], v[78:79], v[204:205] op_sel_hi:[1,0]
  v_cvt_pk_bf16_f32 v88, v64, v65
  v_cvt_pk_bf16_f32 v89, v66, v67
  v_cvt_pk_bf16_f32 v90, v68, v69
  v_cvt_pk_bf16_f32 v91, v70, v71
  v_cvt_pk_bf16_f32 v92, v72, v73
  v_cvt_pk_bf16_f32 v93, v74, v75
  v_cvt_pk_bf16_f32 v94, v76, v77
  v_cvt_pk_bf16_f32 v95, v78, v79
  v_cndmask_b32 v94, v94, v2, s[74:75]
  v_cndmask_b32 v95, v95, v175, s[74:75]
  s_waitcnt lgkmcnt(0)
  v_min_u32 v96, -2, v96
  v_min_u32 v100, -2, v100
  ds_write_b64 v208, v[88:89] offset:4096
  ds_write_b64 v208, v[90:91] offset:4112
  ds_write_b64 v208, v[92:93] offset:4128
  ds_write_b64 v208, v[94:95] offset:4144
  ds_read_b64_tr_b16 v[104:105], v209 offset:4096
  ds_read_b64_tr_b16 v[106:107], v209 offset:4672
  ds_read_b64_tr_b16 v[108:109], v209 offset:5248
  ds_read_b64_tr_b16 v[110:111], v209 offset:5824
  buffer_store_dwordx4 v[96:99], v7, s[48:51], s61 offen offset:0 sc1
  buffer_store_dwordx4 v[100:103], v7, s[48:51], s61 offen offset:1024 sc1
  s_waitcnt lgkmcnt(0)
  v_min_u32 v104, -2, v104
  v_min_u32 v108, -2, v108
  buffer_store_dwordx4 v[104:107], v7, s[48:51], s60 offen offset:0 sc1
  buffer_store_dwordx4 v[108:111], v7, s[48:51], s60 offen offset:1024 sc1
L_q:
  s_waitcnt vmcnt(5)
  s_barrier
  ds_read_b64_tr_b16 v[128:129], v194 offset:0
  ds_read_b64_tr_b16 v[130:131], v194 offset:256
  ds_read_b64_tr_b16 v[132:133], v194 offset:4096
  ds_read_b64_tr_b16 v[134:135], v194 offset:4352
  ds_read_b64_tr_b16 v[136:137], v194 offset:8192
  ds_read_b64_tr_b16 v[138:139], v194 offset:8448
  ds_read_b64_tr_b16 v[140:141], v194 offset:12288
  ds_read_b64_tr_b16 v[142:143], v194 offset:12544
  ds_read_b64_tr_b16 v[144:145], v194 offset:16384
  ds_read_b64_tr_b16 v[146:147], v194 offset:16640
  ds_read_b64_tr_b16 v[148:149], v194 offset:20480
  ds_read_b64_tr_b16 v[150:151], v194 offset:20736
  s_mul_i32 s3, s4, 100352
  s_lshl_b32 s58, s7, 7
  s_add_u32 s58, s58, s3
  s_waitcnt lgkmcnt(10)
  v_mfma_f32_4x4x4_16b_bf16 v[112:115], v[160:161], v[128:129], 0
  v_mfma_f32_4x4x4_16b_bf16 v[116:119], v[160:161], v[130:131], 0
  v_mfma_f32_32x32x16_bf16 v[48:63], v[128:131], a[0:3], 0
  ds_read_b64_tr_b16 v[152:153], v194 offset:24576
  ds_read_b64_tr_b16 v[154:155], v194 offset:24832
  s_add_u32 m0, s79, 0
  s_nop 0
  buffer_load_dwordx4 v212, s[24:27], s58 offen lds
  s_waitcnt lgkmcnt(10)
  v_mfma_f32_4x4x4_16b_bf16 v[112:115], v[160:161], v[132:133], v[112:115]
  v_mfma_f32_4x4x4_16b_bf16 v[116:119], v[160:161], v[134:135], v[116:119]
  v_mfma_f32_32x32x16_bf16 v[48:63], v[132:135], a[16:19], v[48:63]
  ds_read_b64_tr_b16 v[156:157], v195 offset:0
  ds_read_b64_tr_b16 v[158:159], v195 offset:256
  buffer_load_dwordx4 v213, s[24:27], s58 offen offset:1024 lds
  s_waitcnt lgkmcnt(10)
  v_mfma_f32_4x4x4_16b_bf16 v[112:115], v[160:161], v[136:137], v[112:115]
  v_mfma_f32_4x4x4_16b_bf16 v[116:119], v[160:161], v[138:139], v[116:119]
  v_mfma_f32_32x32x16_bf16 v[48:63], v[136:139], a[32:35], v[48:63]
  ds_read_b64_tr_b16 v[128:129], v195 offset:4096
  ds_read_b64_tr_b16 v[130:131], v195 offset:4352
  buffer_load_dwordx4 v214, s[24:27], s58 offen offset:2048 lds
  s_waitcnt lgkmcnt(10)
  v_mfma_f32_4x4x4_16b_bf16 v[112:115], v[160:161], v[140:141], v[112:115]
  v_mfma_f32_4x4x4_16b_bf16 v[116:119], v[160:161], v[142:143], v[116:119]
  v_mfma_f32_32x32x16_bf16 v[48:63], v[140:143], a[48:51], v[48:63]
  ds_read_b64_tr_b16 v[132:133], v195 offset:8192
  ds_read_b64_tr_b16 v[134:135], v195 offset:8448
  buffer_load_dwordx4 v215, s[24:27], s58 offen offset:3072 lds
  s_waitcnt lgkmcnt(10)
  v_mfma_f32_4x4x4_16b_bf16 v[112:115], v[160:161], v[144:145], v[112:115]
  v_mfma_f32_4x4x4_16b_bf16 v[116:119], v[160:161], v[146:147], v[116:119]
  v_mfma_f32_32x32x16_bf16 v[48:63], v[144:147], a[64:67], v[48:63]
  ds_read_b64_tr_b16 v[136:137], v195 offset:12288
  ds_read_b64_tr_b16 v[138:139], v195 offset:12544
  s_add_u32 m0, s79, 4096
  s_add_u32 s58, s58, 28672
  buffer_load_dwordx4 v212, s[24:27], s58 offen lds
  s_waitcnt lgkmcnt(10)
  v_mfma_f32_4x4x4_16b_bf16 v[112:115], v[160:161], v[148:149], v[112:115]
  v_mfma_f32_4x4x4_16b_bf16 v[116:119], v[160:161], v[150:151], v[116:119]
  v_mfma_f32_32x32x16_bf16 v[48:63], v[148:151], a[80:83], v[48:63]
  ds_read_b64_tr_b16 v[140:141], v195 offset:16384
  ds_read_b64_tr_b16 v[142:143], v195 offset:16640
  buffer_load_dwordx4 v213, s[24:27], s58 offen offset:1024 lds
  s_waitcnt lgkmcnt(10)
  v_mfma_f32_4x4x4_16b_bf16 v[112:115], v[160:161], v[152:153], v[112:115]
  v_mfma_f32_4x4x4_16b_bf16 v[116:119], v[160:161], v[154:155], v[116:119]
  v_mfma_f32_32x32x16_bf16 v[48:63], v[152:155], a[96:99], v[48:63]
  ds_read_b64_tr_b16 v[144:145], v195 offset:20480
  ds_read_b64_tr_b16 v[146:147], v195 offset:20736
  buffer_load_dwordx4 v214, s[24:27], s58 offen offset:2048 lds
  s_waitcnt lgkmcnt(10)
  v_mfma_f32_32x32x16_bf16 v[48:63], v[156:159], a[4:7], v[48:63]
  ds_read_b64_tr_b16 v[148:149], v195 offset:24576
  ds_read_b64_tr_b16 v[150:151], v195 offset:24832
  buffer_load_dwordx4 v215, s[24:27], s58 offen offset:3072 lds
  s_waitcnt lgkmcnt(10)
  v_mfma_f32_32x32x16_bf16 v[48:63], v[128:131], a[20:23], v[48:63]
  ds_read_b64_tr_b16 v[152:153], v196 offset:0
  ds_read_b64_tr_b16 v[154:155], v196 offset:256
  s_add_u32 s3, s64, 4096
  s_add_u32 s54, s12, s3
  s_addc_u32 s55, s13, 0
  s_waitcnt lgkmcnt(10)
  v_mfma_f32_32x32x16_bf16 v[48:63], v[132:135], a[36:39], v[48:63]
  ds_read_b64_tr_b16 v[156:157], v196 offset:4096
  ds_read_b64_tr_b16 v[158:159], v196 offset:4352
  v_add_f32 v112, v112, v116
  ds_write_b32 v198, v112 offset:2048
  s_waitcnt lgkmcnt(11)
  v_mfma_f32_32x32x16_bf16 v[48:63], v[136:139], a[52:55], v[48:63]
  ds_read_b64_tr_b16 v[128:129], v196 offset:8192
  ds_read_b64_tr_b16 v[130:131], v196 offset:8448
  s_waitcnt lgkmcnt(11)
  v_mfma_f32_32x32x16_bf16 v[48:63], v[140:143], a[68:71], v[48:63]
  ds_read_b64_tr_b16 v[132:133], v196 offset:12288
  ds_read_b64_tr_b16 v[134:135], v196 offset:12544
  s_waitcnt lgkmcnt(11)
  v_mfma_f32_32x32x16_bf16 v[48:63], v[144:147], a[84:87], v[48:63]
  ds_read_b64_tr_b16 v[136:137], v196 offset:16384
  ds_read_b64_tr_b16 v[138:139], v196 offset:16640
  s_waitcnt lgkmcnt(11)
  v_mfma_f32_32x32x16_bf16 v[48:63], v[148:151], a[100:103], v[48:63]
  ds_read_b64_tr_b16 v[140:141], v196 offset:20480
  ds_read_b64_tr_b16 v[142:143], v196 offset:20736
  s_waitcnt lgkmcnt(8)
  s_barrier
  ds_read_b128 v[112:115], v199 offset:2048
  s_waitcnt lgkmcnt(12)
  v_mfma_f32_32x32x16_bf16 v[48:63], v[152:155], a[8:11], v[48:63]
  ds_read_b64_tr_b16 v[144:145], v196 offset:24576
  ds_read_b64_tr_b16 v[146:147], v196 offset:24832
  s_waitcnt lgkmcnt(12)
  v_mfma_f32_32x32x16_bf16 v[48:63], v[156:159], a[24:27], v[48:63]
  ds_read_b64_tr_b16 v[148:149], v197 offset:0
  ds_read_b64_tr_b16 v[150:151], v197 offset:256
  s_waitcnt lgkmcnt(11)
  v_mfma_f32_32x32x16_bf16 v[48:63], v[128:131], a[40:43], v[48:63]
  ds_read_b64_tr_b16 v[152:153], v197 offset:4096
  ds_read_b64_tr_b16 v[154:155], v197 offset:4352
  s_waitcnt lgkmcnt(11)
  v_mfma_f32_32x32x16_bf16 v[48:63], v[132:135], a[56:59], v[48:63]
  ds_read_b64_tr_b16 v[156:157], v197 offset:8192
  ds_read_b64_tr_b16 v[158:159], v197 offset:8448
  s_waitcnt lgkmcnt(8)
  v_add_f32 v2, v112, v113
  v_add_f32 v3, v114, v115
  v_add_f32 v2, v2, v3
  s_waitcnt lgkmcnt(11)
  v_mfma_f32_32x32x16_bf16 v[48:63], v[136:139], a[72:75], v[48:63]
  ds_read_b64_tr_b16 v[128:129], v197 offset:12288
  ds_read_b64_tr_b16 v[130:131], v197 offset:12544
  v_and_b32 v8, 0xffff0000, v2
  v_sub_f32 v8, v2, v8
  v_and_b32 v9, 0xffff0000, v8
  s_waitcnt lgkmcnt(11)
  v_mfma_f32_32x32x16_bf16 v[48:63], v[140:143], a[88:91], v[48:63]
  ds_read_b64_tr_b16 v[132:133], v197 offset:16384
  ds_read_b64_tr_b16 v[134:135], v197 offset:16640
  v_sub_f32 v9, v8, v9
  v_perm_b32 v164, v2, v2, s62
  v_perm_b32 v165, v8, v8, s62
  s_waitcnt lgkmcnt(10)
  v_mfma_f32_32x32x16_bf16 v[48:63], v[144:147], a[104:107], v[48:63]
  ds_read_b64_tr_b16 v[136:137], v197 offset:20480
  ds_read_b64_tr_b16 v[138:139], v197 offset:20736
  v_perm_b32 v166, v9, v2, s62
  v_mul_f32 v204, 0x3e8b97f6, v204
  s_waitcnt lgkmcnt(10)
  v_mfma_f32_32x32x16_bf16 v[48:63], v[148:151], a[12:15], v[48:63]
  ds_read_b64_tr_b16 v[140:141], v197 offset:24576
  ds_read_b64_tr_b16 v[142:143], v197 offset:24832
  s_waitcnt lgkmcnt(10)
  v_mfma_f32_32x32x16_bf16 v[48:63], v[152:155], a[28:31], v[48:63]
  s_waitcnt lgkmcnt(8)
  v_mfma_f32_32x32x16_bf16 v[48:63], v[156:159], a[44:47], v[48:63]
  s_waitcnt lgkmcnt(6)
  v_mfma_f32_32x32x16_bf16 v[48:63], v[128:131], a[60:63], v[48:63]
  buffer_load_dword v206, v207, s[12:15], 0 offen sc1
  s_waitcnt lgkmcnt(4)
  v_mfma_f32_32x32x16_bf16 v[48:63], v[132:135], a[76:79], v[48:63]
  s_waitcnt lgkmcnt(2)
  v_mfma_f32_32x32x16_bf16 v[48:63], v[136:139], a[92:95], v[48:63]
  s_waitcnt lgkmcnt(0)
  v_mfma_f32_32x32x16_bf16 v[48:63], v[140:143], a[108:111], v[48:63]
  v_mfma_f32_32x32x16_bf16 v[48:63], v[164:167], v[172:175], v[48:63]
  s_nop 11
  v_pk_mul_f32 v[48:49], v[48:49], v[204:205] op_sel_hi:[1,0]
  v_pk_mul_f32 v[50:51], v[50:51], v[204:205] op_sel_hi:[1,0]
  v_pk_mul_f32 v[52:53], v[52:53], v[204:205] op_sel_hi:[1,0]
  v_pk_mul_f32 v[54:55], v[54:55], v[204:205] op_sel_hi:[1,0]
  v_pk_mul_f32 v[56:57], v[56:57], v[204:205] op_sel_hi:[1,0]
  v_pk_mul_f32 v[58:59], v[58:59], v[204:205] op_sel_hi:[1,0]
  v_pk_mul_f32 v[60:61], v[60:61], v[204:205] op_sel_hi:[1,0]
  v_pk_mul_f32 v[62:63], v[62:63], v[204:205] op_sel_hi:[1,0]
  v_cvt_pk_bf16_f32 v40, v48, v49
  v_cvt_pk_bf16_f32 v41, v50, v51
  v_cvt_pk_bf16_f32 v42, v52, v53
  v_cvt_pk_bf16_f32 v43, v54, v55
  v_cvt_pk_bf16_f32 v44, v56, v57
  v_cvt_pk_bf16_f32 v45, v58, v59
  v_cvt_pk_bf16_f32 v46, v60, v61
  v_cvt_pk_bf16_f32 v47, v62, v63
  v_cndmask_b32 v46, v46, v175, s[74:75]
  v_cndmask_b32 v47, v47, v175, s[74:75]
  ds_write_b128 v210, v[40:43]
  ds_write_b128 v210, v[44:47] offset:1024
  s_cmp_eq_u32 s4, 0
  s_cselect_b32 s22, s14, 0
  s_waitcnt vmcnt(0) lgkmcnt(0)
  s_barrier
L_pad1:
  s_cbranch_execz L_tour0
  v_cmp_ne_u32 vcc, 1, v206
  ds_read_b128 v[16:19], v20
  ds_read_b128 v[20:23], v20 offset:1024
  ds_read_b128 v[24:27], v28
  ds_read_b128 v[28:31], v28 offset:1024
  ds_read_b128 v[32:35], v36
  ds_read_b128 v[36:39], v36 offset:1024
  s_cbranch_vccnz L_flw
L_flo:
  global_load_dwordx4 a[128:131], v7, s[54:55] offset:-4096 sc1
  global_load_dwordx4 a[132:135], v7, s[54:55] offset:-3072 sc1
  global_load_dwordx4 a[136:139], v7, s[54:55] offset:-2048 sc1
  global_load_dwordx4 a[140:143], v7, s[54:55] offset:-1024 sc1
  s_mov_b64 exec, 1
  buffer_store_dword v200, off, s[20:23], s73 offset:48 sc1
  s_mov_b64 exec, -1
  s_add_u32 s60, s28, s1
  s_addc_u32 s61, s29, 0
  global_load_dwordx4 a[144:147], v7, s[54:55] offset:0 sc1
  global_load_dwordx4 a[148:151], v7, s[54:55] offset:1024 sc1
  global_load_dwordx4 a[152:155], v7, s[54:55] offset:2048 sc1
  global_load_dwordx4 a[156:159], v7, s[54:55] offset:3072 sc1
  s_add_u32 s54, s54, 8192
  s_addc_u32 s55, s55, 0
  global_load_dwordx4 a[160:163], v7, s[54:55] offset:-4096 sc1
  global_load_dwordx4 a[164:167], v7, s[54:55] offset:-3072 sc1
  global_load_dwordx4 a[168:171], v7, s[54:55] offset:-2048 sc1
  global_load_dwordx4 a[172:175], v7, s[54:55] offset:-1024 sc1
  s_waitcnt vmcnt(9)
  v_accvgpr_read_b32 v2, a128
  v_accvgpr_read_b32 v3, a132
  v_accvgpr_read_b32 v4, a136
  v_accvgpr_read_b32 v10, a140
  v_max3_u32 v2, v2, v3, v4
  v_max_u32 v2, v2, v10
  v_cmp_eq_u32 vcc, -1, v2
  s_waitcnt lgkmcnt(0)
  s_nop 3
  s_cbranch_vccnz L_krt_2
L_kck_1:
  v_mfma_f32_32x32x16_bf16 v[112:127], a[128:131], v[16:19], 0
  v_mfma_f32_32x32x16_bf16 v[112:127], a[132:135], v[20:23], v[112:127]
  s_cmp_eq_u32 s30, 0
  s_cbranch_scc1 L_idle
  v_mfma_f32_32x32x16_bf16 v[128:143], a[128:131], v[24:27], 0
  global_load_dwordx4 a[176:179], v7, s[54:55] offset:0 sc1
  s_nop 7
  v_exp_f32 v112, v112
  v_exp_f32 v113, v113
  v_exp_f32 v114, v114
  v_exp_f32 v115, v115
  v_cvt_pk_bf16_f32 v144, v112, v113
  v_cvt_pk_bf16_f32 v145, v114, v115
  v_exp_f32 v116, v116
  v_exp_f32 v117, v117
  v_exp_f32 v118, v118
  v_exp_f32 v119, v119
  v_cvt_pk_bf16_f32 v146, v116, v117
  v_cvt_pk_bf16_f32 v147, v118, v119
  v_mfma_f32_32x32x16_bf16 v[128:143], a[132:135], v[28:31], v[128:143]
  global_load_dwordx4 a[180:183], v7, s[54:55] offset:1024 sc1
  v_exp_f32 v120, v120
  v_exp_f32 v121, v121
  v_exp_f32 v122, v122
  v_exp_f32 v123, v123
  v_cvt_pk_bf16_f32 v148, v120, v121
  v_cvt_pk_bf16_f32 v149, v122, v123
  v_mfma_f32_32x32x16_bf16 v[48:63], a[136:139], v[144:147], 0
  v_exp_f32 v124, v124
  v_exp_f32 v125, v125
  v_exp_f32 v126, v126
  v_exp_f32 v127, v127
  v_cvt_pk_bf16_f32 v150, v124, v125
  v_cvt_pk_bf16_f32 v151, v126, v127
  v_mfma_f32_32x32x16_bf16 v[112:127], a[128:131], v[32:35], 0
  global_load_dwordx4 a[184:187], v7, s[54:55] offset:2048 sc1
  v_exp_f32 v128, v128
  v_exp_f32 v129, v129
  v_exp_f32 v130, v130
  v_exp_f32 v131, v131
  v_cvt_pk_bf16_f32 v144, v128, v129
  v_cvt_pk_bf16_f32 v145, v130, v131
  v_mfma_f32_32x32x16_bf16 v[48:63], a[140:143], v[148:151], v[48:63]
  v_exp_f32 v132, v132
  v_exp_f32 v133, v133
  v_exp_f32 v134, v134
  v_exp_f32 v135, v135
  v_cvt_pk_bf16_f32 v146, v132, v133
  v_cvt_pk_bf16_f32 v147, v134, v135
  v_mfma_f32_32x32x16_bf16 v[112:127], a[132:135], v[36:39], v[112:127]
  global_load_dwordx4 a[188:191], v7, s[54:55] offset:3072 sc1
  v_exp_f32 v136, v136
  v_exp_f32 v137, v137
  v_exp_f32 v138, v138
  v_exp_f32 v139, v139
  v_cvt_pk_bf16_f32 v148, v136, v137
  v_cvt_pk_bf16_f32 v149, v138, v139
  v_mfma_f32_32x32x16_bf16 v[64:79], a[136:139], v[144:147], 0
  v_exp_f32 v140, v140
  v_exp_f32 v141, v141
  v_exp_f32 v142, v142
  v_exp_f32 v143, v143
  v_cvt_pk_bf16_f32 v150, v140, v141
  v_cvt_pk_bf16_f32 v151, v142, v143
  v_mfma_f32_32x32x16_bf16 v[128:143], a[128:131], v[40:43], 0
  s_add_u32 m0, s79, 8192
  s_add_u32 s58, s58, 28672
  buffer_load_dwordx4 v212, s[24:27], s58 offen lds
  v_exp_f32 v112, v112
  v_exp_f32 v113, v113
  v_exp_f32 v114, v114
  v_exp_f32 v115, v115
  v_cvt_pk_bf16_f32 v144, v112, v113
  v_cvt_pk_bf16_f32 v145, v114, v115
  v_mfma_f32_32x32x16_bf16 v[64:79], a[140:143], v[148:151], v[64:79]
  s_waitcnt vmcnt(9)
  v_accvgpr_read_b32 v2, a144
  v_accvgpr_read_b32 v3, a148
  v_accvgpr_read_b32 v4, a152
  v_accvgpr_read_b32 v10, a156
  v_max3_u32 v2, v2, v3, v4
  v_max_u32 v2, v2, v10
  v_cmp_eq_u32 vcc, -1, v2
  v_exp_f32 v116, v116
  v_exp_f32 v117, v117
  v_exp_f32 v118, v118
  v_exp_f32 v119, v119
  v_cvt_pk_bf16_f32 v146, v116, v117
  v_cvt_pk_bf16_f32 v147, v118, v119
  v_mfma_f32_32x32x16_bf16 v[128:143], a[132:135], v[44:47], v[128:143]
  buffer_load_dwordx4 v213, s[24:27], s58 offen offset:1024 lds
  v_exp_f32 v120, v120
  v_exp_f32 v121, v121
  v_exp_f32 v122, v122
  v_exp_f32 v123, v123
  v_cvt_pk_bf16_f32 v148, v120, v121
  v_cvt_pk_bf16_f32 v149, v122, v123
  v_mfma_f32_32x32x16_bf16 v[80:95], a[136:139], v[144:147], 0
  s_cbranch_vccnz L_krt_14
L_kck_13:
  v_exp_f32 v124, v124
  v_exp_f32 v125, v125
  v_exp_f32 v126, v126
  v_exp_f32 v127, v127
  v_cvt_pk_bf16_f32 v150, v124, v125
  v_cvt_pk_bf16_f32 v151, v126, v127
  v_mfma_f32_32x32x16_bf16 v[112:127], a[144:147], v[16:19], 0
  buffer_load_dwordx4 v214, s[24:27], s58 offen offset:2048 lds
  v_exp_f32 v128, v128
  v_exp_f32 v129, v129
  v_exp_f32 v130, v130
  v_exp_f32 v131, v131
  v_cvt_pk_bf16_f32 v144, v128, v129
  v_cvt_pk_bf16_f32 v145, v130, v131
  v_mfma_f32_32x32x16_bf16 v[80:95], a[140:143], v[148:151], v[80:95]
  v_exp_f32 v132, v132
  v_exp_f32 v133, v133
  v_exp_f32 v134, v134
  v_exp_f32 v135, v135
  v_cvt_pk_bf16_f32 v146, v132, v133
  v_cvt_pk_bf16_f32 v147, v134, v135
  v_mfma_f32_32x32x16_bf16 v[112:127], a[148:151], v[20:23], v[112:127]
  buffer_load_dwordx4 v215, s[24:27], s58 offen offset:3072 lds
  v_exp_f32 v136, v136
  v_exp_f32 v137, v137
  v_exp_f32 v138, v138
  v_exp_f32 v139, v139
  v_cvt_pk_bf16_f32 v148, v136, v137
  v_cvt_pk_bf16_f32 v149, v138, v139
  v_mfma_f32_32x32x16_bf16 v[96:111], a[136:139], v[144:147], 0
  v_exp_f32 v140, v140
  v_exp_f32 v141, v141
  v_exp_f32 v142, v142
  v_exp_f32 v143, v143
  v_cvt_pk_bf16_f32 v150, v140, v141
  v_cvt_pk_bf16_f32 v151, v142, v143
  v_mfma_f32_32x32x16_bf16 v[128:143], a[144:147], v[24:27], 0
  s_add_u32 m0, s79, 12288
  s_add_u32 s58, s58, 28672
  buffer_load_dwordx4 v212, s[24:27], s58 offen lds
  v_exp_f32 v112, v112
  v_exp_f32 v113, v113
  v_exp_f32 v114, v114
  v_exp_f32 v115, v115
  v_cvt_pk_bf16_f32 v144, v112, v113
  v_cvt_pk_bf16_f32 v145, v114, v115
  v_mfma_f32_32x32x16_bf16 v[96:111], a[140:143], v[148:151], v[96:111]
  v_exp_f32 v116, v116
  v_exp_f32 v117, v117
  v_exp_f32 v118, v118
  v_exp_f32 v119, v119
  v_cvt_pk_bf16_f32 v146, v116, v117
  v_cvt_pk_bf16_f32 v147, v118, v119
  v_mfma_f32_32x32x16_bf16 v[128:143], a[148:151], v[28:31], v[128:143]
  buffer_load_dwordx4 v213, s[24:27], s58 offen offset:1024 lds
  v_exp_f32 v120, v120
  v_exp_f32 v121, v121
  v_exp_f32 v122, v122
  v_exp_f32 v123, v123
  v_cvt_pk_bf16_f32 v148, v120, v121
  v_cvt_pk_bf16_f32 v149, v122, v123
  v_mfma_f32_32x32x16_bf16 v[48:63], a[152:155], v[144:147], v[48:63]
  v_exp_f32 v124, v124
  v_exp_f32 v125, v125
  v_exp_f32 v126, v126
  v_exp_f32 v127, v127
  v_cvt_pk_bf16_f32 v150, v124, v125
  v_cvt_pk_bf16_f32 v151, v126, v127
  v_mfma_f32_32x32x16_bf16 v[112:127], a[144:147], v[32:35], 0
  buffer_load_dwordx4 v214, s[24:27], s58 offen offset:2048 lds
  v_exp_f32 v128, v128
  v_exp_f32 v129, v129
  v_exp_f32 v130, v130
  v_exp_f32 v131, v131
  v_cvt_pk_bf16_f32 v144, v128, v129
  v_cvt_pk_bf16_f32 v145, v130, v131
  v_mfma_f32_32x32x16_bf16 v[48:63], a[156:159], v[148:151], v[48:63]
  buffer_load_dword v11, v253, s[12:15], 0 offen offset:48 sc1
  v_exp_f32 v132, v132
  v_exp_f32 v133, v133
  v_exp_f32 v134, v134
  v_exp_f32 v135, v135
  v_cvt_pk_bf16_f32 v146, v132, v133
  v_cvt_pk_bf16_f32 v147, v134, v135
  v_mfma_f32_32x32x16_bf16 v[112:127], a[148:151], v[36:39], v[112:127]
  s_mov_b64 exec, 63
  buffer_store_dword v224, v230, s[20:23], 0 offen sc1
  s_mov_b64 exec, -1
  v_exp_f32 v136, v136
  v_exp_f32 v137, v137
  v_exp_f32 v138, v138
  v_exp_f32 v139, v139
  v_cvt_pk_bf16_f32 v148, v136, v137
  v_cvt_pk_bf16_f32 v149, v138, v139
  v_mfma_f32_32x32x16_bf16 v[64:79], a[152:155], v[144:147], v[64:79]
  v_exp_f32 v140, v140
  v_exp_f32 v141, v141
  v_exp_f32 v142, v142
  v_exp_f32 v143, v143
  v_cvt_pk_bf16_f32 v150, v140, v141
  v_cvt_pk_bf16_f32 v151, v142, v143
  v_mfma_f32_32x32x16_bf16 v[128:143], a[144:147], v[40:43], 0
  buffer_store_dwordx4 v[224:227], v7, s[12:15], s97 offen sc1
  v_exp_f32 v112, v112
  v_exp_f32 v113, v113
  v_exp_f32 v114, v114
  v_exp_f32 v115, v115
  v_cvt_pk_bf16_f32 v144, v112, v113
  v_cvt_pk_bf16_f32 v145, v114, v115
  v_mfma_f32_32x32x16_bf16 v[64:79], a[156:159], v[148:151], v[64:79]
  s_waitcnt vmcnt(14)
  v_accvgpr_read_b32 v2, a160
  v_accvgpr_read_b32 v3, a164
  v_accvgpr_read_b32 v4, a168
  v_accvgpr_read_b32 v10, a172
  v_max3_u32 v2, v2, v3, v4
  v_max_u32 v2, v2, v10
  v_cmp_eq_u32 vcc, -1, v2
  v_exp_f32 v116, v116
  v_exp_f32 v117, v117
  v_exp_f32 v118, v118
  v_exp_f32 v119, v119
  v_cvt_pk_bf16_f32 v146, v116, v117
  v_cvt_pk_bf16_f32 v147, v118, v119
  v_mfma_f32_32x32x16_bf16 v[128:143], a[148:151], v[44:47], v[128:143]
  buffer_store_dwordx4 v[224:227], v7, s[12:15], s97 offen offset:1024 sc1
  v_exp_f32 v120, v120
  v_exp_f32 v121, v121
  v_exp_f32 v122, v122
  v_exp_f32 v123, v123
  v_cvt_pk_bf16_f32 v148, v120, v121
  v_cvt_pk_bf16_f32 v149, v122, v123
  v_mfma_f32_32x32x16_bf16 v[80:95], a[152:155], v[144:147], v[80:95]
  s_cbranch_vccnz L_krt_16
L_kck_15:
  v_exp_f32 v124, v124
  v_exp_f32 v125, v125
  v_exp_f32 v126, v126
  v_exp_f32 v127, v127
  v_cvt_pk_bf16_f32 v150, v124, v125
  v_cvt_pk_bf16_f32 v151, v126, v127
  v_mfma_f32_32x32x16_bf16 v[112:127], a[160:163], v[16:19], 0
  buffer_store_dword v224, v228, s[80:83], s98 offen sc1
  v_exp_f32 v128, v128
  v_exp_f32 v129, v129
  v_exp_f32 v130, v130
  v_exp_f32 v131, v131
  v_cvt_pk_bf16_f32 v144, v128, v129
  v_cvt_pk_bf16_f32 v145, v130, v131
  v_mfma_f32_32x32x16_bf16 v[80:95], a[156:159], v[148:151], v[80:95]
  s_waitcnt vmcnt(4)
  v_cmp_ne_u32 vcc, 1, v11
  v_exp_f32 v132, v132
  v_exp_f32 v133, v133
  v_exp_f32 v134, v134
  v_exp_f32 v135, v135
  v_cvt_pk_bf16_f32 v146, v132, v133
  v_cvt_pk_bf16_f32 v147, v134, v135
  v_mfma_f32_32x32x16_bf16 v[112:127], a[164:167], v[20:23], v[112:127]
  buffer_store_dwordx4 v[224:227], v14, s[80:83], s99 offen sc1
  v_exp_f32 v136, v136
  v_exp_f32 v137, v137
  v_exp_f32 v138, v138
  v_exp_f32 v139, v139
  v_cvt_pk_bf16_f32 v148, v136, v137
  v_cvt_pk_bf16_f32 v149, v138, v139
  v_mfma_f32_32x32x16_bf16 v[96:111], a[152:155], v[144:147], v[96:111]
  s_cbranch_vccnz L_f2r_18
L_f2_17:
  s_add_u32 s54, s54, 8192
  s_addc_u32 s55, s55, 0
  v_exp_f32 v140, v140
  v_exp_f32 v141, v141
  v_exp_f32 v142, v142
  v_exp_f32 v143, v143
  v_cvt_pk_bf16_f32 v150, v140, v141
  v_cvt_pk_bf16_f32 v151, v142, v143
  v_mfma_f32_32x32x16_bf16 v[128:143], a[160:163], v[24:27], 0
  global_load_dwordx4 a[0:3], v7, s[54:55] offset:-4096 sc1
  v_exp_f32 v112, v112
  v_exp_f32 v113, v113
  v_exp_f32 v114, v114
  v_exp_f32 v115, v115
  v_cvt_pk_bf16_f32 v144, v112, v113
  v_cvt_pk_bf16_f32 v145, v114, v115
  v_mfma_f32_32x32x16_bf16 v[96:111], a[156:159], v[148:151], v[96:111]
  v_exp_f32 v116, v116
  v_exp_f32 v117, v117
  v_exp_f32 v118, v118
  v_exp_f32 v119, v119
  v_cvt_pk_bf16_f32 v146, v116, v117
  v_cvt_pk_bf16_f32 v147, v118, v119
  v_mfma_f32_32x32x16_bf16 v[128:143], a[164:167], v[28:31], v[128:143]
  global_load_dwordx4 a[4:7], v7, s[54:55] offset:-3072 sc1
  v_exp_f32 v120, v120
  v_exp_f32 v121, v121
  v_exp_f32 v122, v122
  v_exp_f32 v123, v123
  v_cvt_pk_bf16_f32 v148, v120, v121
  v_cvt_pk_bf16_f32 v149, v122, v123
  v_mfma_f32_32x32x16_bf16 v[48:63], a[168:171], v[144:147], v[48:63]
  v_exp_f32 v124, v124
  v_exp_f32 v125, v125
  v_exp_f32 v126, v126
  v_exp_f32 v127, v127
  v_cvt_pk_bf16_f32 v150, v124, v125
  v_cvt_pk_bf16_f32 v151, v126, v127
  v_mfma_f32_32x32x16_bf16 v[112:127], a[160:163], v[32:35], 0
  global_load_dwordx4 a[8:11], v7, s[54:55] offset:-2048 sc1
  v_exp_f32 v128, v128
  v_exp_f32 v129, v129
  v_exp_f32 v130, v130
  v_exp_f32 v131, v131
  v_cvt_pk_bf16_f32 v144, v128, v129
  v_cvt_pk_bf16_f32 v145, v130, v131
  v_mfma_f32_32x32x16_bf16 v[48:63], a[172:175], v[148:151], v[48:63]
  v_exp_f32 v132, v132
  v_exp_f32 v133, v133
  v_exp_f32 v134, v134
  v_exp_f32 v135, v135
  v_cvt_pk_bf16_f32 v146, v132, v133
  v_cvt_pk_bf16_f32 v147, v134, v135
  v_mfma_f32_32x32x16_bf16 v[112:127], a[164:167], v[36:39], v[112:127]
  global_load_dwordx4 a[12:15], v7, s[54:55] offset:-1024 sc1
  v_exp_f32 v136, v136
  v_exp_f32 v137, v137
  v_exp_f32 v138, v138
  v_exp_f32 v139, v139
  v_cvt_pk_bf16_f32 v148, v136, v137
  v_cvt_pk_bf16_f32 v149, v138, v139
  v_mfma_f32_32x32x16_bf16 v[64:79], a[168:171], v[144:147], v[64:79]
  v_exp_f32 v140, v140
  v_exp_f32 v141, v141
  v_exp_f32 v142, v142
  v_exp_f32 v143, v143
  v_cvt_pk_bf16_f32 v150, v140, v141
  v_cvt_pk_bf16_f32 v151, v142, v143
  v_mfma_f32_32x32x16_bf16 v[128:143], a[160:163], v[40:43], 0
  global_load_dwordx4 a[16:19], v7, s[54:55] offset:0 sc1
  v_exp_f32 v112, v112
  v_exp_f32 v113, v113
  v_exp_f32 v114, v114
  v_exp_f32 v115, v115
  v_cvt_pk_bf16_f32 v144, v112, v113
  v_cvt_pk_bf16_f32 v145, v114, v115
  v_mfma_f32_32x32x16_bf16 v[64:79], a[172:175], v[148:151], v[64:79]
  v_accvgpr_read_b32 v2, a176
  v_accvgpr_read_b32 v3, a180
  v_accvgpr_read_b32 v4, a184
  v_accvgpr_read_b32 v10, a188
  v_max3_u32 v2, v2, v3, v4
  v_max_u32 v2, v2, v10
  v_cmp_eq_u32 vcc, -1, v2
  v_exp_f32 v116, v116
  v_exp_f32 v117, v117
  v_exp_f32 v118, v118
  v_exp_f32 v119, v119
  v_cvt_pk_bf16_f32 v146, v116, v117
  v_cvt_pk_bf16_f32 v147, v118, v119
  v_mfma_f32_32x32x16_bf16 v[128:143], a[164:167], v[44:47], v[128:143]
  global_load_dwordx4 a[20:23], v7, s[54:55] offset:1024 sc1
  v_exp_f32 v120, v120
  v_exp_f32 v121, v121
  v_exp_f32 v122, v122
  v_exp_f32 v123, v123
  v_cvt_pk_bf16_f32 v148, v120, v121
  v_cvt_pk_bf16_f32 v149, v122, v123
  v_mfma_f32_32x32x16_bf16 v[80:95], a[168:171], v[144:147], v[80:95]
  s_cbranch_vccnz L_krt_20
L_kck_19:
  v_exp_f32 v124, v124
  v_exp_f32 v125, v125
  v_exp_f32 v126, v126
  v_exp_f32 v127, v127
  v_cvt_pk_bf16_f32 v150, v124, v125
  v_cvt_pk_bf16_f32 v151, v126, v127
  v_mfma_f32_32x32x16_bf16 v[112:127], a[176:179], v[16:19], 0
  buffer_store_dwordx4 v[224:227], v14, s[80:83], s99 offen offset:1024 sc1
  v_exp_f32 v128, v128
  v_exp_f32 v129, v129
  v_exp_f32 v130, v130
  v_exp_f32 v131, v131
  v_cvt_pk_bf16_f32 v144, v128, v129
  v_cvt_pk_bf16_f32 v145, v130, v131
  v_mfma_f32_32x32x16_bf16 v[80:95], a[172:175], v[148:151], v[80:95]
  v_exp_f32 v132, v132
  v_exp_f32 v133, v133
  v_exp_f32 v134, v134
  v_exp_f32 v135, v135
  v_cvt_pk_bf16_f32 v146, v132, v133
  v_cvt_pk_bf16_f32 v147, v134, v135
  v_mfma_f32_32x32x16_bf16 v[112:127], a[180:183], v[20:23], v[112:127]
  global_load_dwordx4 a[24:27], v7, s[54:55] offset:2048 sc1
  v_exp_f32 v136, v136
  v_exp_f32 v137, v137
  v_exp_f32 v138, v138
  v_exp_f32 v139, v139
  v_cvt_pk_bf16_f32 v148, v136, v137
  v_cvt_pk_bf16_f32 v149, v138, v139
  v_mfma_f32_32x32x16_bf16 v[96:111], a[168:171], v[144:147], v[96:111]
  v_exp_f32 v140, v140
  v_exp_f32 v141, v141
  v_exp_f32 v142, v142
  v_exp_f32 v143, v143
  v_cvt_pk_bf16_f32 v150, v140, v141
  v_cvt_pk_bf16_f32 v151, v142, v143
  v_mfma_f32_32x32x16_bf16 v[128:143], a[176:179], v[24:27], 0
  global_load_dwordx4 a[28:31], v7, s[54:55] offset:3072 sc1
  v_exp_f32 v112, v112
  v_exp_f32 v113, v113
  v_exp_f32 v114, v114
  v_exp_f32 v115, v115
  v_cvt_pk_bf16_f32 v144, v112, v113
  v_cvt_pk_bf16_f32 v145, v114, v115
  v_mfma_f32_32x32x16_bf16 v[96:111], a[172:175], v[148:151], v[96:111]
  v_exp_f32 v116, v116
  v_exp_f32 v117, v117
  v_exp_f32 v118, v118
  v_exp_f32 v119, v119
  v_cvt_pk_bf16_f32 v146, v116, v117
  v_cvt_pk_bf16_f32 v147, v118, v119
  v_mfma_f32_32x32x16_bf16 v[128:143], a[180:183], v[28:31], v[128:143]
  buffer_store_dwordx4 v[224:227], v7, s[84:87], s100 offen sc1
  v_exp_f32 v120, v120
  v_exp_f32 v121, v121
  v_exp_f32 v122, v122
  v_exp_f32 v123, v123
  v_cvt_pk_bf16_f32 v148, v120, v121
  v_cvt_pk_bf16_f32 v149, v122, v123
  v_mfma_f32_32x32x16_bf16 v[48:63], a[184:187], v[144:147], v[48:63]
  s_add_u32 s54, s54, 8192
  s_addc_u32 s55, s55, 0
  v_exp_f32 v124, v124
  v_exp_f32 v125, v125
  v_exp_f32 v126, v126
  v_exp_f32 v127, v127
  v_cvt_pk_bf16_f32 v150, v124, v125
  v_cvt_pk_bf16_f32 v151, v126, v127
  v_mfma_f32_32x32x16_bf16 v[112:127], a[176:179], v[32:35], 0
  global_load_dwordx4 a[32:35], v7, s[54:55] offset:-4096 sc1
  v_exp_f32 v128, v128
  v_exp_f32 v129, v129
  v_exp_f32 v130, v130
  v_exp_f32 v131, v131
  v_cvt_pk_bf16_f32 v144, v128, v129
  v_cvt_pk_bf16_f32 v145, v130, v131
  v_mfma_f32_32x32x16_bf16 v[48:63], a[188:191], v[148:151], v[48:63]
  v_exp_f32 v132, v132
  v_exp_f32 v133, v133
  v_exp_f32 v134, v134
  v_exp_f32 v135, v135
  v_cvt_pk_bf16_f32 v146, v132, v133
  v_cvt_pk_bf16_f32 v147, v134, v135
  v_mfma_f32_32x32x16_bf16 v[112:127], a[180:183], v[36:39], v[112:127]
  global_load_dwordx4 a[36:39], v7, s[54:55] offset:-3072 sc1
  v_exp_f32 v136, v136
  v_exp_f32 v137, v137
  v_exp_f32 v138, v138
  v_exp_f32 v139, v139
  v_cvt_pk_bf16_f32 v148, v136, v137
  v_cvt_pk_bf16_f32 v149, v138, v139
  v_mfma_f32_32x32x16_bf16 v[64:79], a[184:187], v[144:147], v[64:79]
  v_exp_f32 v140, v140
  v_exp_f32 v141, v141
  v_exp_f32 v142, v142
  v_exp_f32 v143, v143
  v_cvt_pk_bf16_f32 v150, v140, v141
  v_cvt_pk_bf16_f32 v151, v142, v143
  v_mfma_f32_32x32x16_bf16 v[128:143], a[176:179], v[40:43], 0
  buffer_store_dwordx4 v[224:227], v7, s[84:87], s78 offen sc1
  v_exp_f32 v112, v112
  v_exp_f32 v113, v113
  v_exp_f32 v114, v114
  v_exp_f32 v115, v115
  v_cvt_pk_bf16_f32 v144, v112, v113
  v_cvt_pk_bf16_f32 v145, v114, v115
  v_mfma_f32_32x32x16_bf16 v[64:79], a[188:191], v[148:151], v[64:79]
  v_exp_f32 v116, v116
  v_exp_f32 v117, v117
  v_exp_f32 v118, v118
  v_exp_f32 v119, v119
  v_cvt_pk_bf16_f32 v146, v116, v117
  v_cvt_pk_bf16_f32 v147, v118, v119
  v_mfma_f32_32x32x16_bf16 v[128:143], a[180:183], v[44:47], v[128:143]
  global_load_dwordx4 a[40:43], v7, s[54:55] offset:-2048 sc1
  v_exp_f32 v120, v120
  v_exp_f32 v121, v121
  v_exp_f32 v122, v122
  v_exp_f32 v123, v123
  v_cvt_pk_bf16_f32 v148, v120, v121
  v_cvt_pk_bf16_f32 v149, v122, v123
  v_mfma_f32_32x32x16_bf16 v[80:95], a[184:187], v[144:147], v[80:95]
  s_waitcnt vmcnt(10)
  v_exp_f32 v124, v124
  v_exp_f32 v125, v125
  v_exp_f32 v126, v126
  v_exp_f32 v127, v127
  v_cvt_pk_bf16_f32 v150, v124, v125
  v_cvt_pk_bf16_f32 v151, v126, v127
  v_mfma_f32_32x32x16_bf16 v[112:127], a[0:3], v[16:19], 0
  global_load_dwordx4 a[44:47], v7, s[54:55] offset:-1024 sc1
  v_exp_f32 v128, v128
  v_exp_f32 v129, v129
  v_exp_f32 v130, v130
  v_exp_f32 v131, v131
  v_cvt_pk_bf16_f32 v144, v128, v129
  v_cvt_pk_bf16_f32 v145, v130, v131
  v_mfma_f32_32x32x16_bf16 v[80:95], a[188:191], v[148:151], v[80:95]
  v_exp_f32 v132, v132
  v_exp_f32 v133, v133
  v_exp_f32 v134, v134
  v_exp_f32 v135, v135
  v_cvt_pk_bf16_f32 v146, v132, v133
  v_cvt_pk_bf16_f32 v147, v134, v135
  v_mfma_f32_32x32x16_bf16 v[112:127], a[4:7], v[20:23], v[112:127]
  buffer_load_dwordx4 v[240:243], v244, s[16:19], s65 offen offset:0
  v_exp_f32 v136, v136
  v_exp_f32 v137, v137
  v_exp_f32 v138, v138
  v_exp_f32 v139, v139
  v_cvt_pk_bf16_f32 v148, v136, v137
  v_cvt_pk_bf16_f32 v149, v138, v139
  v_mfma_f32_32x32x16_bf16 v[96:111], a[184:187], v[144:147], v[96:111]
  v_exp_f32 v140, v140
  v_exp_f32 v141, v141
  v_exp_f32 v142, v142
  v_exp_f32 v143, v143
  v_cvt_pk_bf16_f32 v150, v140, v141
  v_cvt_pk_bf16_f32 v151, v142, v143
  v_mfma_f32_32x32x16_bf16 v[128:143], a[0:3], v[24:27], 0
  global_load_dwordx4 a[48:51], v7, s[54:55] offset:0 sc1
  v_exp_f32 v112, v112
  v_exp_f32 v113, v113
  v_exp_f32 v114, v114
  v_exp_f32 v115, v115
  v_cvt_pk_bf16_f32 v144, v112, v113
  v_cvt_pk_bf16_f32 v145, v114, v115
  v_mfma_f32_32x32x16_bf16 v[96:111], a[188:191], v[148:151], v[96:111]
  v_exp_f32 v116, v116
  v_exp_f32 v117, v117
  v_exp_f32 v118, v118
  v_exp_f32 v119, v119
  v_cvt_pk_bf16_f32 v146, v116, v117
  v_cvt_pk_bf16_f32 v147, v118, v119
  v_mfma_f32_32x32x16_bf16 v[128:143], a[4:7], v[28:31], v[128:143]
  global_load_dwordx4 a[52:55], v7, s[54:55] offset:1024 sc1
  v_exp_f32 v120, v120
  v_exp_f32 v121, v121
  v_exp_f32 v122, v122
  v_exp_f32 v123, v123
  v_cvt_pk_bf16_f32 v148, v120, v121
  v_cvt_pk_bf16_f32 v149, v122, v123
  v_mfma_f32_32x32x16_bf16 v[48:63], a[8:11], v[144:147], v[48:63]
  v_exp_f32 v124, v124
  v_exp_f32 v125, v125
  v_exp_f32 v126, v126
  v_exp_f32 v127, v127
  v_cvt_pk_bf16_f32 v150, v124, v125
  v_cvt_pk_bf16_f32 v151, v126, v127
  v_mfma_f32_32x32x16_bf16 v[112:127], a[0:3], v[32:35], 0
  buffer_load_dwordx4 v[244:247], v244, s[16:19], s65 offen offset:64
  v_exp_f32 v128, v128
  v_exp_f32 v129, v129
  v_exp_f32 v130, v130
  v_exp_f32 v131, v131
  v_cvt_pk_bf16_f32 v144, v128, v129
  v_cvt_pk_bf16_f32 v145, v130, v131
  v_mfma_f32_32x32x16_bf16 v[48:63], a[12:15], v[148:151], v[48:63]
  v_exp_f32 v132, v132
  v_exp_f32 v133, v133
  v_exp_f32 v134, v134
  v_exp_f32 v135, v135
  v_cvt_pk_bf16_f32 v146, v132, v133
  v_cvt_pk_bf16_f32 v147, v134, v135
  v_mfma_f32_32x32x16_bf16 v[112:127], a[4:7], v[36:39], v[112:127]
  global_load_dwordx4 a[56:59], v7, s[54:55] offset:2048 sc1
  v_exp_f32 v136, v136
  v_exp_f32 v137, v137
  v_exp_f32 v138, v138
  v_exp_f32 v139, v139
  v_cvt_pk_bf16_f32 v148, v136, v137
  v_cvt_pk_bf16_f32 v149, v138, v139
  v_mfma_f32_32x32x16_bf16 v[64:79], a[8:11], v[144:147], v[64:79]
  v_exp_f32 v140, v140
  v_exp_f32 v141, v141
  v_exp_f32 v142, v142
  v_exp_f32 v143, v143
  v_cvt_pk_bf16_f32 v150, v140, v141
  v_cvt_pk_bf16_f32 v151, v142, v143
  v_mfma_f32_32x32x16_bf16 v[128:143], a[0:3], v[40:43], 0
  global_load_dwordx4 a[60:63], v7, s[54:55] offset:3072 sc1
  v_exp_f32 v112, v112
  v_exp_f32 v113, v113
  v_exp_f32 v114, v114
  v_exp_f32 v115, v115
  v_cvt_pk_bf16_f32 v144, v112, v113
  v_cvt_pk_bf16_f32 v145, v114, v115
  v_mfma_f32_32x32x16_bf16 v[64:79], a[12:15], v[148:151], v[64:79]
  buffer_load_dwordx2 v[248:249], v250, s[36:39], s66 offen offset:0
  v_exp_f32 v116, v116
  v_exp_f32 v117, v117
  v_exp_f32 v118, v118
  v_exp_f32 v119, v119
  v_cvt_pk_bf16_f32 v146, v116, v117
  v_cvt_pk_bf16_f32 v147, v118, v119
  v_mfma_f32_32x32x16_bf16 v[128:143], a[4:7], v[44:47], v[128:143]
  s_add_u32 s54, s54, 8192
  s_addc_u32 s55, s55, 0
  global_load_dwordx4 a[64:67], v7, s[54:55] offset:-4096 sc1
  v_exp_f32 v120, v120
  v_exp_f32 v121, v121
  v_exp_f32 v122, v122
  v_exp_f32 v123, v123
  v_cvt_pk_bf16_f32 v148, v120, v121
  v_cvt_pk_bf16_f32 v149, v122, v123
  v_mfma_f32_32x32x16_bf16 v[80:95], a[8:11], v[144:147], v[80:95]
  s_waitcnt vmcnt(14)
  v_exp_f32 v124, v124
  v_exp_f32 v125, v125
  v_exp_f32 v126, v126
  v_exp_f32 v127, v127
  v_cvt_pk_bf16_f32 v150, v124, v125
  v_cvt_pk_bf16_f32 v151, v126, v127
  v_mfma_f32_32x32x16_bf16 v[112:127], a[16:19], v[16:19], 0
  global_load_dwordx4 a[68:71], v7, s[54:55] offset:-3072 sc1
  v_exp_f32 v128, v128
  v_exp_f32 v129, v129
  v_exp_f32 v130, v130
  v_exp_f32 v131, v131
  v_cvt_pk_bf16_f32 v144, v128, v129
  v_cvt_pk_bf16_f32 v145, v130, v131
  v_mfma_f32_32x32x16_bf16 v[80:95], a[12:15], v[148:151], v[80:95]
  buffer_load_dwordx2 v[250:251], v250, s[36:39], s66 offen offset:16
  v_exp_f32 v132, v132
  v_exp_f32 v133, v133
  v_exp_f32 v134, v134
  v_exp_f32 v135, v135
  v_cvt_pk_bf16_f32 v146, v132, v133
  v_cvt_pk_bf16_f32 v147, v134, v135
  v_mfma_f32_32x32x16_bf16 v[112:127], a[20:23], v[20:23], v[112:127]
  global_load_dwordx4 a[72:75], v7, s[54:55] offset:-2048 sc1
  v_exp_f32 v136, v136
  v_exp_f32 v137, v137
  v_exp_f32 v138, v138
  v_exp_f32 v139, v139
  v_cvt_pk_bf16_f32 v148, v136, v137
  v_cvt_pk_bf16_f32 v149, v138, v139
  v_mfma_f32_32x32x16_bf16 v[96:111], a[8:11], v[144:147], v[96:111]
  v_exp_f32 v140, v140
  v_exp_f32 v141, v141
  v_exp_f32 v142, v142
  v_exp_f32 v143, v143
  v_cvt_pk_bf16_f32 v150, v140, v141
  v_cvt_pk_bf16_f32 v151, v142, v143
  v_mfma_f32_32x32x16_bf16 v[128:143], a[16:19], v[24:27], 0
  global_load_dwordx4 a[76:79], v7, s[54:55] offset:-1024 sc1
L_pad2:
  s_cbranch_execz L_tour0
  v_exp_f32 v112, v112
  v_exp_f32 v113, v113
  v_exp_f32 v114, v114
  v_exp_f32 v115, v115
  v_cvt_pk_bf16_f32 v144, v112, v113
  v_cvt_pk_bf16_f32 v145, v114, v115
  v_mfma_f32_32x32x16_bf16 v[96:111], a[12:15], v[148:151], v[96:111]
  buffer_load_ushort v252, v252, s[40:43], s68 offen
  v_exp_f32 v116, v116
  v_exp_f32 v117, v117
  v_exp_f32 v118, v118
  v_exp_f32 v119, v119
  v_cvt_pk_bf16_f32 v146, v116, v117
  v_cvt_pk_bf16_f32 v147, v118, v119
  v_mfma_f32_32x32x16_bf16 v[128:143], a[20:23], v[28:31], v[128:143]
  global_load_dwordx4 a[80:83], v7, s[54:55] offset:0 sc1
  v_exp_f32 v120, v120
  v_exp_f32 v121, v121
  v_exp_f32 v122, v122
  v_exp_f32 v123, v123
  v_cvt_pk_bf16_f32 v148, v120, v121
  v_cvt_pk_bf16_f32 v149, v122, v123
  v_mfma_f32_32x32x16_bf16 v[48:63], a[24:27], v[144:147], v[48:63]
  v_exp_f32 v124, v124
  v_exp_f32 v125, v125
  v_exp_f32 v126, v126
  v_exp_f32 v127, v127
  v_cvt_pk_bf16_f32 v150, v124, v125
  v_cvt_pk_bf16_f32 v151, v126, v127
  v_mfma_f32_32x32x16_bf16 v[112:127], a[16:19], v[32:35], 0
  global_load_dwordx4 a[84:87], v7, s[54:55] offset:1024 sc1
  v_exp_f32 v128, v128
  v_exp_f32 v129, v129
  v_exp_f32 v130, v130
  v_exp_f32 v131, v131
  v_cvt_pk_bf16_f32 v144, v128, v129
  v_cvt_pk_bf16_f32 v145, v130, v131
  v_mfma_f32_32x32x16_bf16 v[48:63], a[28:31], v[148:151], v[48:63]
  global_load_dwordx4 a[88:91], v7, s[54:55] offset:2048 sc1
  v_exp_f32 v132, v132
  v_exp_f32 v133, v133
  v_exp_f32 v134, v134
  v_exp_f32 v135, v135
  v_cvt_pk_bf16_f32 v146, v132, v133
  v_cvt_pk_bf16_f32 v147, v134, v135
  v_mfma_f32_32x32x16_bf16 v[112:127], a[20:23], v[36:39], v[112:127]
  global_load_dwordx4 a[92:95], v7, s[54:55] offset:3072 sc1
  v_exp_f32 v136, v136
  v_exp_f32 v137, v137
  v_exp_f32 v138, v138
  v_exp_f32 v139, v139
  v_cvt_pk_bf16_f32 v148, v136, v137
  v_cvt_pk_bf16_f32 v149, v138, v139
  v_mfma_f32_32x32x16_bf16 v[64:79], a[24:27], v[144:147], v[64:79]
  s_add_u32 s54, s54, 8192
  s_addc_u32 s55, s55, 0
  s_waitcnt vmcnt(19)
  s_mov_b64 exec, 7
  buffer_store_dword v224, v233, s[12:15], s101 offen offset:16 sc1
  s_mov_b64 exec, -1
  v_exp_f32 v140, v140
  v_exp_f32 v141, v141
  v_exp_f32 v142, v142
  v_exp_f32 v143, v143
  v_cvt_pk_bf16_f32 v150, v140, v141
  v_cvt_pk_bf16_f32 v151, v142, v143
  v_mfma_f32_32x32x16_bf16 v[128:143], a[16:19], v[40:43], 0
  global_load_dwordx4 a[96:99], v7, s[54:55] offset:-4096 sc1
  v_exp_f32 v112, v112
  v_exp_f32 v113, v113
  v_exp_f32 v114, v114
  v_exp_f32 v115, v115
  v_cvt_pk_bf16_f32 v144, v112, v113
  v_cvt_pk_bf16_f32 v145, v114, v115
  v_mfma_f32_32x32x16_bf16 v[64:79], a[28:31], v[148:151], v[64:79]
  global_load_dwordx4 a[100:103], v7, s[54:55] offset:-3072 sc1
  v_exp_f32 v116, v116
  v_exp_f32 v117, v117
  v_exp_f32 v118, v118
  v_exp_f32 v119, v119
  v_cvt_pk_bf16_f32 v146, v116, v117
  v_cvt_pk_bf16_f32 v147, v118, v119
  v_mfma_f32_32x32x16_bf16 v[128:143], a[20:23], v[44:47], v[128:143]
  global_load_dwordx4 a[104:107], v7, s[54:55] offset:-2048 sc1
  v_exp_f32 v120, v120
  v_exp_f32 v121, v121
  v_exp_f32 v122, v122
  v_exp_f32 v123, v123
  v_cvt_pk_bf16_f32 v148, v120, v121
  v_cvt_pk_bf16_f32 v149, v122, v123
  v_mfma_f32_32x32x16_bf16 v[80:95], a[24:27], v[144:147], v[80:95]
  s_waitcnt vmcnt(21)
  v_exp_f32 v124, v124
  v_exp_f32 v125, v125
  v_exp_f32 v126, v126
  v_exp_f32 v127, v127
  v_cvt_pk_bf16_f32 v150, v124, v125
  v_cvt_pk_bf16_f32 v151, v126, v127
  v_mfma_f32_32x32x16_bf16 v[112:127], a[32:35], v[16:19], 0
  global_load_dwordx4 a[108:111], v7, s[54:55] offset:-1024 sc1
  v_exp_f32 v128, v128
  v_exp_f32 v129, v129
  v_exp_f32 v130, v130
  v_exp_f32 v131, v131
  v_cvt_pk_bf16_f32 v144, v128, v129
  v_cvt_pk_bf16_f32 v145, v130, v131
  v_mfma_f32_32x32x16_bf16 v[80:95], a[28:31], v[148:151], v[80:95]
  global_load_dwordx4 a[112:115], v7, s[54:55] offset:0 sc1
  v_exp_f32 v132, v132
  v_exp_f32 v133, v133
  v_exp_f32 v134, v134
  v_exp_f32 v135, v135
  v_cvt_pk_bf16_f32 v146, v132, v133
  v_cvt_pk_bf16_f32 v147, v134, v135
  v_mfma_f32_32x32x16_bf16 v[112:127], a[36:39], v[20:23], v[112:127]
  global_load_dwordx4 a[116:119], v7, s[54:55] offset:1024 sc1
  v_exp_f32 v136, v136
  v_exp_f32 v137, v137
  v_exp_f32 v138, v138
  v_exp_f32 v139, v139
  v_cvt_pk_bf16_f32 v148, v136, v137
  v_cvt_pk_bf16_f32 v149, v138, v139
  v_mfma_f32_32x32x16_bf16 v[96:111], a[24:27], v[144:147], v[96:111]
  v_exp_f32 v140, v140
  v_exp_f32 v141, v141
  v_exp_f32 v142, v142
  v_exp_f32 v143, v143
  v_cvt_pk_bf16_f32 v150, v140, v141
  v_cvt_pk_bf16_f32 v151, v142, v143
  v_mfma_f32_32x32x16_bf16 v[128:143], a[32:35], v[24:27], 0
  global_load_dwordx4 a[120:123], v7, s[54:55] offset:2048 sc1
  v_exp_f32 v112, v112
  v_exp_f32 v113, v113
  v_exp_f32 v114, v114
  v_exp_f32 v115, v115
  v_cvt_pk_bf16_f32 v144, v112, v113
  v_cvt_pk_bf16_f32 v145, v114, v115
  v_mfma_f32_32x32x16_bf16 v[96:111], a[28:31], v[148:151], v[96:111]
  global_load_dwordx4 a[124:127], v7, s[54:55] offset:3072 sc1
  v_exp_f32 v116, v116
  v_exp_f32 v117, v117
  v_exp_f32 v118, v118
  v_exp_f32 v119, v119
  v_cvt_pk_bf16_f32 v146, v116, v117
  v_cvt_pk_bf16_f32 v147, v118, v119
  v_mfma_f32_32x32x16_bf16 v[128:143], a[36:39], v[28:31], v[128:143]
  s_add_u32 s54, s54, 8192
  s_addc_u32 s55, s55, 0
  global_load_dwordx4 v[152:155], v7, s[54:55] offset:-4096 sc1
  v_exp_f32 v120, v120
  v_exp_f32 v121, v121
  v_exp_f32 v122, v122
  v_exp_f32 v123, v123
  v_cvt_pk_bf16_f32 v148, v120, v121
  v_cvt_pk_bf16_f32 v149, v122, v123
  v_mfma_f32_32x32x16_bf16 v[48:63], a[40:43], v[144:147], v[48:63]
  v_exp_f32 v124, v124
  v_exp_f32 v125, v125
  v_exp_f32 v126, v126
  v_exp_f32 v127, v127
  v_cvt_pk_bf16_f32 v150, v124, v125
  v_cvt_pk_bf16_f32 v151, v126, v127
  v_mfma_f32_32x32x16_bf16 v[112:127], a[32:35], v[32:35], 0
  global_load_dwordx4 v[156:159], v7, s[54:55] offset:-3072 sc1
  v_exp_f32 v128, v128
  v_exp_f32 v129, v129
  v_exp_f32 v130, v130
  v_exp_f32 v131, v131
  v_cvt_pk_bf16_f32 v144, v128, v129
  v_cvt_pk_bf16_f32 v145, v130, v131
  v_mfma_f32_32x32x16_bf16 v[48:63], a[44:47], v[148:151], v[48:63]
  global_load_dwordx4 v[160:163], v7, s[54:55] offset:-2048 sc1
  v_exp_f32 v132, v132
  v_exp_f32 v133, v133
  v_exp_f32 v134, v134
  v_exp_f32 v135, v135
  v_cvt_pk_bf16_f32 v146, v132, v133
  v_cvt_pk_bf16_f32 v147, v134, v135
  v_mfma_f32_32x32x16_bf16 v[112:127], a[36:39], v[36:39], v[112:127]
  global_load_dwordx4 v[164:167], v7, s[54:55] offset:-1024 sc1
  v_exp_f32 v136, v136
  v_exp_f32 v137, v137
  v_exp_f32 v138, v138
  v_exp_f32 v139, v139
  v_cvt_pk_bf16_f32 v148, v136, v137
  v_cvt_pk_bf16_f32 v149, v138, v139
  v_mfma_f32_32x32x16_bf16 v[64:79], a[40:43], v[144:147], v[64:79]
  v_exp_f32 v140, v140
  v_exp_f32 v141, v141
  v_exp_f32 v142, v142
  v_exp_f32 v143, v143
  v_cvt_pk_bf16_f32 v150, v140, v141
  v_cvt_pk_bf16_f32 v151, v142, v143
  v_mfma_f32_32x32x16_bf16 v[128:143], a[32:35], v[40:43], 0
  global_load_dwordx4 v[168:171], v7, s[54:55] offset:0 sc1
  v_exp_f32 v112, v112
  v_exp_f32 v113, v113
  v_exp_f32 v114, v114
  v_exp_f32 v115, v115
  v_cvt_pk_bf16_f32 v144, v112, v113
  v_cvt_pk_bf16_f32 v145, v114, v115
  v_mfma_f32_32x32x16_bf16 v[64:79], a[44:47], v[148:151], v[64:79]
  global_load_dwordx4 v[172:175], v7, s[54:55] offset:1024 sc1
  v_exp_f32 v116, v116
  v_exp_f32 v117, v117
  v_exp_f32 v118, v118
  v_exp_f32 v119, v119
  v_cvt_pk_bf16_f32 v146, v116, v117
  v_cvt_pk_bf16_f32 v147, v118, v119
  v_mfma_f32_32x32x16_bf16 v[128:143], a[36:39], v[44:47], v[128:143]
  global_load_dwordx4 v[176:179], v7, s[54:55] offset:2048 sc1
  v_exp_f32 v120, v120
  v_exp_f32 v121, v121
  v_exp_f32 v122, v122
  v_exp_f32 v123, v123
  v_cvt_pk_bf16_f32 v148, v120, v121
  v_cvt_pk_bf16_f32 v149, v122, v123
  v_mfma_f32_32x32x16_bf16 v[80:95], a[40:43], v[144:147], v[80:95]
  s_waitcnt vmcnt(27)
  v_exp_f32 v124, v124
  v_exp_f32 v125, v125
  v_exp_f32 v126, v126
  v_exp_f32 v127, v127
  v_cvt_pk_bf16_f32 v150, v124, v125
  v_cvt_pk_bf16_f32 v151, v126, v127
  v_mfma_f32_32x32x16_bf16 v[112:127], a[48:51], v[16:19], 0
  global_load_dwordx4 v[180:183], v7, s[54:55] offset:3072 sc1
  v_exp_f32 v128, v128
  v_exp_f32 v129, v129
  v_exp_f32 v130, v130
  v_exp_f32 v131, v131
  v_cvt_pk_bf16_f32 v144, v128, v129
  v_cvt_pk_bf16_f32 v145, v130, v131
  v_mfma_f32_32x32x16_bf16 v[80:95], a[44:47], v[148:151], v[80:95]
  s_add_u32 s54, s54, 8192
  s_addc_u32 s55, s55, 0
  global_load_dwordx4 v[184:187], v7, s[54:55] offset:-4096 sc1
  v_exp_f32 v132, v132
  v_exp_f32 v133, v133
  v_exp_f32 v134, v134
  v_exp_f32 v135, v135
  v_cvt_pk_bf16_f32 v146, v132, v133
  v_cvt_pk_bf16_f32 v147, v134, v135
  v_mfma_f32_32x32x16_bf16 v[112:127], a[52:55], v[20:23], v[112:127]
  global_load_dwordx4 v[188:191], v7, s[54:55] offset:-3072 sc1
  v_exp_f32 v136, v136
  v_exp_f32 v137, v137
  v_exp_f32 v138, v138
  v_exp_f32 v139, v139
  v_cvt_pk_bf16_f32 v148, v136, v137
  v_cvt_pk_bf16_f32 v149, v138, v139
  v_mfma_f32_32x32x16_bf16 v[96:111], a[40:43], v[144:147], v[96:111]
  v_exp_f32 v140, v140
  v_exp_f32 v141, v141
  v_exp_f32 v142, v142
  v_exp_f32 v143, v143
  v_cvt_pk_bf16_f32 v150, v140, v141
  v_cvt_pk_bf16_f32 v151, v142, v143
  v_mfma_f32_32x32x16_bf16 v[128:143], a[48:51], v[24:27], 0
  global_load_dwordx4 v[192:195], v7, s[54:55] offset:-2048 sc1
  v_exp_f32 v112, v112
  v_exp_f32 v113, v113
  v_exp_f32 v114, v114
  v_exp_f32 v115, v115
  v_cvt_pk_bf16_f32 v144, v112, v113
  v_cvt_pk_bf16_f32 v145, v114, v115
  v_mfma_f32_32x32x16_bf16 v[96:111], a[44:47], v[148:151], v[96:111]
  global_load_dwordx4 v[196:199], v7, s[54:55] offset:-1024 sc1
  v_exp_f32 v116, v116
  v_exp_f32 v117, v117
  v_exp_f32 v118, v118
  v_exp_f32 v119, v119
  v_cvt_pk_bf16_f32 v146, v116, v117
  v_cvt_pk_bf16_f32 v147, v118, v119
  v_mfma_f32_32x32x16_bf16 v[128:143], a[52:55], v[28:31], v[128:143]
  global_load_dwordx4 v[200:203], v7, s[54:55] offset:0 sc1
  v_exp_f32 v120, v120
  v_exp_f32 v121, v121
  v_exp_f32 v122, v122
  v_exp_f32 v123, v123
  v_cvt_pk_bf16_f32 v148, v120, v121
  v_cvt_pk_bf16_f32 v149, v122, v123
  v_mfma_f32_32x32x16_bf16 v[48:63], a[56:59], v[144:147], v[48:63]
  v_exp_f32 v124, v124
  v_exp_f32 v125, v125
  v_exp_f32 v126, v126
  v_exp_f32 v127, v127
  v_cvt_pk_bf16_f32 v150, v124, v125
  v_cvt_pk_bf16_f32 v151, v126, v127
  v_mfma_f32_32x32x16_bf16 v[112:127], a[48:51], v[32:35], 0
  global_load_dwordx4 v[204:207], v7, s[54:55] offset:1024 sc1
  v_exp_f32 v128, v128
  v_exp_f32 v129, v129
  v_exp_f32 v130, v130
  v_exp_f32 v131, v131
  v_cvt_pk_bf16_f32 v144, v128, v129
  v_cvt_pk_bf16_f32 v145, v130, v131
  v_mfma_f32_32x32x16_bf16 v[48:63], a[60:63], v[148:151], v[48:63]
  global_load_dwordx4 v[208:211], v7, s[54:55] offset:2048 sc1
  v_exp_f32 v132, v132
  v_exp_f32 v133, v133
  v_exp_f32 v134, v134
  v_exp_f32 v135, v135
  v_cvt_pk_bf16_f32 v146, v132, v133
  v_cvt_pk_bf16_f32 v147, v134, v135
  v_mfma_f32_32x32x16_bf16 v[112:127], a[52:55], v[36:39], v[112:127]
  global_load_dwordx4 v[212:215], v7, s[54:55] offset:3072 sc1
  v_exp_f32 v136, v136
  v_exp_f32 v137, v137
  v_exp_f32 v138, v138
  v_exp_f32 v139, v139
  v_cvt_pk_bf16_f32 v148, v136, v137
  v_cvt_pk_bf16_f32 v149, v138, v139
  v_mfma_f32_32x32x16_bf16 v[64:79], a[56:59], v[144:147], v[64:79]
  s_add_u32 m0, s0, 20480
  v_exp_f32 v140, v140
  v_exp_f32 v141, v141
  v_exp_f32 v142, v142
  v_exp_f32 v143, v143
  v_cvt_pk_bf16_f32 v150, v140, v141
  v_cvt_pk_bf16_f32 v151, v142, v143
  v_mfma_f32_32x32x16_bf16 v[128:143], a[48:51], v[40:43], 0
  global_load_lds_dwordx4 v216, s[60:61] offset:0
  v_exp_f32 v112, v112
  v_exp_f32 v113, v113
  v_exp_f32 v114, v114
  v_exp_f32 v115, v115
  v_cvt_pk_bf16_f32 v144, v112, v113
  v_cvt_pk_bf16_f32 v145, v114, v115
  v_mfma_f32_32x32x16_bf16 v[64:79], a[60:63], v[148:151], v[64:79]
  s_add_u32 s62, s60, 114688
  v_exp_f32 v116, v116
  v_exp_f32 v117, v117
  v_exp_f32 v118, v118
  v_exp_f32 v119, v119
  v_cvt_pk_bf16_f32 v146, v116, v117
  v_cvt_pk_bf16_f32 v147, v118, v119
  v_mfma_f32_32x32x16_bf16 v[128:143], a[52:55], v[44:47], v[128:143]
  global_load_lds_dwordx4 v217, s[60:61] offset:1024
  v_exp_f32 v120, v120
  v_exp_f32 v121, v121
  v_exp_f32 v122, v122
  v_exp_f32 v123, v123
  v_cvt_pk_bf16_f32 v148, v120, v121
  v_cvt_pk_bf16_f32 v149, v122, v123
  v_mfma_f32_32x32x16_bf16 v[80:95], a[56:59], v[144:147], v[80:95]
  s_addc_u32 s63, s61, 0
  s_waitcnt vmcnt(32)
  v_exp_f32 v124, v124
  v_exp_f32 v125, v125
  v_exp_f32 v126, v126
  v_exp_f32 v127, v127
  v_cvt_pk_bf16_f32 v150, v124, v125
  v_cvt_pk_bf16_f32 v151, v126, v127
  v_mfma_f32_32x32x16_bf16 v[112:127], a[64:67], v[16:19], 0
  global_load_lds_dwordx4 v218, s[60:61] offset:2048
  v_exp_f32 v128, v128
  v_exp_f32 v129, v129
  v_exp_f32 v130, v130
  v_exp_f32 v131, v131
  v_cvt_pk_bf16_f32 v144, v128, v129
  v_cvt_pk_bf16_f32 v145, v130, v131
  v_mfma_f32_32x32x16_bf16 v[80:95], a[60:63], v[148:151], v[80:95]
  v_exp_f32 v132, v132
  v_exp_f32 v133, v133
  v_exp_f32 v134, v134
  v_exp_f32 v135, v135
  v_cvt_pk_bf16_f32 v146, v132, v133
  v_cvt_pk_bf16_f32 v147, v134, v135
  v_mfma_f32_32x32x16_bf16 v[112:127], a[68:71], v[20:23], v[112:127]
  global_load_lds_dwordx4 v219, s[60:61] offset:3072
  v_exp_f32 v136, v136
  v_exp_f32 v137, v137
  v_exp_f32 v138, v138
  v_exp_f32 v139, v139
  v_cvt_pk_bf16_f32 v148, v136, v137
  v_cvt_pk_bf16_f32 v149, v138, v139
  v_mfma_f32_32x32x16_bf16 v[96:111], a[56:59], v[144:147], v[96:111]
  s_add_u32 m0, s0, 16384
  v_exp_f32 v140, v140
  v_exp_f32 v141, v141
  v_exp_f32 v142, v142
  v_exp_f32 v143, v143
  v_cvt_pk_bf16_f32 v150, v140, v141
  v_cvt_pk_bf16_f32 v151, v142, v143
  v_mfma_f32_32x32x16_bf16 v[128:143], a[64:67], v[24:27], 0
  global_load_lds_dwordx4 v216, s[62:63] offset:0
  v_exp_f32 v112, v112
  v_exp_f32 v113, v113
  v_exp_f32 v114, v114
  v_exp_f32 v115, v115
  v_cvt_pk_bf16_f32 v144, v112, v113
  v_cvt_pk_bf16_f32 v145, v114, v115
  v_mfma_f32_32x32x16_bf16 v[96:111], a[60:63], v[148:151], v[96:111]
  s_add_u32 s60, s62, 114688
  v_exp_f32 v116, v116
  v_exp_f32 v117, v117
  v_exp_f32 v118, v118
  v_exp_f32 v119, v119
  v_cvt_pk_bf16_f32 v146, v116, v117
  v_cvt_pk_bf16_f32 v147, v118, v119
  v_mfma_f32_32x32x16_bf16 v[128:143], a[68:71], v[28:31], v[128:143]
  global_load_lds_dwordx4 v217, s[62:63] offset:1024
  v_exp_f32 v120, v120
  v_exp_f32 v121, v121
  v_exp_f32 v122, v122
  v_exp_f32 v123, v123
  v_cvt_pk_bf16_f32 v148, v120, v121
  v_cvt_pk_bf16_f32 v149, v122, v123
  v_mfma_f32_32x32x16_bf16 v[48:63], a[72:75], v[144:147], v[48:63]
  s_addc_u32 s61, s63, 0
  v_exp_f32 v124, v124
  v_exp_f32 v125, v125
  v_exp_f32 v126, v126
  v_exp_f32 v127, v127
  v_cvt_pk_bf16_f32 v150, v124, v125
  v_cvt_pk_bf16_f32 v151, v126, v127
  v_mfma_f32_32x32x16_bf16 v[112:127], a[64:67], v[32:35], 0
  global_load_lds_dwordx4 v218, s[62:63] offset:2048
  v_exp_f32 v128, v128
  v_exp_f32 v129, v129
  v_exp_f32 v130, v130
  v_exp_f32 v131, v131
  v_cvt_pk_bf16_f32 v144, v128, v129
  v_cvt_pk_bf16_f32 v145, v130, v131
  v_mfma_f32_32x32x16_bf16 v[48:63], a[76:79], v[148:151], v[48:63]
  v_exp_f32 v132, v132
  v_exp_f32 v133, v133
  v_exp_f32 v134, v134
  v_exp_f32 v135, v135
  v_cvt_pk_bf16_f32 v146, v132, v133
  v_cvt_pk_bf16_f32 v147, v134, v135
  v_mfma_f32_32x32x16_bf16 v[112:127], a[68:71], v[36:39], v[112:127]
  global_load_lds_dwordx4 v219, s[62:63] offset:3072
  v_exp_f32 v136, v136
  v_exp_f32 v137, v137
  v_exp_f32 v138, v138
  v_exp_f32 v139, v139
  v_cvt_pk_bf16_f32 v148, v136, v137
  v_cvt_pk_bf16_f32 v149, v138, v139
  v_mfma_f32_32x32x16_bf16 v[64:79], a[72:75], v[144:147], v[64:79]
  s_add_u32 m0, s0, 12288
  v_exp_f32 v140, v140
  v_exp_f32 v141, v141
  v_exp_f32 v142, v142
  v_exp_f32 v143, v143
  v_cvt_pk_bf16_f32 v150, v140, v141
  v_cvt_pk_bf16_f32 v151, v142, v143
  v_mfma_f32_32x32x16_bf16 v[128:143], a[64:67], v[40:43], 0
  global_load_lds_dwordx4 v216, s[60:61] offset:0
  v_exp_f32 v112, v112
  v_exp_f32 v113, v113
  v_exp_f32 v114, v114
  v_exp_f32 v115, v115
  v_cvt_pk_bf16_f32 v144, v112, v113
  v_cvt_pk_bf16_f32 v145, v114, v115
  v_mfma_f32_32x32x16_bf16 v[64:79], a[76:79], v[148:151], v[64:79]
  s_add_u32 s62, s60, 114688
  v_exp_f32 v116, v116
  v_exp_f32 v117, v117
  v_exp_f32 v118, v118
  v_exp_f32 v119, v119
  v_cvt_pk_bf16_f32 v146, v116, v117
  v_cvt_pk_bf16_f32 v147, v118, v119
  v_mfma_f32_32x32x16_bf16 v[128:143], a[68:71], v[44:47], v[128:143]
  global_load_lds_dwordx4 v217, s[60:61] offset:1024
  v_exp_f32 v120, v120
  v_exp_f32 v121, v121
  v_exp_f32 v122, v122
  v_exp_f32 v123, v123
  v_cvt_pk_bf16_f32 v148, v120, v121
  v_cvt_pk_bf16_f32 v149, v122, v123
  v_mfma_f32_32x32x16_bf16 v[80:95], a[72:75], v[144:147], v[80:95]
  s_addc_u32 s63, s61, 0
  s_waitcnt vmcnt(35)
  v_exp_f32 v124, v124
  v_exp_f32 v125, v125
  v_exp_f32 v126, v126
  v_exp_f32 v127, v127
  v_cvt_pk_bf16_f32 v150, v124, v125
  v_cvt_pk_bf16_f32 v151, v126, v127
  v_mfma_f32_32x32x16_bf16 v[112:127], a[80:83], v[16:19], 0
  global_load_lds_dwordx4 v218, s[60:61] offset:2048
  v_exp_f32 v128, v128
  v_exp_f32 v129, v129
  v_exp_f32 v130, v130
  v_exp_f32 v131, v131
  v_cvt_pk_bf16_f32 v144, v128, v129
  v_cvt_pk_bf16_f32 v145, v130, v131
  v_mfma_f32_32x32x16_bf16 v[80:95], a[76:79], v[148:151], v[80:95]
  s_waitcnt vmcnt(7)
  v_exp_f32 v132, v132
  v_exp_f32 v133, v133
  v_exp_f32 v134, v134
  v_exp_f32 v135, v135
  v_cvt_pk_bf16_f32 v146, v132, v133
  v_cvt_pk_bf16_f32 v147, v134, v135
  v_mfma_f32_32x32x16_bf16 v[112:127], a[84:87], v[20:23], v[112:127]
  global_load_lds_dwordx4 v219, s[60:61] offset:3072
  v_exp_f32 v136, v136
  v_exp_f32 v137, v137
  v_exp_f32 v138, v138
  v_exp_f32 v139, v139
  v_cvt_pk_bf16_f32 v148, v136, v137
  v_cvt_pk_bf16_f32 v149, v138, v139
  v_mfma_f32_32x32x16_bf16 v[96:111], a[72:75], v[144:147], v[96:111]
  s_add_u32 m0, s0, 8192
  v_exp_f32 v140, v140
  v_exp_f32 v141, v141
  v_exp_f32 v142, v142
  v_exp_f32 v143, v143
  v_cvt_pk_bf16_f32 v150, v140, v141
  v_cvt_pk_bf16_f32 v151, v142, v143
  v_mfma_f32_32x32x16_bf16 v[128:143], a[80:83], v[24:27], 0
  global_load_lds_dwordx4 v216, s[62:63] offset:0
  ds_read_b64_tr_b16 a[192:193], v220 offset:20480
  ds_read_b64_tr_b16 a[194:195], v220 offset:20992
  v_exp_f32 v112, v112
  v_exp_f32 v113, v113
  v_exp_f32 v114, v114
  v_exp_f32 v115, v115
  v_cvt_pk_bf16_f32 v144, v112, v113
  v_cvt_pk_bf16_f32 v145, v114, v115
  v_mfma_f32_32x32x16_bf16 v[96:111], a[76:79], v[148:151], v[96:111]
  s_add_u32 s60, s62, 114688
  v_exp_f32 v116, v116
  v_exp_f32 v117, v117
  v_exp_f32 v118, v118
  v_exp_f32 v119, v119
  v_cvt_pk_bf16_f32 v146, v116, v117
  v_cvt_pk_bf16_f32 v147, v118, v119
  v_mfma_f32_32x32x16_bf16 v[128:143], a[84:87], v[28:31], v[128:143]
  global_load_lds_dwordx4 v217, s[62:63] offset:1024
  ds_read_b64_tr_b16 a[196:197], v221 offset:20480
  ds_read_b64_tr_b16 a[198:199], v221 offset:20992
  v_exp_f32 v120, v120
  v_exp_f32 v121, v121
  v_exp_f32 v122, v122
  v_exp_f32 v123, v123
  v_cvt_pk_bf16_f32 v148, v120, v121
  v_cvt_pk_bf16_f32 v149, v122, v123
  v_mfma_f32_32x32x16_bf16 v[48:63], a[88:91], v[144:147], v[48:63]
  s_addc_u32 s61, s63, 0
  v_exp_f32 v124, v124
  v_exp_f32 v125, v125
  v_exp_f32 v126, v126
  v_exp_f32 v127, v127
  v_cvt_pk_bf16_f32 v150, v124, v125
  v_cvt_pk_bf16_f32 v151, v126, v127
  v_mfma_f32_32x32x16_bf16 v[112:127], a[80:83], v[32:35], 0
  global_load_lds_dwordx4 v218, s[62:63] offset:2048
  ds_read_b64_tr_b16 a[200:201], v220 offset:22528
  ds_read_b64_tr_b16 a[202:203], v220 offset:23040
  v_exp_f32 v128, v128
  v_exp_f32 v129, v129
  v_exp_f32 v130, v130
  v_exp_f32 v131, v131
  v_cvt_pk_bf16_f32 v144, v128, v129
  v_cvt_pk_bf16_f32 v145, v130, v131
  v_mfma_f32_32x32x16_bf16 v[48:63], a[92:95], v[148:151], v[48:63]
  s_waitcnt vmcnt(7)
  v_exp_f32 v132, v132
  v_exp_f32 v133, v133
  v_exp_f32 v134, v134
  v_exp_f32 v135, v135
  v_cvt_pk_bf16_f32 v146, v132, v133
  v_cvt_pk_bf16_f32 v147, v134, v135
  v_mfma_f32_32x32x16_bf16 v[112:127], a[84:87], v[36:39], v[112:127]
  global_load_lds_dwordx4 v219, s[62:63] offset:3072
  ds_read_b64_tr_b16 a[204:205], v221 offset:22528
  ds_read_b64_tr_b16 a[206:207], v221 offset:23040
  v_exp_f32 v136, v136
  v_exp_f32 v137, v137
  v_exp_f32 v138, v138
  v_exp_f32 v139, v139
  v_cvt_pk_bf16_f32 v148, v136, v137
  v_cvt_pk_bf16_f32 v149, v138, v139
  v_mfma_f32_32x32x16_bf16 v[64:79], a[88:91], v[144:147], v[64:79]
  s_add_u32 m0, s0, 4096
  v_exp_f32 v140, v140
  v_exp_f32 v141, v141
  v_exp_f32 v142, v142
  v_exp_f32 v143, v143
  v_cvt_pk_bf16_f32 v150, v140, v141
  v_cvt_pk_bf16_f32 v151, v142, v143
  v_mfma_f32_32x32x16_bf16 v[128:143], a[80:83], v[40:43], 0
  global_load_lds_dwordx4 v216, s[60:61] offset:0
  ds_read_b64_tr_b16 a[208:209], v220 offset:16384
  ds_read_b64_tr_b16 a[210:211], v220 offset:16896
  v_exp_f32 v112, v112
  v_exp_f32 v113, v113
  v_exp_f32 v114, v114
  v_exp_f32 v115, v115
  v_cvt_pk_bf16_f32 v144, v112, v113
  v_cvt_pk_bf16_f32 v145, v114, v115
  v_mfma_f32_32x32x16_bf16 v[64:79], a[92:95], v[148:151], v[64:79]
  s_add_u32 s62, s60, 114688
  v_exp_f32 v116, v116
  v_exp_f32 v117, v117
  v_exp_f32 v118, v118
  v_exp_f32 v119, v119
  v_cvt_pk_bf16_f32 v146, v116, v117
  v_cvt_pk_bf16_f32 v147, v118, v119
  v_mfma_f32_32x32x16_bf16 v[128:143], a[84:87], v[44:47], v[128:143]
  global_load_lds_dwordx4 v217, s[60:61] offset:1024
  ds_read_b64_tr_b16 a[212:213], v221 offset:16384
  ds_read_b64_tr_b16 a[214:215], v221 offset:16896
  v_exp_f32 v120, v120
  v_exp_f32 v121, v121
  v_exp_f32 v122, v122
  v_exp_f32 v123, v123
  v_cvt_pk_bf16_f32 v148, v120, v121
  v_cvt_pk_bf16_f32 v149, v122, v123
  v_mfma_f32_32x32x16_bf16 v[80:95], a[88:91], v[144:147], v[80:95]
  s_addc_u32 s63, s61, 0
  v_exp_f32 v124, v124
  v_exp_f32 v125, v125
  v_exp_f32 v126, v126
  v_exp_f32 v127, v127
  v_cvt_pk_bf16_f32 v150, v124, v125
  v_cvt_pk_bf16_f32 v151, v126, v127
  v_mfma_f32_32x32x16_bf16 v[112:127], a[96:99], v[16:19], 0
  global_load_lds_dwordx4 v218, s[60:61] offset:2048
  ds_read_b64_tr_b16 a[216:217], v220 offset:18432
  ds_read_b64_tr_b16 a[218:219], v220 offset:18944
  v_exp_f32 v128, v128
  v_exp_f32 v129, v129
  v_exp_f32 v130, v130
  v_exp_f32 v131, v131
  v_cvt_pk_bf16_f32 v144, v128, v129
  v_cvt_pk_bf16_f32 v145, v130, v131
  v_mfma_f32_32x32x16_bf16 v[80:95], a[92:95], v[148:151], v[80:95]
  s_waitcnt vmcnt(7) lgkmcnt(6)
  v_exp_f32 v132, v132
  v_exp_f32 v133, v133
  v_exp_f32 v134, v134
  v_exp_f32 v135, v135
  v_cvt_pk_bf16_f32 v146, v132, v133
  v_cvt_pk_bf16_f32 v147, v134, v135
  v_mfma_f32_32x32x16_bf16 v[112:127], a[100:103], v[20:23], v[112:127]
  global_load_lds_dwordx4 v219, s[60:61] offset:3072
  ds_read_b64_tr_b16 a[220:221], v221 offset:18432
  ds_read_b64_tr_b16 a[222:223], v221 offset:18944
  v_exp_f32 v136, v136
  v_exp_f32 v137, v137
  v_exp_f32 v138, v138
  v_exp_f32 v139, v139
  v_cvt_pk_bf16_f32 v148, v136, v137
  v_cvt_pk_bf16_f32 v149, v138, v139
  v_mfma_f32_32x32x16_bf16 v[96:111], a[88:91], v[144:147], v[96:111]
  s_add_u32 m0, s0, 20480
  v_exp_f32 v140, v140
  v_exp_f32 v141, v141
  v_exp_f32 v142, v142
  v_exp_f32 v143, v143
  v_cvt_pk_bf16_f32 v150, v140, v141
  v_cvt_pk_bf16_f32 v151, v142, v143
  v_mfma_f32_32x32x16_bf16 v[128:143], a[96:99], v[24:27], 0
  global_load_lds_dwordx4 v216, s[62:63] offset:0
  ds_read_b64_tr_b16 a[224:225], v220 offset:12288
  ds_read_b64_tr_b16 a[226:227], v220 offset:12800
  v_exp_f32 v112, v112
  v_exp_f32 v113, v113
  v_exp_f32 v114, v114
  v_exp_f32 v115, v115
  v_cvt_pk_bf16_f32 v144, v112, v113
  v_cvt_pk_bf16_f32 v145, v114, v115
  v_mfma_f32_32x32x16_bf16 v[96:111], a[92:95], v[148:151], v[96:111]
  s_add_u32 s60, s62, 114688
  v_exp_f32 v116, v116
  v_exp_f32 v117, v117
  v_exp_f32 v118, v118
  v_exp_f32 v119, v119
  v_cvt_pk_bf16_f32 v146, v116, v117
  v_cvt_pk_bf16_f32 v147, v118, v119
  v_mfma_f32_32x32x16_bf16 v[128:143], a[100:103], v[28:31], v[128:143]
  global_load_lds_dwordx4 v217, s[62:63] offset:1024
  ds_read_b64_tr_b16 a[228:229], v221 offset:12288
  ds_read_b64_tr_b16 a[230:231], v221 offset:12800
  v_exp_f32 v120, v120
  v_exp_f32 v121, v121
  v_exp_f32 v122, v122
  v_exp_f32 v123, v123
  v_cvt_pk_bf16_f32 v148, v120, v121
  v_cvt_pk_bf16_f32 v149, v122, v123
  v_mfma_f32_32x32x16_bf16 v[48:63], a[104:107], v[144:147], v[48:63]
  s_addc_u32 s61, s63, 0
L_pad3:
  s_cbranch_execz L_tour0
  v_exp_f32 v124, v124
  v_exp_f32 v125, v125
  v_exp_f32 v126, v126
  v_exp_f32 v127, v127
  v_cvt_pk_bf16_f32 v150, v124, v125
  v_cvt_pk_bf16_f32 v151, v126, v127
  v_mfma_f32_32x32x16_bf16 v[112:127], a[96:99], v[32:35], 0
  global_load_lds_dwordx4 v218, s[62:63] offset:2048
  ds_read_b64_tr_b16 a[232:233], v220 offset:14336
  ds_read_b64_tr_b16 a[234:235], v220 offset:14848
  v_exp_f32 v128, v128
  v_exp_f32 v129, v129
  v_exp_f32 v130, v130
  v_exp_f32 v131, v131
  v_cvt_pk_bf16_f32 v144, v128, v129
  v_cvt_pk_bf16_f32 v145, v130, v131
  v_mfma_f32_32x32x16_bf16 v[48:63], a[108:111], v[148:151], v[48:63]
  s_waitcnt vmcnt(7) lgkmcnt(6)
  v_exp_f32 v132, v132
  v_exp_f32 v133, v133
  v_exp_f32 v134, v134
  v_exp_f32 v135, v135
  v_cvt_pk_bf16_f32 v146, v132, v133
  v_cvt_pk_bf16_f32 v147, v134, v135
  v_mfma_f32_32x32x16_bf16 v[112:127], a[100:103], v[36:39], v[112:127]
  global_load_lds_dwordx4 v219, s[62:63] offset:3072
  ds_read_b64_tr_b16 a[236:237], v221 offset:14336
  ds_read_b64_tr_b16 a[238:239], v221 offset:14848
  v_exp_f32 v136, v136
  v_exp_f32 v137, v137
  v_exp_f32 v138, v138
  v_exp_f32 v139, v139
  v_cvt_pk_bf16_f32 v148, v136, v137
  v_cvt_pk_bf16_f32 v149, v138, v139
  v_mfma_f32_32x32x16_bf16 v[64:79], a[104:107], v[144:147], v[64:79]
  s_add_u32 m0, s0, 16384
  v_exp_f32 v140, v140
  v_exp_f32 v141, v141
  v_exp_f32 v142, v142
  v_exp_f32 v143, v143
  v_cvt_pk_bf16_f32 v150, v140, v141
  v_cvt_pk_bf16_f32 v151, v142, v143
  v_mfma_f32_32x32x16_bf16 v[128:143], a[96:99], v[40:43], 0
  global_load_lds_dwordx4 v216, s[60:61] offset:0
  ds_read_b64_tr_b16 a[240:241], v220 offset:8192
  ds_read_b64_tr_b16 a[242:243], v220 offset:8704
  v_exp_f32 v112, v112
  v_exp_f32 v113, v113
  v_exp_f32 v114, v114
  v_exp_f32 v115, v115
  v_cvt_pk_bf16_f32 v144, v112, v113
  v_cvt_pk_bf16_f32 v145, v114, v115
  v_mfma_f32_32x32x16_bf16 v[64:79], a[108:111], v[148:151], v[64:79]
  s_add_u32 s62, s60, 114688
  v_exp_f32 v116, v116
  v_exp_f32 v117, v117
  v_exp_f32 v118, v118
  v_exp_f32 v119, v119
  v_cvt_pk_bf16_f32 v146, v116, v117
  v_cvt_pk_bf16_f32 v147, v118, v119
  v_mfma_f32_32x32x16_bf16 v[128:143], a[100:103], v[44:47], v[128:143]
  global_load_lds_dwordx4 v217, s[60:61] offset:1024
  ds_read_b64_tr_b16 a[244:245], v221 offset:8192
  ds_read_b64_tr_b16 a[246:247], v221 offset:8704
  v_exp_f32 v120, v120
  v_exp_f32 v121, v121
  v_exp_f32 v122, v122
  v_exp_f32 v123, v123
  v_cvt_pk_bf16_f32 v148, v120, v121
  v_cvt_pk_bf16_f32 v149, v122, v123
  v_mfma_f32_32x32x16_bf16 v[80:95], a[104:107], v[144:147], v[80:95]
  s_addc_u32 s63, s61, 0
  v_exp_f32 v124, v124
  v_exp_f32 v125, v125
  v_exp_f32 v126, v126
  v_exp_f32 v127, v127
  v_cvt_pk_bf16_f32 v150, v124, v125
  v_cvt_pk_bf16_f32 v151, v126, v127
  v_mfma_f32_32x32x16_bf16 v[112:127], a[112:115], v[16:19], 0
  global_load_lds_dwordx4 v218, s[60:61] offset:2048
  ds_read_b64_tr_b16 a[248:249], v220 offset:10240
  ds_read_b64_tr_b16 a[250:251], v220 offset:10752
  v_exp_f32 v128, v128
  v_exp_f32 v129, v129
  v_exp_f32 v130, v130
  v_exp_f32 v131, v131
  v_cvt_pk_bf16_f32 v144, v128, v129
  v_cvt_pk_bf16_f32 v145, v130, v131
  v_mfma_f32_32x32x16_bf16 v[80:95], a[108:111], v[148:151], v[80:95]
  s_waitcnt vmcnt(7) lgkmcnt(6)
  v_exp_f32 v132, v132
  v_exp_f32 v133, v133
  v_exp_f32 v134, v134
  v_exp_f32 v135, v135
  v_cvt_pk_bf16_f32 v146, v132, v133
  v_cvt_pk_bf16_f32 v147, v134, v135
  v_mfma_f32_32x32x16_bf16 v[112:127], a[116:119], v[20:23], v[112:127]
  global_load_lds_dwordx4 v219, s[60:61] offset:3072
  ds_read_b64_tr_b16 a[252:253], v221 offset:10240
  ds_read_b64_tr_b16 a[254:255], v221 offset:10752
  v_exp_f32 v136, v136
  v_exp_f32 v137, v137
  v_exp_f32 v138, v138
  v_exp_f32 v139, v139
  v_cvt_pk_bf16_f32 v148, v136, v137
  v_cvt_pk_bf16_f32 v149, v138, v139
  v_mfma_f32_32x32x16_bf16 v[96:111], a[104:107], v[144:147], v[96:111]
  s_add_u32 m0, s0, 12288
  v_exp_f32 v140, v140
  v_exp_f32 v141, v141
  v_exp_f32 v142, v142
  v_exp_f32 v143, v143
  v_cvt_pk_bf16_f32 v150, v140, v141
  v_cvt_pk_bf16_f32 v151, v142, v143
  v_mfma_f32_32x32x16_bf16 v[128:143], a[112:115], v[24:27], 0
  global_load_lds_dwordx4 v216, s[62:63] offset:0
  ds_read_b64_tr_b16 a[128:129], v220 offset:4096
  ds_read_b64_tr_b16 a[130:131], v220 offset:4608
  v_exp_f32 v112, v112
  v_exp_f32 v113, v113
  v_exp_f32 v114, v114
  v_exp_f32 v115, v115
  v_cvt_pk_bf16_f32 v144, v112, v113
  v_cvt_pk_bf16_f32 v145, v114, v115
  v_mfma_f32_32x32x16_bf16 v[96:111], a[108:111], v[148:151], v[96:111]
  s_add_u32 s60, s62, 114688
  v_exp_f32 v116, v116
  v_exp_f32 v117, v117
  v_exp_f32 v118, v118
  v_exp_f32 v119, v119
  v_cvt_pk_bf16_f32 v146, v116, v117
  v_cvt_pk_bf16_f32 v147, v118, v119
  v_mfma_f32_32x32x16_bf16 v[128:143], a[116:119], v[28:31], v[128:143]
  global_load_lds_dwordx4 v217, s[62:63] offset:1024
  ds_read_b64_tr_b16 a[132:133], v221 offset:4096
  ds_read_b64_tr_b16 a[134:135], v221 offset:4608
  v_exp_f32 v120, v120
  v_exp_f32 v121, v121
  v_exp_f32 v122, v122
  v_exp_f32 v123, v123
  v_cvt_pk_bf16_f32 v148, v120, v121
  v_cvt_pk_bf16_f32 v149, v122, v123
  v_mfma_f32_32x32x16_bf16 v[48:63], a[120:123], v[144:147], v[48:63]
  s_addc_u32 s61, s63, 0
  v_exp_f32 v124, v124
  v_exp_f32 v125, v125
  v_exp_f32 v126, v126
  v_exp_f32 v127, v127
  v_cvt_pk_bf16_f32 v150, v124, v125
  v_cvt_pk_bf16_f32 v151, v126, v127
  v_mfma_f32_32x32x16_bf16 v[112:127], a[112:115], v[32:35], 0
  global_load_lds_dwordx4 v218, s[62:63] offset:2048
  ds_read_b64_tr_b16 a[136:137], v220 offset:6144
  ds_read_b64_tr_b16 a[138:139], v220 offset:6656
  v_exp_f32 v128, v128
  v_exp_f32 v129, v129
  v_exp_f32 v130, v130
  v_exp_f32 v131, v131
  v_cvt_pk_bf16_f32 v144, v128, v129
  v_cvt_pk_bf16_f32 v145, v130, v131
  v_mfma_f32_32x32x16_bf16 v[48:63], a[124:127], v[148:151], v[48:63]
  s_waitcnt vmcnt(7) lgkmcnt(6)
  v_exp_f32 v132, v132
  v_exp_f32 v133, v133
  v_exp_f32 v134, v134
  v_exp_f32 v135, v135
  v_cvt_pk_bf16_f32 v146, v132, v133
  v_cvt_pk_bf16_f32 v147, v134, v135
  v_mfma_f32_32x32x16_bf16 v[112:127], a[116:119], v[36:39], v[112:127]
  global_load_lds_dwordx4 v219, s[62:63] offset:3072
  ds_read_b64_tr_b16 a[140:141], v221 offset:6144
  ds_read_b64_tr_b16 a[142:143], v221 offset:6656
  v_exp_f32 v136, v136
  v_exp_f32 v137, v137
  v_exp_f32 v138, v138
  v_exp_f32 v139, v139
  v_cvt_pk_bf16_f32 v148, v136, v137
  v_cvt_pk_bf16_f32 v149, v138, v139
  v_mfma_f32_32x32x16_bf16 v[64:79], a[120:123], v[144:147], v[64:79]
  s_add_u32 m0, s0, 8192
  v_exp_f32 v140, v140
  v_exp_f32 v141, v141
  v_exp_f32 v142, v142
  v_exp_f32 v143, v143
  v_cvt_pk_bf16_f32 v150, v140, v141
  v_cvt_pk_bf16_f32 v151, v142, v143
  v_mfma_f32_32x32x16_bf16 v[128:143], a[112:115], v[40:43], 0
  global_load_lds_dwordx4 v216, s[60:61] offset:0
  ds_read_b64_tr_b16 a[144:145], v220 offset:20480
  ds_read_b64_tr_b16 a[146:147], v220 offset:20992
  v_exp_f32 v112, v112
  v_exp_f32 v113, v113
  v_exp_f32 v114, v114
  v_exp_f32 v115, v115
  v_cvt_pk_bf16_f32 v144, v112, v113
  v_cvt_pk_bf16_f32 v145, v114, v115
  v_mfma_f32_32x32x16_bf16 v[64:79], a[124:127], v[148:151], v[64:79]
  s_add_u32 s62, s60, 114688
  v_exp_f32 v116, v116
  v_exp_f32 v117, v117
  v_exp_f32 v118, v118
  v_exp_f32 v119, v119
  v_cvt_pk_bf16_f32 v146, v116, v117
  v_cvt_pk_bf16_f32 v147, v118, v119
  v_mfma_f32_32x32x16_bf16 v[128:143], a[116:119], v[44:47], v[128:143]
  global_load_lds_dwordx4 v217, s[60:61] offset:1024
  ds_read_b64_tr_b16 a[148:149], v221 offset:20480
  ds_read_b64_tr_b16 a[150:151], v221 offset:20992
  v_exp_f32 v120, v120
  v_exp_f32 v121, v121
  v_exp_f32 v122, v122
  v_exp_f32 v123, v123
  v_cvt_pk_bf16_f32 v148, v120, v121
  v_cvt_pk_bf16_f32 v149, v122, v123
  v_mfma_f32_32x32x16_bf16 v[80:95], a[120:123], v[144:147], v[80:95]
  s_addc_u32 s63, s61, 0
  v_exp_f32 v124, v124
  v_exp_f32 v125, v125
  v_exp_f32 v126, v126
  v_exp_f32 v127, v127
  v_cvt_pk_bf16_f32 v150, v124, v125
  v_cvt_pk_bf16_f32 v151, v126, v127
  v_mfma_f32_32x32x16_bf16 v[112:127], v[152:155], v[16:19], 0
  global_load_lds_dwordx4 v218, s[60:61] offset:2048
  ds_read_b64_tr_b16 a[152:153], v220 offset:22528
  ds_read_b64_tr_b16 a[154:155], v220 offset:23040
  v_exp_f32 v128, v128
  v_exp_f32 v129, v129
  v_exp_f32 v130, v130
  v_exp_f32 v131, v131
  v_cvt_pk_bf16_f32 v144, v128, v129
  v_cvt_pk_bf16_f32 v145, v130, v131
  v_mfma_f32_32x32x16_bf16 v[80:95], a[124:127], v[148:151], v[80:95]
  s_waitcnt vmcnt(7) lgkmcnt(6)
  v_exp_f32 v132, v132
  v_exp_f32 v133, v133
  v_exp_f32 v134, v134
  v_exp_f32 v135, v135
  v_cvt_pk_bf16_f32 v146, v132, v133
  v_cvt_pk_bf16_f32 v147, v134, v135
  v_mfma_f32_32x32x16_bf16 v[112:127], v[156:159], v[20:23], v[112:127]
  global_load_lds_dwordx4 v219, s[60:61] offset:3072
  ds_read_b64_tr_b16 a[156:157], v221 offset:22528
  ds_read_b64_tr_b16 a[158:159], v221 offset:23040
  v_exp_f32 v136, v136
  v_exp_f32 v137, v137
  v_exp_f32 v138, v138
  v_exp_f32 v139, v139
  v_cvt_pk_bf16_f32 v148, v136, v137
  v_cvt_pk_bf16_f32 v149, v138, v139
  v_mfma_f32_32x32x16_bf16 v[96:111], a[120:123], v[144:147], v[96:111]
  s_add_u32 m0, s0, 4096
  v_exp_f32 v140, v140
  v_exp_f32 v141, v141
  v_exp_f32 v142, v142
  v_exp_f32 v143, v143
  v_cvt_pk_bf16_f32 v150, v140, v141
  v_cvt_pk_bf16_f32 v151, v142, v143
  v_mfma_f32_32x32x16_bf16 v[128:143], v[168:171], v[16:19], 0
  global_load_lds_dwordx4 v216, s[62:63] offset:0
  ds_read_b64_tr_b16 a[160:161], v220 offset:16384
  ds_read_b64_tr_b16 a[162:163], v220 offset:16896
  v_exp_f32 v112, v112
  v_exp_f32 v113, v113
  v_exp_f32 v114, v114
  v_exp_f32 v115, v115
  v_cvt_pk_bf16_f32 v144, v112, v113
  v_cvt_pk_bf16_f32 v145, v114, v115
  v_mfma_f32_32x32x16_bf16 v[96:111], a[124:127], v[148:151], v[96:111]
  s_add_u32 s60, s62, 114688
  v_exp_f32 v116, v116
  v_exp_f32 v117, v117
  v_exp_f32 v118, v118
  v_exp_f32 v119, v119
  v_cvt_pk_bf16_f32 v146, v116, v117
  v_cvt_pk_bf16_f32 v147, v118, v119
  v_mfma_f32_32x32x16_bf16 v[128:143], v[172:175], v[20:23], v[128:143]
  global_load_lds_dwordx4 v217, s[62:63] offset:1024
  ds_read_b64_tr_b16 a[164:165], v221 offset:16384
  ds_read_b64_tr_b16 a[166:167], v221 offset:16896
  v_exp_f32 v120, v120
  v_exp_f32 v121, v121
  v_exp_f32 v122, v122
  v_exp_f32 v123, v123
  v_cvt_pk_bf16_f32 v148, v120, v121
  v_cvt_pk_bf16_f32 v149, v122, v123
  v_mfma_f32_32x32x16_bf16 v[48:63], v[160:163], v[144:147], v[48:63]
  s_addc_u32 s61, s63, 0
  v_exp_f32 v124, v124
  v_exp_f32 v125, v125
  v_exp_f32 v126, v126
  v_exp_f32 v127, v127
  v_cvt_pk_bf16_f32 v150, v124, v125
  v_cvt_pk_bf16_f32 v151, v126, v127
  v_mfma_f32_32x32x16_bf16 v[112:127], v[184:187], v[16:19], 0
  global_load_lds_dwordx4 v218, s[62:63] offset:2048
  ds_read_b64_tr_b16 a[168:169], v220 offset:18432
  ds_read_b64_tr_b16 a[170:171], v220 offset:18944
  v_exp_f32 v128, v128
  v_exp_f32 v129, v129
  v_exp_f32 v130, v130
  v_exp_f32 v131, v131
  v_cvt_pk_bf16_f32 v144, v128, v129
  v_cvt_pk_bf16_f32 v145, v130, v131
  v_mfma_f32_32x32x16_bf16 v[48:63], v[164:167], v[148:151], v[48:63]
  s_waitcnt vmcnt(7)
  v_exp_f32 v132, v132
  v_exp_f32 v133, v133
  v_exp_f32 v134, v134
  v_exp_f32 v135, v135
  v_cvt_pk_bf16_f32 v146, v132, v133
  v_cvt_pk_bf16_f32 v147, v134, v135
  v_mfma_f32_32x32x16_bf16 v[112:127], v[188:191], v[20:23], v[112:127]
  global_load_lds_dwordx4 v219, s[62:63] offset:3072
  ds_read_b64_tr_b16 a[172:173], v221 offset:18432
  ds_read_b64_tr_b16 a[174:175], v221 offset:18944
  v_exp_f32 v136, v136
  v_exp_f32 v137, v137
  v_exp_f32 v138, v138
  v_exp_f32 v139, v139
  v_cvt_pk_bf16_f32 v148, v136, v137
  v_cvt_pk_bf16_f32 v149, v138, v139
  v_mfma_f32_32x32x16_bf16 v[48:63], v[176:179], v[144:147], v[48:63]
  s_add_u32 m0, s0, 0
  v_exp_f32 v140, v140
  v_exp_f32 v141, v141
  v_exp_f32 v142, v142
  v_exp_f32 v143, v143
  v_cvt_pk_bf16_f32 v150, v140, v141
  v_cvt_pk_bf16_f32 v151, v142, v143
  v_mfma_f32_32x32x16_bf16 v[128:143], v[200:203], v[16:19], 0
  global_load_lds_dwordx4 v216, s[60:61] offset:0
  ds_read_b64_tr_b16 a[176:177], v220 offset:12288
  ds_read_b64_tr_b16 a[178:179], v220 offset:12800
  v_exp_f32 v112, v112
  v_exp_f32 v113, v113
  v_exp_f32 v114, v114
  v_exp_f32 v115, v115
  v_cvt_pk_bf16_f32 v144, v112, v113
  v_cvt_pk_bf16_f32 v145, v114, v115
  v_mfma_f32_32x32x16_bf16 v[48:63], v[180:183], v[148:151], v[48:63]
  s_add_u32 s62, s60, 114688
  v_exp_f32 v116, v116
  v_exp_f32 v117, v117
  v_exp_f32 v118, v118
  v_exp_f32 v119, v119
  v_cvt_pk_bf16_f32 v146, v116, v117
  v_cvt_pk_bf16_f32 v147, v118, v119
  v_mfma_f32_32x32x16_bf16 v[128:143], v[204:207], v[20:23], v[128:143]
  global_load_lds_dwordx4 v217, s[60:61] offset:1024
  ds_read_b64_tr_b16 a[180:181], v221 offset:12288
  ds_read_b64_tr_b16 a[182:183], v221 offset:12800
  v_exp_f32 v120, v120
  v_exp_f32 v121, v121
  v_exp_f32 v122, v122
  v_exp_f32 v123, v123
  v_cvt_pk_bf16_f32 v148, v120, v121
  v_cvt_pk_bf16_f32 v149, v122, v123
  v_mfma_f32_32x32x16_bf16 v[48:63], v[192:195], v[144:147], v[48:63]
  s_addc_u32 s63, s61, 0
  v_exp_f32 v124, v124
  v_exp_f32 v125, v125
  v_exp_f32 v126, v126
  v_exp_f32 v127, v127
  v_cvt_pk_bf16_f32 v150, v124, v125
  v_cvt_pk_bf16_f32 v151, v126, v127
  v_mfma_f32_32x32x16_bf16 v[112:127], v[152:155], v[24:27], 0
  global_load_lds_dwordx4 v218, s[60:61] offset:2048
  ds_read_b64_tr_b16 a[184:185], v220 offset:14336
  ds_read_b64_tr_b16 a[186:187], v220 offset:14848
  v_exp_f32 v128, v128
  v_exp_f32 v129, v129
  v_exp_f32 v130, v130
  v_exp_f32 v131, v131
  v_cvt_pk_bf16_f32 v144, v128, v129
  v_cvt_pk_bf16_f32 v145, v130, v131
  v_mfma_f32_32x32x16_bf16 v[48:63], v[196:199], v[148:151], v[48:63]
  s_waitcnt vmcnt(7)
  v_exp_f32 v132, v132
  v_exp_f32 v133, v133
  v_exp_f32 v134, v134
  v_exp_f32 v135, v135
  v_cvt_pk_bf16_f32 v146, v132, v133
  v_cvt_pk_bf16_f32 v147, v134, v135
  v_mfma_f32_32x32x16_bf16 v[112:127], v[156:159], v[28:31], v[112:127]
  global_load_lds_dwordx4 v219, s[60:61] offset:3072
  ds_read_b64_tr_b16 a[188:189], v221 offset:14336
  ds_read_b64_tr_b16 a[190:191], v221 offset:14848
  v_exp_f32 v136, v136
  v_exp_f32 v137, v137
  v_exp_f32 v138, v138
  v_exp_f32 v139, v139
  v_cvt_pk_bf16_f32 v148, v136, v137
  v_cvt_pk_bf16_f32 v149, v138, v139
  v_mfma_f32_32x32x16_bf16 v[48:63], v[208:211], v[144:147], v[48:63]
  v_exp_f32 v140, v140
  v_exp_f32 v141, v141
  v_exp_f32 v142, v142
  v_exp_f32 v143, v143
  v_cvt_pk_bf16_f32 v150, v140, v141
  v_cvt_pk_bf16_f32 v151, v142, v143
  v_mfma_f32_32x32x16_bf16 v[128:143], v[168:171], v[24:27], 0
  ds_read_b64_tr_b16 a[0:1], v220 offset:8192
  ds_read_b64_tr_b16 a[2:3], v220 offset:8704
  v_exp_f32 v112, v112
  v_exp_f32 v113, v113
  v_exp_f32 v114, v114
  v_exp_f32 v115, v115
  v_cvt_pk_bf16_f32 v144, v112, v113
  v_cvt_pk_bf16_f32 v145, v114, v115
  v_mfma_f32_32x32x16_bf16 v[48:63], v[212:215], v[148:151], v[48:63]
  v_exp_f32 v116, v116
  v_exp_f32 v117, v117
  v_exp_f32 v118, v118
  v_exp_f32 v119, v119
  v_cvt_pk_bf16_f32 v146, v116, v117
  v_cvt_pk_bf16_f32 v147, v118, v119
  v_mfma_f32_32x32x16_bf16 v[128:143], v[172:175], v[28:31], v[128:143]
  ds_read_b64_tr_b16 a[4:5], v221 offset:8192
  ds_read_b64_tr_b16 a[6:7], v221 offset:8704
  v_exp_f32 v120, v120
  v_exp_f32 v121, v121
  v_exp_f32 v122, v122
  v_exp_f32 v123, v123
  v_cvt_pk_bf16_f32 v148, v120, v121
  v_cvt_pk_bf16_f32 v149, v122, v123
  v_mfma_f32_32x32x16_bf16 v[64:79], v[160:163], v[144:147], v[64:79]
  v_exp_f32 v124, v124
  v_exp_f32 v125, v125
  v_exp_f32 v126, v126
  v_exp_f32 v127, v127
  v_cvt_pk_bf16_f32 v150, v124, v125
  v_cvt_pk_bf16_f32 v151, v126, v127
  v_mfma_f32_32x32x16_bf16 v[112:127], v[184:187], v[24:27], 0
  ds_read_b64_tr_b16 a[8:9], v220 offset:10240
  ds_read_b64_tr_b16 a[10:11], v220 offset:10752
  v_exp_f32 v128, v128
  v_exp_f32 v129, v129
  v_exp_f32 v130, v130
  v_exp_f32 v131, v131
  v_cvt_pk_bf16_f32 v144, v128, v129
  v_cvt_pk_bf16_f32 v145, v130, v131
  v_mfma_f32_32x32x16_bf16 v[64:79], v[164:167], v[148:151], v[64:79]
  s_waitcnt vmcnt(4)
  buffer_load_dwordx4 v[232:235], v229, s[12:15], s69 offen sc1
  v_exp_f32 v132, v132
  v_exp_f32 v133, v133
  v_exp_f32 v134, v134
  v_exp_f32 v135, v135
  v_cvt_pk_bf16_f32 v146, v132, v133
  v_cvt_pk_bf16_f32 v147, v134, v135
  v_mfma_f32_32x32x16_bf16 v[112:127], v[188:191], v[28:31], v[112:127]
  ds_read_b64_tr_b16 a[12:13], v221 offset:10240
  ds_read_b64_tr_b16 a[14:15], v221 offset:10752
  v_exp_f32 v136, v136
  v_exp_f32 v137, v137
  v_exp_f32 v138, v138
  v_exp_f32 v139, v139
  v_cvt_pk_bf16_f32 v148, v136, v137
  v_cvt_pk_bf16_f32 v149, v138, v139
  v_mfma_f32_32x32x16_bf16 v[64:79], v[176:179], v[144:147], v[64:79]
  v_exp_f32 v140, v140
  v_exp_f32 v141, v141
  v_exp_f32 v142, v142
  v_exp_f32 v143, v143
  v_cvt_pk_bf16_f32 v150, v140, v141
  v_cvt_pk_bf16_f32 v151, v142, v143
  v_mfma_f32_32x32x16_bf16 v[128:143], v[200:203], v[24:27], 0
  ds_read_b64_tr_b16 a[16:17], v220 offset:4096
  ds_read_b64_tr_b16 a[18:19], v220 offset:4608
  v_exp_f32 v112, v112
  v_exp_f32 v113, v113
  v_exp_f32 v114, v114
  v_exp_f32 v115, v115
  v_cvt_pk_bf16_f32 v144, v112, v113
  v_cvt_pk_bf16_f32 v145, v114, v115
  v_mfma_f32_32x32x16_bf16 v[64:79], v[180:183], v[148:151], v[64:79]
  s_waitcnt lgkmcnt(2)
  v_exp_f32 v116, v116
  v_exp_f32 v117, v117
  v_exp_f32 v118, v118
  v_exp_f32 v119, v119
  v_cvt_pk_bf16_f32 v146, v116, v117
  v_cvt_pk_bf16_f32 v147, v118, v119
  v_mfma_f32_32x32x16_bf16 v[128:143], v[204:207], v[28:31], v[128:143]
  ds_read_b64_tr_b16 a[20:21], v221 offset:4096
  ds_read_b64_tr_b16 a[22:23], v221 offset:4608
  v_exp_f32 v120, v120
  v_exp_f32 v121, v121
  v_exp_f32 v122, v122
  v_exp_f32 v123, v123
  v_cvt_pk_bf16_f32 v148, v120, v121
  v_cvt_pk_bf16_f32 v149, v122, v123
  v_mfma_f32_32x32x16_bf16 v[64:79], v[192:195], v[144:147], v[64:79]
  s_add_u32 m0, s0, 8192
  v_exp_f32 v124, v124
  v_exp_f32 v125, v125
  v_exp_f32 v126, v126
  v_exp_f32 v127, v127
  v_cvt_pk_bf16_f32 v150, v124, v125
  v_cvt_pk_bf16_f32 v151, v126, v127
  v_mfma_f32_32x32x16_bf16 v[112:127], v[152:155], v[32:35], 0
  global_load_lds_dwordx4 v216, s[62:63] offset:0
  ds_read_b64_tr_b16 a[24:25], v220 offset:6144
  ds_read_b64_tr_b16 a[26:27], v220 offset:6656
  v_exp_f32 v128, v128
  v_exp_f32 v129, v129
  v_exp_f32 v130, v130
  v_exp_f32 v131, v131
  v_cvt_pk_bf16_f32 v144, v128, v129
  v_cvt_pk_bf16_f32 v145, v130, v131
  v_mfma_f32_32x32x16_bf16 v[64:79], v[196:199], v[148:151], v[64:79]
  s_waitcnt vmcnt(2)
  s_add_u32 s60, s62, 114688
  v_exp_f32 v132, v132
  v_exp_f32 v133, v133
  v_exp_f32 v134, v134
  v_exp_f32 v135, v135
  v_cvt_pk_bf16_f32 v146, v132, v133
  v_cvt_pk_bf16_f32 v147, v134, v135
  v_mfma_f32_32x32x16_bf16 v[112:127], v[156:159], v[36:39], v[112:127]
  global_load_lds_dwordx4 v217, s[62:63] offset:1024
  ds_read_b64_tr_b16 a[28:29], v221 offset:6144
  ds_read_b64_tr_b16 a[30:31], v221 offset:6656
  v_exp_f32 v136, v136
  v_exp_f32 v137, v137
  v_exp_f32 v138, v138
  v_exp_f32 v139, v139
  v_cvt_pk_bf16_f32 v148, v136, v137
  v_cvt_pk_bf16_f32 v149, v138, v139
  v_mfma_f32_32x32x16_bf16 v[64:79], v[208:211], v[144:147], v[64:79]
  s_addc_u32 s61, s63, 0
  v_exp_f32 v140, v140
  v_exp_f32 v141, v141
  v_exp_f32 v142, v142
  v_exp_f32 v143, v143
  v_cvt_pk_bf16_f32 v150, v140, v141
  v_cvt_pk_bf16_f32 v151, v142, v143
  v_mfma_f32_32x32x16_bf16 v[128:143], v[168:171], v[32:35], 0
  global_load_lds_dwordx4 v218, s[62:63] offset:2048
  ds_read_b64_tr_b16 a[32:33], v220 offset:0
  ds_read_b64_tr_b16 a[34:35], v220 offset:512
  v_exp_f32 v112, v112
  v_exp_f32 v113, v113
  v_exp_f32 v114, v114
  v_exp_f32 v115, v115
  v_cvt_pk_bf16_f32 v144, v112, v113
  v_cvt_pk_bf16_f32 v145, v114, v115
  v_mfma_f32_32x32x16_bf16 v[64:79], v[212:215], v[148:151], v[64:79]
  s_waitcnt lgkmcnt(2)
  v_exp_f32 v116, v116
  v_exp_f32 v117, v117
  v_exp_f32 v118, v118
  v_exp_f32 v119, v119
  v_cvt_pk_bf16_f32 v146, v116, v117
  v_cvt_pk_bf16_f32 v147, v118, v119
  v_mfma_f32_32x32x16_bf16 v[128:143], v[172:175], v[36:39], v[128:143]
  global_load_lds_dwordx4 v219, s[62:63] offset:3072
  ds_read_b64_tr_b16 a[36:37], v221 offset:0
  ds_read_b64_tr_b16 a[38:39], v221 offset:512
  v_exp_f32 v120, v120
  v_exp_f32 v121, v121
  v_exp_f32 v122, v122
  v_exp_f32 v123, v123
  v_cvt_pk_bf16_f32 v148, v120, v121
  v_cvt_pk_bf16_f32 v149, v122, v123
  v_mfma_f32_32x32x16_bf16 v[80:95], v[160:163], v[144:147], v[80:95]
  s_add_u32 m0, s0, 4096
  s_barrier
  v_exp_f32 v124, v124
  v_exp_f32 v125, v125
  v_exp_f32 v126, v126
  v_exp_f32 v127, v127
  v_cvt_pk_bf16_f32 v150, v124, v125
  v_cvt_pk_bf16_f32 v151, v126, v127
  v_mfma_f32_32x32x16_bf16 v[112:127], v[184:187], v[32:35], 0
  global_load_lds_dwordx4 v216, s[60:61] offset:0
  ds_read_b64_tr_b16 a[40:41], v220 offset:2048
  ds_read_b64_tr_b16 a[42:43], v220 offset:2560
  v_exp_f32 v128, v128
  v_exp_f32 v129, v129
  v_exp_f32 v130, v130
  v_exp_f32 v131, v131
  v_cvt_pk_bf16_f32 v144, v128, v129
  v_cvt_pk_bf16_f32 v145, v130, v131
  v_mfma_f32_32x32x16_bf16 v[80:95], v[164:167], v[148:151], v[80:95]
  s_add_u32 s62, s60, 114688
  ds_write_b128 v236, v[48:51] offset:0
  v_exp_f32 v132, v132
  v_exp_f32 v133, v133
  v_exp_f32 v134, v134
  v_exp_f32 v135, v135
  v_cvt_pk_bf16_f32 v146, v132, v133
  v_cvt_pk_bf16_f32 v147, v134, v135
  v_mfma_f32_32x32x16_bf16 v[112:127], v[188:191], v[36:39], v[112:127]
  global_load_lds_dwordx4 v217, s[60:61] offset:1024
  ds_read_b64_tr_b16 a[44:45], v221 offset:2048
  ds_read_b64_tr_b16 a[46:47], v221 offset:2560
  v_exp_f32 v136, v136
  v_exp_f32 v137, v137
  v_exp_f32 v138, v138
  v_exp_f32 v139, v139
  v_cvt_pk_bf16_f32 v148, v136, v137
  v_cvt_pk_bf16_f32 v149, v138, v139
  v_mfma_f32_32x32x16_bf16 v[80:95], v[176:179], v[144:147], v[80:95]
  s_addc_u32 s63, s61, 0
  ds_write_b128 v236, v[52:55] offset:1024
  v_exp_f32 v140, v140
  v_exp_f32 v141, v141
  v_exp_f32 v142, v142
  v_exp_f32 v143, v143
  v_cvt_pk_bf16_f32 v150, v140, v141
  v_cvt_pk_bf16_f32 v151, v142, v143
  v_mfma_f32_32x32x16_bf16 v[128:143], v[200:203], v[32:35], 0
  global_load_lds_dwordx4 v218, s[60:61] offset:2048
  v_exp_f32 v112, v112
  v_exp_f32 v113, v113
  v_exp_f32 v114, v114
  v_exp_f32 v115, v115
  v_cvt_pk_bf16_f32 v144, v112, v113
  v_cvt_pk_bf16_f32 v145, v114, v115
  v_mfma_f32_32x32x16_bf16 v[80:95], v[180:183], v[148:151], v[80:95]
  s_waitcnt lgkmcnt(1)
  ds_write_b128 v236, v[56:59] offset:2048
  v_exp_f32 v116, v116
  v_exp_f32 v117, v117
  v_exp_f32 v118, v118
  v_exp_f32 v119, v119
  v_cvt_pk_bf16_f32 v146, v116, v117
  v_cvt_pk_bf16_f32 v147, v118, v119
  v_mfma_f32_32x32x16_bf16 v[128:143], v[204:207], v[36:39], v[128:143]
  global_load_lds_dwordx4 v219, s[60:61] offset:3072
  v_exp_f32 v120, v120
  v_exp_f32 v121, v121
  v_exp_f32 v122, v122
  v_exp_f32 v123, v123
  v_cvt_pk_bf16_f32 v148, v120, v121
  v_cvt_pk_bf16_f32 v149, v122, v123
  v_mfma_f32_32x32x16_bf16 v[80:95], v[192:195], v[144:147], v[80:95]
  s_add_u32 m0, s0, 0
  ds_write_b128 v236, v[60:63] offset:3072
  v_exp_f32 v124, v124
  v_exp_f32 v125, v125
  v_exp_f32 v126, v126
  v_exp_f32 v127, v127
  v_cvt_pk_bf16_f32 v150, v124, v125
  v_cvt_pk_bf16_f32 v151, v126, v127
  v_mfma_f32_32x32x16_bf16 v[112:127], v[152:155], v[40:43], 0
  global_load_lds_dwordx4 v216, s[62:63] offset:0
  v_exp_f32 v128, v128
  v_exp_f32 v129, v129
  v_exp_f32 v130, v130
  v_exp_f32 v131, v131
  v_cvt_pk_bf16_f32 v144, v128, v129
  v_cvt_pk_bf16_f32 v145, v130, v131
  v_mfma_f32_32x32x16_bf16 v[80:95], v[196:199], v[148:151], v[80:95]
  s_add_u32 s60, s62, 114688
  ds_write_b128 v237, v[64:67] offset:4096
  v_exp_f32 v132, v132
  v_exp_f32 v133, v133
  v_exp_f32 v134, v134
  v_exp_f32 v135, v135
  v_cvt_pk_bf16_f32 v146, v132, v133
  v_cvt_pk_bf16_f32 v147, v134, v135
  v_mfma_f32_32x32x16_bf16 v[112:127], v[156:159], v[44:47], v[112:127]
  global_load_lds_dwordx4 v217, s[62:63] offset:1024
  v_exp_f32 v136, v136
  v_exp_f32 v137, v137
  v_exp_f32 v138, v138
  v_exp_f32 v139, v139
  v_cvt_pk_bf16_f32 v148, v136, v137
  v_cvt_pk_bf16_f32 v149, v138, v139
  v_mfma_f32_32x32x16_bf16 v[80:95], v[208:211], v[144:147], v[80:95]
  s_addc_u32 s61, s63, 0
  ds_write_b128 v237, v[68:71] offset:5120
L_padx0_4:
  s_cbranch_execz L_tour0
  v_exp_f32 v140, v140
  v_exp_f32 v141, v141
  v_exp_f32 v142, v142
  v_exp_f32 v143, v143
  v_cvt_pk_bf16_f32 v150, v140, v141
  v_cvt_pk_bf16_f32 v151, v142, v143
  v_mfma_f32_32x32x16_bf16 v[128:143], v[168:171], v[40:43], 0
  global_load_lds_dwordx4 v218, s[62:63] offset:2048
  v_exp_f32 v112, v112
  v_exp_f32 v113, v113
  v_exp_f32 v114, v114
  v_exp_f32 v115, v115
  v_cvt_pk_bf16_f32 v144, v112, v113
  v_cvt_pk_bf16_f32 v145, v114, v115
  v_mfma_f32_32x32x16_bf16 v[80:95], v[212:215], v[148:151], v[80:95]
  ds_write_b128 v237, v[72:75] offset:6144
  v_exp_f32 v116, v116
  v_exp_f32 v117, v117
  v_exp_f32 v118, v118
  v_exp_f32 v119, v119
  v_cvt_pk_bf16_f32 v146, v116, v117
  v_cvt_pk_bf16_f32 v147, v118, v119
  v_mfma_f32_32x32x16_bf16 v[128:143], v[172:175], v[44:47], v[128:143]
  global_load_lds_dwordx4 v219, s[62:63] offset:3072
  v_exp_f32 v120, v120
  v_exp_f32 v121, v121
  v_exp_f32 v122, v122
  v_exp_f32 v123, v123
  v_cvt_pk_bf16_f32 v148, v120, v121
  v_cvt_pk_bf16_f32 v149, v122, v123
  v_mfma_f32_32x32x16_bf16 v[96:111], v[160:163], v[144:147], v[96:111]
  ds_write_b128 v237, v[76:79] offset:7168
  v_exp_f32 v124, v124
  v_exp_f32 v125, v125
  v_exp_f32 v126, v126
  v_exp_f32 v127, v127
  v_cvt_pk_bf16_f32 v150, v124, v125
  v_cvt_pk_bf16_f32 v151, v126, v127
  v_mfma_f32_32x32x16_bf16 v[112:127], v[184:187], v[40:43], 0
  s_waitcnt vmcnt(12)
  v_min3_u32 v2, v232, v233, v234
  v_min_u32 v2, v2, v235
  v_cmp_ne_u32 vcc, -1, v2
  v_exp_f32 v128, v128
  v_exp_f32 v129, v129
  v_exp_f32 v130, v130
  v_exp_f32 v131, v131
  v_cvt_pk_bf16_f32 v144, v128, v129
  v_cvt_pk_bf16_f32 v145, v130, v131
  v_mfma_f32_32x32x16_bf16 v[96:111], v[164:167], v[148:151], v[96:111]
  s_cbranch_vccnz L_cnr_22
L_cn_21:
  ds_write_b128 v238, v[80:83] offset:8192
  v_exp_f32 v132, v132
  v_exp_f32 v133, v133
  v_exp_f32 v134, v134
  v_exp_f32 v135, v135
  v_cvt_pk_bf16_f32 v146, v132, v133
  v_cvt_pk_bf16_f32 v147, v134, v135
  v_mfma_f32_32x32x16_bf16 v[112:127], v[188:191], v[44:47], v[112:127]
  s_waitcnt lgkmcnt(1)
  s_barrier
  v_exp_f32 v136, v136
  v_exp_f32 v137, v137
  v_exp_f32 v138, v138
  v_exp_f32 v139, v139
  v_cvt_pk_bf16_f32 v148, v136, v137
  v_cvt_pk_bf16_f32 v149, v138, v139
  v_mfma_f32_32x32x16_bf16 v[96:111], v[176:179], v[144:147], v[96:111]
  ds_write_b128 v238, v[84:87] offset:9216
  v_exp_f32 v140, v140
  v_exp_f32 v141, v141
  v_exp_f32 v142, v142
  v_exp_f32 v143, v143
  v_cvt_pk_bf16_f32 v150, v140, v141
  v_cvt_pk_bf16_f32 v151, v142, v143
  v_mfma_f32_32x32x16_bf16 v[128:143], v[200:203], v[40:43], 0
  ds_write_b128 v238, v[88:91] offset:10240
  v_exp_f32 v112, v112
  v_exp_f32 v113, v113
  v_exp_f32 v114, v114
  v_exp_f32 v115, v115
  v_cvt_pk_bf16_f32 v144, v112, v113
  v_cvt_pk_bf16_f32 v145, v114, v115
  v_mfma_f32_32x32x16_bf16 v[96:111], v[180:183], v[148:151], v[96:111]
  ds_read_b128 v[48:51], v239 offset:12288
  ds_read_b128 v[52:55], v239 offset:13312
  ds_read_b128 v[56:59], v239 offset:14336
  ds_read_b128 v[60:63], v239 offset:15360
  v_exp_f32 v116, v116
  v_exp_f32 v117, v117
  v_exp_f32 v118, v118
  v_exp_f32 v119, v119
  v_cvt_pk_bf16_f32 v146, v116, v117
  v_cvt_pk_bf16_f32 v147, v118, v119
  v_mfma_f32_32x32x16_bf16 v[128:143], v[204:207], v[44:47], v[128:143]
  ds_write_b128 v238, v[92:95] offset:11264
  v_exp_f32 v120, v120
  v_exp_f32 v121, v121
  v_exp_f32 v122, v122
  v_exp_f32 v123, v123
  v_cvt_pk_bf16_f32 v148, v120, v121
  v_cvt_pk_bf16_f32 v149, v122, v123
  v_mfma_f32_32x32x16_bf16 v[96:111], v[192:195], v[144:147], v[96:111]
  ds_read_b128 v[64:67], v239 offset:16384
  ds_read_b128 v[68:71], v239 offset:17408
  ds_read_b128 v[72:75], v239 offset:18432
  ds_read_b128 v[76:79], v239 offset:19456
  s_mov_b64 exec, 1
  buffer_store_dword v1, off, s[20:23], s2 sc1
  s_mov_b64 exec, -1
  v_exp_f32 v124, v124
  v_exp_f32 v125, v125
  v_exp_f32 v126, v126
  v_exp_f32 v127, v127
  v_cvt_pk_bf16_f32 v150, v124, v125
  v_cvt_pk_bf16_f32 v151, v126, v127
  v_exp_f32 v128, v128
  v_exp_f32 v129, v129
  v_exp_f32 v130, v130
  v_exp_f32 v131, v131
  v_cvt_pk_bf16_f32 v144, v128, v129
  v_cvt_pk_bf16_f32 v145, v130, v131
  v_mfma_f32_32x32x16_bf16 v[96:111], v[196:199], v[148:151], v[96:111]
  s_waitcnt lgkmcnt(0)
  s_barrier
  ds_read_b128 v[80:83], v239 offset:20480
  ds_read_b128 v[84:87], v239 offset:21504
  ds_read_b128 v[88:91], v239 offset:22528
  ds_read_b128 v[92:95], v239 offset:23552
  v_exp_f32 v132, v132
  v_exp_f32 v133, v133
  v_exp_f32 v134, v134
  v_exp_f32 v135, v135
  v_cvt_pk_bf16_f32 v146, v132, v133
  v_cvt_pk_bf16_f32 v147, v134, v135
  v_exp_f32 v136, v136
  v_exp_f32 v137, v137
  v_exp_f32 v138, v138
  v_exp_f32 v139, v139
  v_cvt_pk_bf16_f32 v148, v136, v137
  v_cvt_pk_bf16_f32 v149, v138, v139
  v_mfma_f32_32x32x16_bf16 v[96:111], v[208:211], v[144:147], v[96:111]
  v_exp_f32 v140, v140
  v_exp_f32 v141, v141
  v_exp_f32 v142, v142
  v_exp_f32 v143, v143
  v_cvt_pk_bf16_f32 v150, v140, v141
  v_cvt_pk_bf16_f32 v151, v142, v143
L_att_end:
  s_nop 1
  v_mfma_f32_32x32x16_bf16 v[96:111], v[212:215], v[148:151], v[96:111]
  s_waitcnt lgkmcnt(0)
  v_pk_add_f32 v[48:49], v[48:49], v[64:65]
  v_pk_add_f32 v[50:51], v[50:51], v[66:67]
  v_pk_add_f32 v[52:53], v[52:53], v[68:69]
  v_pk_add_f32 v[54:55], v[54:55], v[70:71]
  v_pk_add_f32 v[56:57], v[56:57], v[72:73]
  v_pk_add_f32 v[58:59], v[58:59], v[74:75]
  v_pk_add_f32 v[60:61], v[60:61], v[76:77]
  v_pk_add_f32 v[62:63], v[62:63], v[78:79]
  v_pk_add_f32 v[48:49], v[48:49], v[80:81]
  v_pk_add_f32 v[50:51], v[50:51], v[82:83]
  v_pk_add_f32 v[52:53], v[52:53], v[84:85]
  v_pk_add_f32 v[54:55], v[54:55], v[86:87]
  v_pk_add_f32 v[56:57], v[56:57], v[88:89]
  v_pk_add_f32 v[58:59], v[58:59], v[90:91]
  v_pk_add_f32 v[60:61], v[60:61], v[92:93]
  v_pk_add_f32 v[62:63], v[62:63], v[94:95]
  v_pk_add_f32 v[108:109], v[108:109], v[60:61]
  v_mov_b32 v2, v108
  v_mov_b32 v4, v108
  v_mov_b32 v3, 0x5d800000
  v_pk_add_f32 v[96:97], v[96:97], v[48:49]
  v_permlane32_swap_b32 v2, v4
  v_med3_f32 v2, v4, s72, v3
  v_cmp_neq_f32 vcc, v2, v4
  v_pk_add_f32 v[98:99], v[98:99], v[50:51]
  v_pk_add_f32 v[100:101], v[100:101], v[52:53]
  v_pk_add_f32 v[102:103], v[102:103], v[54:55]
  v_pk_add_f32 v[104:105], v[104:105], v[56:57]
  v_pk_add_f32 v[106:107], v[106:107], v[58:59]
  v_pk_add_f32 v[110:111], v[110:111], v[62:63]
  s_cbranch_vccnz L_safe
L_safe_done:
  v_rcp_f32 v4, v4
  v_mov_b32 v3, 0
  v_pk_mul_f32 v[96:97], v[96:97], v[4:5] op_sel_hi:[1,0]
  v_pk_mul_f32 v[98:99], v[98:99], v[4:5] op_sel_hi:[1,0]
  v_pk_mul_f32 v[100:101], v[100:101], v[4:5] op_sel_hi:[1,0]
  v_pk_mul_f32 v[102:103], v[102:103], v[4:5] op_sel_hi:[1,0]
  v_cvt_pk_bf16_f32 v176, v96, v97
  v_cvt_pk_bf16_f32 v177, v98, v99
  v_cvt_pk_bf16_f32 v178, v100, v101
  v_cvt_pk_bf16_f32 v179, v102, v103
  v_min_u32 v176, -2, v176
  buffer_store_dwordx4 v[176:179], v7, s[12:15], s97 offen offset:0 sc1
  v_pk_mul_f32 v[104:105], v[104:105], v[4:5] op_sel_hi:[1,0]
  v_pk_mul_f32 v[106:107], v[106:107], v[4:5] op_sel_hi:[1,0]
  v_pk_mul_f32 v[108:109], v[108:109], v[4:5] op_sel_hi:[1,0]
  v_pk_mul_f32 v[110:111], v[110:111], v[4:5] op_sel_hi:[1,0]
  v_cvt_pk_bf16_f32 v180, v104, v105
  v_cvt_pk_bf16_f32 v181, v106, v107
  v_cvt_pk_bf16_f32 v182, v108, v109
  v_cvt_pk_bf16_f32 v183, v110, v111
  v_cndmask_b32 v182, v182, v3, s[74:75]
  v_cndmask_b32 v183, v183, v3, s[74:75]
  v_min_u32 v180, -2, v180
  buffer_store_dwordx4 v[180:183], v7, s[12:15], s97 offen offset:1024 sc1
  s_cmp_ge_u32 s7, 7
  s_cbranch_scc1 L_tail
  v_readlane_b32 s55, v230, 3
  s_add_u32 m0, s0, 12288
  s_add_u32 s59, s1, 1605632
  buffer_load_dwordx4 v216, s[28:31], s59 offen lds
  v_lshrrev_b32 v2, 3, v1
  v_mul_u32_u24 v8, 4096, v2
  v_lshrrev_b32 v2, 2, v1
  v_and_b32 v2, 4, v2
  v_and_b32 v3, 7, v1
  v_xor_b32 v2, v2, v3
  v_lshl_add_u32 v8, v2, 4, v8
  v_add_u32 v9, 31744, v8
  v_add_u32 v10, 63488, v8
  v_add_u32 v11, 95232, v8
  buffer_load_dwordx4 v217, s[28:31], s59 offen offset:1024 lds
  s_mul_i32 s54, s4, 1835008
  s_lshl_b32 s3, s8, 7
  s_add_u32 s54, s54, s3
  s_waitcnt vmcnt(13)
  ds_read_b64_tr_b16 a[48:49], v220 offset:8192
  ds_read_b64_tr_b16 a[50:51], v220 offset:8704
  ds_read_b64_tr_b16 a[52:53], v221 offset:8192
  ds_read_b64_tr_b16 a[54:55], v221 offset:8704
  ds_read_b64_tr_b16 a[56:57], v220 offset:10240
  ds_read_b64_tr_b16 a[58:59], v220 offset:10752
  buffer_load_dwordx4 v218, s[28:31], s59 offen offset:2048 lds
  ds_read_b64_tr_b16 a[60:61], v221 offset:10240
  ds_read_b64_tr_b16 a[62:63], v221 offset:10752
  s_waitcnt vmcnt(10)
  ds_read_b64_tr_b16 a[64:65], v220 offset:4096
  ds_read_b64_tr_b16 a[66:67], v220 offset:4608
  ds_read_b64_tr_b16 a[68:69], v221 offset:4096
  ds_read_b64_tr_b16 a[70:71], v221 offset:4608
  ds_read_b64_tr_b16 a[72:73], v220 offset:6144
  ds_read_b64_tr_b16 a[74:75], v220 offset:6656
  ds_read_b64_tr_b16 a[76:77], v221 offset:6144
  buffer_load_dwordx4 v219, s[28:31], s59 offen offset:3072 lds
  ds_read_b64_tr_b16 a[78:79], v221 offset:6656
  s_waitcnt vmcnt(7)
  ds_read_b64_tr_b16 a[80:81], v220 offset:0
  ds_read_b64_tr_b16 a[82:83], v220 offset:512
  ds_read_b64_tr_b16 a[84:85], v221 offset:0
  ds_read_b64_tr_b16 a[86:87], v221 offset:512
  ds_read_b64_tr_b16 a[88:89], v220 offset:2048
  ds_read_b64_tr_b16 a[90:91], v220 offset:2560
  ds_read_b64_tr_b16 a[92:93], v221 offset:2048
  ds_read_b64_tr_b16 a[94:95], v221 offset:2560
  s_add_u32 m0, s0, 16384
  s_add_u32 s59, s1, 1720320
  buffer_load_dwordx4 v216, s[28:31], s59 offen lds
  v_bfe_u32 v15, v1, 4, 1
  v_lshlrev_b32 v15, 5, v15
  v_and_b32 v5, 3, v1
  v_lshl_add_u32 v15, v5, 3, v15
  s_lshl_b32 s3, s10, 6
  v_add_u32 v5, s3, v15
  v_bfe_u32 v2, v1, 2, 2
  v_lshrrev_b32 v3, 5, v1
  v_lshl_add_u32 v3, v3, 2, v2
  v_lshrrev_b32 v2, 1, v2
  v_lshlrev_b32 v2, 6, v2
  v_xor_b32 v2, v2, v5
  v_lshl_add_u32 v12, v3, 7, v2
  buffer_load_dwordx4 v217, s[28:31], s59 offen offset:1024 lds
  v_add_u32 v12, s0, v12
  v_xor_b32 v13, 64, v12
  v_and_b32 v5, 32, v15
  s_lshl_b32 s3, s11, 5
  v_add3_u32 v15, v15, v5, s3
  v_bfe_u32 v2, v1, 2, 2
  v_lshrrev_b32 v3, 5, v1
  v_lshl_add_u32 v3, v3, 2, v2
  v_lshrrev_b32 v2, 1, v2
  v_lshlrev_b32 v2, 5, v2
  v_xor_b32 v2, v2, v15
  v_lshl_add_u32 v4, v3, 7, v2
  buffer_load_dwordx4 v218, s[28:31], s59 offen offset:2048 lds
  s_mul_i32 s3, s11, 28672
  v_add_u32 v4, s3, v4
  v_xor_b32 v5, 32, v4
  buffer_load_dword v6, v231, s[12:15], s67 offen sc1
  ds_read_b64_tr_b16 v[176:177], v4 offset:0
  ds_read_b64_tr_b16 v[178:179], v4 offset:1024
  ds_read_b64_tr_b16 v[180:181], v5 offset:0
  ds_read_b64_tr_b16 v[182:183], v5 offset:1024
  ds_read_b64_tr_b16 v[184:185], v4 offset:2048
  ds_read_b64_tr_b16 v[186:187], v4 offset:3072
  buffer_load_dwordx4 v219, s[28:31], s59 offen offset:3072 lds
  ds_read_b64_tr_b16 v[188:189], v5 offset:2048
  ds_read_b64_tr_b16 v[190:191], v5 offset:3072
  v_min_u32 v2, 6, v1
  v_lshlrev_b32 v15, 12, v2
  s_lshl_b32 s60, s8, 7
  s_add_u32 s60, s60, 9076736
  v_permlane32_swap_b32 v240, v242
  v_permlane32_swap_b32 v241, v243
  v_permlane32_swap_b32 v244, v246
  v_permlane32_swap_b32 v245, v247
  s_waitcnt lgkmcnt(8)
  s_add_u32 m0, s0, 0
  s_add_u32 s59, s54, 0
  buffer_load_dwordx4 v8, s[32:35], s59 offen lds
  v_lshlrev_b32 v192, 16, v240
  v_and_b32 v193, 0xffff0000, v240
  v_lshlrev_b32 v194, 16, v241
  v_and_b32 v195, 0xffff0000, v241
  v_lshlrev_b32 v196, 16, v242
  v_and_b32 v197, 0xffff0000, v242
  v_lshlrev_b32 v198, 16, v243
  v_and_b32 v199, 0xffff0000, v243
  v_lshlrev_b32 v200, 16, v244
  v_and_b32 v201, 0xffff0000, v244
  buffer_load_dwordx4 v9, s[32:35], s59 offen offset:1024 lds
  v_lshlrev_b32 v202, 16, v245
  v_and_b32 v203, 0xffff0000, v245
  v_lshlrev_b32 v204, 16, v246
  v_and_b32 v205, 0xffff0000, v246
  v_lshlrev_b32 v206, 16, v247
  v_and_b32 v207, 0xffff0000, v247
  v_add_u32 v243, s0, v7
  s_xor_b32 s3, s4, 2
  s_mul_i32 s3, s3, 24576
  s_add_u32 s3, s3, 59392
  v_add_u32 v244, s3, v7
  buffer_load_dwordx4 v10, s[32:35], s59 offen offset:2048 lds
  v_lshlrev_b32 v245, 3, v1
  s_lshl_b32 s62, s52, 12
  s_add_u32 s62, s62, 8388608
  s_lshl_b32 s61, s4, 13
  s_add_u32 s61, s61, 24576
  s_sub_u32 s3, s61, s0
  v_add_u32 v246, s3, v12
  v_xor_b32 v247, 64, v246
  v_and_b32 v2, 31, v1
  v_mul_u32_u24 v2, 72, v2
  v_lshrrev_b32 v3, 5, v1
  v_lshl_add_u32 v2, v3, 3, v2
  v_add_u32 v240, s0, v2
  buffer_load_dwordx4 v11, s[32:35], s59 offen offset:3072 lds
  v_bfe_u32 v2, v1, 2, 2
  v_lshl_add_u32 v2, v3, 3, v2
  v_mul_u32_u24 v2, 72, v2
  v_bfe_u32 v3, v1, 4, 1
  v_lshl_add_u32 v2, v3, 5, v2
  v_and_b32 v3, 3, v1
  v_lshl_add_u32 v2, v3, 3, v2
  v_add_u32 v241, s0, v2
  s_lshl1_add_u32 s63, s52, s11
  s_lshl_b32 s63, s63, 14
  s_add_u32 s63, s63, 6291456
  s_add_u32 m0, s0, 4096
  s_add_u32 s59, s54, 131072
  buffer_load_dwordx4 v8, s[32:35], s59 offen lds
  buffer_load_dwordx4 v9, s[32:35], s59 offen offset:1024 lds
  buffer_load_dwordx4 v10, s[32:35], s59 offen offset:2048 lds
  buffer_load_dwordx4 v11, s[32:35], s59 offen offset:3072 lds
  s_mov_b64 exec, 0
  s_cmp_eq_u32 s4, 1
  s_cbranch_scc1 L_pad5
  s_cmp_eq_u32 s4, 2
  s_cbranch_scc1 L_pad6
  s_cmp_eq_u32 s4, 3
  s_cbranch_scc1 L_pad7
  s_branch L_pad4
L_pad7:
L_tour1:
  s_mov_b64 exec, -1
  s_waitcnt vmcnt(9)
L_h2_23:
  v_cmp_eq_u32 vcc, -1, v6
  s_nop 4
  s_cbranch_vccz L_h2o_24
  s_sub_u32 s96, s96, 1
  s_cbranch_scc1 L_end
  buffer_load_dword v6, v231, s[12:15], s67 offen sc1
  s_waitcnt vmcnt(0)
  s_branch L_h2_23
L_h2o_24:
  s_mov_b32 s3, s63
  buffer_load_dwordx4 v[112:115], v7, s[12:15], s3 offen offset:0 sc1
  buffer_load_dwordx4 v[116:119], v7, s[12:15], s3 offen offset:1024 sc1
  buffer_load_dwordx4 v[120:123], v7, s[12:15], s3 offen offset:2048 sc1
  buffer_load_dwordx4 v[124:127], v7, s[12:15], s3 offen offset:3072 sc1
  s_add_u32 s3, s3, 4096
  buffer_load_dwordx4 v[128:131], v7, s[12:15], s3 offen offset:0 sc1
  buffer_load_dwordx4 v[132:135], v7, s[12:15], s3 offen offset:1024 sc1
  buffer_load_dwordx4 v[136:139], v7, s[12:15], s3 offen offset:2048 sc1
  ds_read_b64_tr_b16 v[224:225], v4 offset:3584
  ds_read_b64_tr_b16 v[226:227], v4 offset:4608
  ds_read_b64_tr_b16 v[228:229], v5 offset:3584
  ds_read_b64_tr_b16 v[230:231], v5 offset:4608
  s_waitcnt vmcnt(7)
  ds_read_b64_tr_b16 a[96:97], v220 offset:12288
  ds_read_b64_tr_b16 a[98:99], v220 offset:12800
  ds_read_b64_tr_b16 a[100:101], v221 offset:12288
  ds_read_b64_tr_b16 a[102:103], v221 offset:12800
  buffer_load_dwordx4 v[140:143], v7, s[12:15], s3 offen offset:3072 sc1
  ds_read_b64_tr_b16 a[104:105], v220 offset:14336
  ds_read_b64_tr_b16 a[106:107], v220 offset:14848
  ds_read_b64_tr_b16 a[108:109], v221 offset:14336
  ds_read_b64_tr_b16 a[110:111], v221 offset:14848
  ds_read_b64_tr_b16 a[112:113], v220 offset:16384
  ds_read_b64_tr_b16 a[114:115], v220 offset:16896
  s_add_u32 s3, s3, 4096
  buffer_load_dwordx4 v[144:147], v7, s[12:15], s3 offen offset:0 sc1
  ds_read_b64_tr_b16 a[116:117], v221 offset:16384
  ds_read_b64_tr_b16 a[118:119], v221 offset:16896
  ds_read_b64_tr_b16 a[120:121], v220 offset:18432
  ds_read_b64_tr_b16 a[122:123], v220 offset:18944
  ds_read_b64_tr_b16 a[124:125], v221 offset:18432
  ds_read_b64_tr_b16 a[126:127], v221 offset:18944
  buffer_load_dwordx4 v[148:151], v7, s[12:15], s3 offen offset:1024 sc1
  ds_read_b64_tr_b16 v[16:17], v12 offset:0
  ds_read_b64_tr_b16 v[18:19], v12 offset:1024
  ds_read_b64_tr_b16 v[20:21], v13 offset:0
  ds_read_b64_tr_b16 v[22:23], v13 offset:1024
  ds_read_b64_tr_b16 v[24:25], v12 offset:2048
  ds_read_b64_tr_b16 v[26:27], v12 offset:3072
  buffer_load_dwordx4 v[152:155], v7, s[12:15], s3 offen offset:2048 sc1
  ds_read_b64_tr_b16 v[28:29], v13 offset:2048
  ds_read_b64_tr_b16 v[30:31], v13 offset:3072
  ds_read_b64_tr_b16 v[32:33], v12 offset:4096
  ds_read_b64_tr_b16 v[34:35], v12 offset:5120
  ds_read_b64_tr_b16 v[36:37], v13 offset:4096
  ds_read_b64_tr_b16 v[38:39], v13 offset:5120
  buffer_load_dwordx4 v[156:159], v7, s[12:15], s3 offen offset:3072 sc1
  ds_read_b64_tr_b16 v[40:41], v12 offset:6144
  ds_read_b64_tr_b16 v[42:43], v12 offset:7168
  ds_read_b64_tr_b16 v[44:45], v13 offset:6144
  ds_read_b64_tr_b16 v[46:47], v13 offset:7168
  s_add_u32 s3, s3, 4096
  buffer_load_dwordx4 v[160:163], v7, s[12:15], s3 offen offset:0 sc1
  buffer_load_dwordx4 v[164:167], v7, s[12:15], s3 offen offset:1024 sc1
  buffer_load_dwordx4 v[168:171], v7, s[12:15], s3 offen offset:2048 sc1
  buffer_load_dwordx4 v[172:175], v7, s[12:15], s3 offen offset:3072 sc1
  s_waitcnt vmcnt(12)
  v_max3_u32 v2, v112, v116, v120
  v_max_u32 v2, v2, v124
  v_cmp_eq_u32 vcc, -1, v2
  s_waitcnt lgkmcnt(0)
  s_nop 3
  s_cbranch_vccnz L_ort_26
L_ock_25:
  s_waitcnt lgkmcnt(15)
  v_mfma_f32_32x32x16_bf16 v[192:207], v[176:179], v[112:115], v[192:207]
  ds_read_b64_tr_b16 v[232:233], v4 offset:5632
  ds_read_b64_tr_b16 v[234:235], v4 offset:6656
  ds_read_b64_tr_b16 v[236:237], v5 offset:5632
  ds_read_b64_tr_b16 v[238:239], v5 offset:6656
  v_mfma_f32_32x32x16_bf16 v[208:223], v[180:183], v[112:115], 0
  s_add_u32 m0, s0, 8192
  s_add_u32 s59, s54, 262144
  buffer_load_dwordx4 v8, s[32:35], s59 offen lds
  s_waitcnt lgkmcnt(15)
  v_mfma_f32_32x32x16_bf16 v[192:207], v[184:187], v[116:119], v[192:207]
  ds_read_b64_tr_b16 v[176:177], v4 offset:7168
  ds_read_b64_tr_b16 v[178:179], v4 offset:8192
  ds_read_b64_tr_b16 v[180:181], v5 offset:7168
  ds_read_b64_tr_b16 v[182:183], v5 offset:8192
  v_mfma_f32_32x32x16_bf16 v[208:223], v[188:191], v[116:119], v[208:223]
  buffer_load_dwordx4 v9, s[32:35], s59 offen offset:1024 lds
  s_waitcnt lgkmcnt(15)
  v_mfma_f32_32x32x16_bf16 v[192:207], v[224:227], v[120:123], v[192:207]
  ds_read_b64_tr_b16 v[184:185], v4 offset:9216
  ds_read_b64_tr_b16 v[186:187], v4 offset:10240
  ds_read_b64_tr_b16 v[188:189], v5 offset:9216
  ds_read_b64_tr_b16 v[190:191], v5 offset:10240
  v_mfma_f32_32x32x16_bf16 v[208:223], v[228:231], v[120:123], v[208:223]
  buffer_load_dwordx4 v10, s[32:35], s59 offen offset:2048 lds
  s_waitcnt lgkmcnt(8)
  v_mfma_f32_32x32x16_bf16 v[192:207], v[232:235], v[124:127], v[192:207]
  ds_read_b64_tr_b16 v[224:225], v4 offset:10752
  ds_read_b64_tr_b16 v[226:227], v4 offset:11776
  ds_read_b64_tr_b16 v[228:229], v5 offset:10752
  ds_read_b64_tr_b16 v[230:231], v5 offset:11776
  s_waitcnt vmcnt(11)
  v_max3_u32 v2, v128, v132, v136
  v_max_u32 v2, v2, v140
  v_cmp_eq_u32 vcc, -1, v2
  v_mfma_f32_32x32x16_bf16 v[208:223], v[236:239], v[124:127], v[208:223]
  buffer_load_dwordx4 v11, s[32:35], s59 offen offset:3072 lds
  s_nop 2
  s_cbranch_vccnz L_ort_28
L_ock_27:
  s_waitcnt lgkmcnt(8)
  v_mfma_f32_32x32x16_bf16 v[192:207], v[176:179], v[128:131], v[192:207]
  ds_read_b64_tr_b16 v[232:233], v4 offset:12800
  ds_read_b64_tr_b16 v[234:235], v4 offset:13824
  ds_read_b64_tr_b16 v[236:237], v5 offset:12800
  ds_read_b64_tr_b16 v[238:239], v5 offset:13824
  v_mfma_f32_32x32x16_bf16 v[208:223], v[180:183], v[128:131], v[208:223]
  s_add_u32 m0, s0, 12288
  s_add_u32 s59, s54, 393216
  buffer_load_dwordx4 v8, s[32:35], s59 offen lds
  s_waitcnt lgkmcnt(8)
  v_mfma_f32_32x32x16_bf16 v[192:207], v[184:187], v[132:135], v[192:207]
  ds_read_b64_tr_b16 v[176:177], v4 offset:14336
  ds_read_b64_tr_b16 v[178:179], v4 offset:15360
  ds_read_b64_tr_b16 v[180:181], v5 offset:14336
  ds_read_b64_tr_b16 v[182:183], v5 offset:15360
  v_mfma_f32_32x32x16_bf16 v[208:223], v[188:191], v[132:135], v[208:223]
  buffer_load_dwordx4 v9, s[32:35], s59 offen offset:1024 lds
  s_waitcnt lgkmcnt(8)
  v_mfma_f32_32x32x16_bf16 v[192:207], v[224:227], v[136:139], v[192:207]
  ds_read_b64_tr_b16 v[184:185], v4 offset:16384
  ds_read_b64_tr_b16 v[186:187], v4 offset:17408
  ds_read_b64_tr_b16 v[188:189], v5 offset:16384
  ds_read_b64_tr_b16 v[190:191], v5 offset:17408
  v_mfma_f32_32x32x16_bf16 v[208:223], v[228:231], v[136:139], v[208:223]
  buffer_load_dwordx4 v10, s[32:35], s59 offen offset:2048 lds
  s_waitcnt lgkmcnt(8)
  v_mfma_f32_32x32x16_bf16 v[192:207], v[232:235], v[140:143], v[192:207]
  ds_read_b64_tr_b16 v[224:225], v4 offset:17920
  ds_read_b64_tr_b16 v[226:227], v4 offset:18944
  ds_read_b64_tr_b16 v[228:229], v5 offset:17920
  ds_read_b64_tr_b16 v[230:231], v5 offset:18944
  s_waitcnt vmcnt(11)
  v_max3_u32 v2, v144, v148, v152
  v_max_u32 v2, v2, v156
  v_cmp_eq_u32 vcc, -1, v2
  v_mfma_f32_32x32x16_bf16 v[208:223], v[236:239], v[140:143], v[208:223]
  buffer_load_dwordx4 v11, s[32:35], s59 offen offset:3072 lds
  s_nop 2
  s_cbranch_vccnz L_ort_30
L_ock_29:
  s_waitcnt lgkmcnt(8)
  v_mfma_f32_32x32x16_bf16 v[192:207], v[176:179], v[144:147], v[192:207]
  ds_read_b64_tr_b16 v[232:233], v4 offset:19968
  ds_read_b64_tr_b16 v[234:235], v4 offset:20992
  ds_read_b64_tr_b16 v[236:237], v5 offset:19968
  ds_read_b64_tr_b16 v[238:239], v5 offset:20992
  v_mfma_f32_32x32x16_bf16 v[208:223], v[180:183], v[144:147], v[208:223]
  s_add_u32 m0, s0, 16384
  s_add_u32 s59, s54, 524288
  buffer_load_dwordx4 v8, s[32:35], s59 offen lds
  s_waitcnt lgkmcnt(8)
  v_mfma_f32_32x32x16_bf16 v[192:207], v[184:187], v[148:151], v[192:207]
  ds_read_b64_tr_b16 v[176:177], v4 offset:21504
  ds_read_b64_tr_b16 v[178:179], v4 offset:22528
  ds_read_b64_tr_b16 v[180:181], v5 offset:21504
  ds_read_b64_tr_b16 v[182:183], v5 offset:22528
  v_mfma_f32_32x32x16_bf16 v[208:223], v[188:191], v[148:151], v[208:223]
  buffer_load_dwordx4 v9, s[32:35], s59 offen offset:1024 lds
  s_waitcnt lgkmcnt(8)
  v_mfma_f32_32x32x16_bf16 v[192:207], v[224:227], v[152:155], v[192:207]
  ds_read_b64_tr_b16 v[184:185], v4 offset:23552
  ds_read_b64_tr_b16 v[186:187], v4 offset:24576
  ds_read_b64_tr_b16 v[188:189], v5 offset:23552
  ds_read_b64_tr_b16 v[190:191], v5 offset:24576
  s_barrier
  s_mov_b64 exec, 1
  buffer_store_dword v1, off, s[20:23], s57 sc1
  s_mov_b64 exec, -1
  s_add_u32 s57, s57, 32768
  v_mfma_f32_32x32x16_bf16 v[208:223], v[228:231], v[152:155], v[208:223]
  buffer_load_dwordx4 v10, s[32:35], s59 offen offset:2048 lds
  s_waitcnt lgkmcnt(8)
  v_mfma_f32_32x32x16_bf16 v[192:207], v[232:235], v[156:159], v[192:207]
  ds_read_b64_tr_b16 v[224:225], v4 offset:25088
  ds_read_b64_tr_b16 v[226:227], v4 offset:26112
  ds_read_b64_tr_b16 v[228:229], v5 offset:25088
  ds_read_b64_tr_b16 v[230:231], v5 offset:26112
  s_waitcnt vmcnt(12)
  v_max3_u32 v2, v160, v164, v168
  v_max_u32 v2, v2, v172
  v_cmp_eq_u32 vcc, -1, v2
  v_mfma_f32_32x32x16_bf16 v[208:223], v[236:239], v[156:159], v[208:223]
  buffer_load_dwordx4 v11, s[32:35], s59 offen offset:3072 lds
  s_nop 2
  s_cbranch_vccnz L_ort_32
L_ock_31:
  s_waitcnt lgkmcnt(8)
  v_mfma_f32_32x32x16_bf16 v[192:207], v[176:179], v[160:163], v[192:207]
  ds_read_b64_tr_b16 v[232:233], v4 offset:27136
  ds_read_b64_tr_b16 v[234:235], v4 offset:28160
  ds_read_b64_tr_b16 v[236:237], v5 offset:27136
  ds_read_b64_tr_b16 v[238:239], v5 offset:28160
  v_mfma_f32_32x32x16_bf16 v[208:223], v[180:183], v[160:163], v[208:223]
  s_waitcnt lgkmcnt(8)
  v_mfma_f32_32x32x16_bf16 v[192:207], v[184:187], v[164:167], v[192:207]
  v_mfma_f32_32x32x16_bf16 v[208:223], v[188:191], v[164:167], v[208:223]
  s_waitcnt lgkmcnt(4)
  v_mfma_f32_32x32x16_bf16 v[192:207], v[224:227], v[168:171], v[192:207]
  v_mfma_f32_32x32x16_bf16 v[208:223], v[228:231], v[168:171], v[208:223]
  s_waitcnt lgkmcnt(0)
  v_mfma_f32_32x32x16_bf16 v[192:207], v[232:235], v[172:175], v[192:207]
  v_mfma_f32_32x32x16_bf16 v[208:223], v[236:239], v[172:175], v[208:223]
  s_nop 11
  ds_write_b128 v243, v[208:211] offset:20480
  ds_write_b128 v243, v[212:215] offset:21504
  ds_write_b128 v243, v[216:219] offset:22528
  ds_write_b128 v243, v[220:223] offset:23552
  s_waitcnt lgkmcnt(0)
  s_barrier
  ds_read_b128 v[224:227], v244 offset:20480
  ds_read_b128 v[228:231], v244 offset:21504
  ds_read_b128 v[232:235], v244 offset:22528
  ds_read_b128 v[236:239], v244 offset:23552
  buffer_load_dword v242, v15, s[12:15], s60 offen sc1
  s_waitcnt lgkmcnt(3)
  v_pk_add_f32 v[224:225], v[224:225], v[192:193]
  v_pk_add_f32 v[226:227], v[226:227], v[194:195]
  v_pk_add_f32 v[2:3], v[224:225], v[226:227]
  v_pk_mul_f32 v[4:5], v[224:225], v[224:225]
  v_pk_fma_f32 v[4:5], v[226:227], v[226:227], v[4:5]
  s_waitcnt lgkmcnt(2)
  v_pk_add_f32 v[228:229], v[228:229], v[196:197]
  v_pk_add_f32 v[2:3], v[2:3], v[228:229]
  v_pk_fma_f32 v[4:5], v[228:229], v[228:229], v[4:5]
  v_pk_add_f32 v[230:231], v[230:231], v[198:199]
  v_pk_add_f32 v[2:3], v[2:3], v[230:231]
  v_pk_fma_f32 v[4:5], v[230:231], v[230:231], v[4:5]
  s_waitcnt lgkmcnt(1)
  v_pk_add_f32 v[232:233], v[232:233], v[200:201]
  v_pk_add_f32 v[2:3], v[2:3], v[232:233]
  v_pk_fma_f32 v[4:5], v[232:233], v[232:233], v[4:5]
  v_pk_add_f32 v[234:235], v[234:235], v[202:203]
  v_pk_add_f32 v[2:3], v[2:3], v[234:235]
  v_pk_fma_f32 v[4:5], v[234:235], v[234:235], v[4:5]
  s_waitcnt lgkmcnt(0)
  v_pk_add_f32 v[236:237], v[236:237], v[204:205]
L_pad4:
  s_cbranch_execz L_tour1
  v_pk_add_f32 v[2:3], v[2:3], v[236:237]
  v_pk_fma_f32 v[4:5], v[236:237], v[236:237], v[4:5]
  v_pk_add_f32 v[238:239], v[238:239], v[206:207]
  v_pk_add_f32 v[2:3], v[2:3], v[238:239]
  v_pk_fma_f32 v[4:5], v[238:239], v[238:239], v[4:5]
  v_add_f32 v2, v2, v3
  v_add_f32 v3, v4, v5
  v_mov_b32 v4, v2
  v_mov_b32 v5, v3
  s_mov_b32 exec_hi, -1
  v_permlane32_swap_b32 v4, v2
  v_permlane32_swap_b32 v5, v3
  v_pk_add_f32 v[2:3], v[2:3], v[4:5]
  v_min_u32 v3, -2, v3
  s_mov_b32 exec_hi, 0
  buffer_store_dwordx2 v[2:3], v245, s[12:15], s98 offen sc1
  s_mov_b32 exec_hi, -1
  s_add_u32 m0, s61, 0
  s_add_u32 s59, s54, 655360
  buffer_load_dwordx4 v8, s[32:35], s59 offen lds
  s_waitcnt vmcnt(3)
  ds_read_b64_tr_b16 v[48:49], v12 offset:8192
  ds_read_b64_tr_b16 v[50:51], v12 offset:9216
  ds_read_b64_tr_b16 v[52:53], v13 offset:8192
  ds_read_b64_tr_b16 v[54:55], v13 offset:9216
  buffer_load_dwordx4 v9, s[32:35], s59 offen offset:1024 lds
  ds_read_b64_tr_b16 v[56:57], v12 offset:10240
  ds_read_b64_tr_b16 v[58:59], v12 offset:11264
  ds_read_b64_tr_b16 v[60:61], v13 offset:10240
  ds_read_b64_tr_b16 v[62:63], v13 offset:11264
  buffer_load_dwordx4 v10, s[32:35], s59 offen offset:2048 lds
  ds_read_b64_tr_b16 v[64:65], v12 offset:12288
  ds_read_b64_tr_b16 v[66:67], v12 offset:13312
  ds_read_b64_tr_b16 v[68:69], v13 offset:12288
  ds_read_b64_tr_b16 v[70:71], v13 offset:13312
  buffer_load_dwordx4 v11, s[32:35], s59 offen offset:3072 lds
  ds_read_b64_tr_b16 v[72:73], v12 offset:14336
  ds_read_b64_tr_b16 v[74:75], v12 offset:15360
  ds_read_b64_tr_b16 v[76:77], v13 offset:14336
  ds_read_b64_tr_b16 v[78:79], v13 offset:15360
  s_add_u32 m0, s61, 4096
  s_add_u32 s59, s54, 786432
  buffer_load_dwordx4 v8, s[32:35], s59 offen lds
  ds_read_b64_tr_b16 v[80:81], v12 offset:16384
  ds_read_b64_tr_b16 v[82:83], v12 offset:17408
  ds_read_b64_tr_b16 v[84:85], v13 offset:16384
  ds_read_b64_tr_b16 v[86:87], v13 offset:17408
  buffer_load_dwordx4 v9, s[32:35], s59 offen offset:1024 lds
  ds_read_b64_tr_b16 v[88:89], v12 offset:18432
  ds_read_b64_tr_b16 v[90:91], v12 offset:19456
  ds_read_b64_tr_b16 v[92:93], v13 offset:18432
  ds_read_b64_tr_b16 v[94:95], v13 offset:19456
  buffer_load_dwordx4 v10, s[32:35], s59 offen offset:2048 lds
  buffer_load_dwordx4 v11, s[32:35], s59 offen offset:3072 lds
  s_waitcnt vmcnt(8)
  s_waitcnt vmcnt(9)
L_hs_33:
  v_cmp_eq_u32 vcc, -1, v242
  s_nop 4
  s_cbranch_vccz L_hso_34
  s_sub_u32 s96, s96, 1
  s_cbranch_scc1 L_end
  buffer_load_dword v242, v15, s[12:15], s60 offen sc1
  s_waitcnt vmcnt(0)
  s_branch L_hs_33
L_hso_34:
  buffer_load_dwordx2 v[112:113], v245, s[12:15], s62 offen offset:0 sc1
  buffer_load_dwordx2 v[114:115], v245, s[12:15], s62 offen offset:512 sc1
  buffer_load_dwordx2 v[116:117], v245, s[12:15], s62 offen offset:1024 sc1
  buffer_load_dwordx2 v[118:119], v245, s[12:15], s62 offen offset:1536 sc1
  buffer_load_dwordx2 v[120:121], v245, s[12:15], s62 offen offset:2048 sc1
  buffer_load_dwordx2 v[122:123], v245, s[12:15], s62 offen offset:2560 sc1
  buffer_load_dwordx2 v[124:125], v245, s[12:15], s62 offen offset:3072 sc1
  v_min_u32 v2, 7, v1
  v_lshlrev_b32 v15, 7, v2
  s_cmp_eq_u32 s95, 7
  s_cselect_b32 s60, 3, s95
  s_lshl2_add_u32 s60, s60, s4
  s_lshl_b32 s60, s60, 10
  s_add_u32 s60, s60, 9109504
  s_waitcnt vmcnt(7)
  ds_read_b64_tr_b16 v[96:97], v246 offset:0
  ds_read_b64_tr_b16 v[98:99], v246 offset:1024
  ds_read_b64_tr_b16 v[100:101], v247 offset:0
  ds_read_b64_tr_b16 v[102:103], v247 offset:1024
  ds_read_b64_tr_b16 v[104:105], v246 offset:2048
  ds_read_b64_tr_b16 v[106:107], v246 offset:3072
  ds_read_b64_tr_b16 v[108:109], v247 offset:2048
  ds_read_b64_tr_b16 v[110:111], v247 offset:3072
  s_waitcnt lgkmcnt(0)
  s_add_u32 m0, s0, 0
  s_add_u32 s59, s54, 917504
  buffer_load_dwordx4 v8, s[32:35], s59 offen lds
  buffer_load_dwordx4 v9, s[32:35], s59 offen offset:1024 lds
  buffer_load_dwordx4 v10, s[32:35], s59 offen offset:2048 lds
  buffer_load_dwordx4 v11, s[32:35], s59 offen offset:3072 lds
  s_mov_b32 s3, 0x3f800054
  v_mov_b32 v6, 0x2edbe6ff
  s_barrier
  s_mov_b64 exec, 1
  buffer_store_dword v1, off, s[20:23], s57 sc1
  s_mov_b64 exec, -1
  s_add_u32 s57, s57, 32768
  s_waitcnt vmcnt(5)
  v_max3_u32 v2, v113, v115, v117
  v_max3_u32 v2, v2, v119, v121
  v_max3_u32 v2, v2, v123, v125
  v_cmp_eq_u32 vcc, -1, v2
  s_nop 4
  s_cbranch_vccnz L_s_35
L_so_36:
  v_pk_add_f32 v[112:113], v[112:113], v[114:115]
  v_pk_add_f32 v[116:117], v[116:117], v[118:119]
  v_pk_add_f32 v[120:121], v[120:121], v[122:123]
  v_pk_add_f32 v[112:113], v[112:113], v[116:117]
  v_pk_add_f32 v[120:121], v[120:121], v[124:125]
  v_pk_add_f32 v[112:113], v[112:113], v[120:121]
  v_mov_b32 v4, v112
  v_mov_b32 v5, v113
  s_nop 0
  v_permlane32_swap_b32 v4, v112
  v_permlane32_swap_b32 v5, v113
  v_pk_add_f32 v[2:3], v[112:113], v[4:5]
  v_mul_f32 v2, 0xbb124925, v2
  v_mul_f32 v3, 0x3b124925, v3
  v_fma_f32 v3, -v2, v2, v3
  v_max_f32 v3, 0, v3
  v_fma_f32 v3, v3, s3, v6
  v_rsq_f32 v4, v3
  s_nop 0
  v_mul_f32 v2, v2, v4
  v_pk_fma_f32 v[192:193], v[224:225], v[4:5], v[2:3] op_sel_hi:[1,0,0]
  v_pk_fma_f32 v[194:195], v[226:227], v[4:5], v[2:3] op_sel_hi:[1,0,0]
  v_pk_fma_f32 v[196:197], v[228:229], v[4:5], v[2:3] op_sel_hi:[1,0,0]
  v_pk_fma_f32 v[198:199], v[230:231], v[4:5], v[2:3] op_sel_hi:[1,0,0]
  v_cvt_pk_bf16_f32 v208, v192, v193
  v_cvt_pk_bf16_f32 v209, v194, v195
  v_cvt_pk_bf16_f32 v210, v196, v197
  v_cvt_pk_bf16_f32 v211, v198, v199
  ds_write_b64 v240, v[208:209] offset:20480
  ds_write_b64 v240, v[210:211] offset:20496
  v_pk_fma_f32 v[200:201], v[232:233], v[4:5], v[2:3] op_sel_hi:[1,0,0]
  v_pk_fma_f32 v[202:203], v[234:235], v[4:5], v[2:3] op_sel_hi:[1,0,0]
  v_pk_fma_f32 v[204:205], v[236:237], v[4:5], v[2:3] op_sel_hi:[1,0,0]
  v_pk_fma_f32 v[206:207], v[238:239], v[4:5], v[2:3] op_sel_hi:[1,0,0]
  v_cvt_pk_bf16_f32 v212, v200, v201
  v_cvt_pk_bf16_f32 v213, v202, v203
  v_cvt_pk_bf16_f32 v214, v204, v205
  v_cvt_pk_bf16_f32 v215, v206, v207
  ds_write_b64 v240, v[212:213] offset:20512
  ds_write_b64 v240, v[214:215] offset:20528
  ds_read_b64_tr_b16 v[160:161], v241 offset:20480
  ds_read_b64_tr_b16 v[162:163], v241 offset:20768
  ds_read_b64_tr_b16 v[164:165], v241 offset:21632
  ds_read_b64_tr_b16 v[166:167], v241 offset:21920
  s_waitcnt lgkmcnt(2)
  v_min_u32 v160, -2, v160
  buffer_store_dwordx4 v[160:163], v14, s[12:15], s99 offen offset:0 sc1
  s_waitcnt lgkmcnt(0)
  v_min_u32 v164, -2, v164
  buffer_store_dwordx4 v[164:167], v14, s[12:15], s99 offen offset:1024 sc1
  s_add_u32 m0, s0, 4096
  s_add_u32 s59, s54, 1048576
  buffer_load_dwordx4 v8, s[32:35], s59 offen lds
  v_min_u32 v2, 7, v1
  v_cmp_ne_u32 vcc, 3, v2
  s_nop 1
  v_cndmask_b32 v2, 0, v2, vcc
  v_lshlrev_b32 v244, 7, v2
  s_cmp_eq_u32 s95, 7
  s_cselect_b32 s3, 3, s95
  s_lshl3_add_u32 s3, s3, s4
  s_lshl_b32 s64, s3, 15
  s_add_u32 s64, s64, 9437184
  s_add_u32 s65, s64, 131072
  s_lshl3_add_u32 s3, s7, s4
  s_mov_b32 s57, s55
  buffer_load_dwordx4 v9, s[32:35], s59 offen offset:1024 lds
  s_mul_i32 s66, s3, 28672
  s_add_u32 s66, s66, 11534336
  s_add_u32 s67, s66, 114688
  s_cmp_lt_u32 s95, 7
  s_cselect_b32 s64, s64, s14
  s_cselect_b32 s65, s65, s14
  buffer_load_dwordx4 v10, s[32:35], s59 offen offset:2048 lds
  s_cmp_ge_u32 s9, 14
  s_cselect_b32 s3, 256, 0
  v_xor_b32 v254, s3, v7
  s_xor_b32 s3, s4, 1
  s_mul_i32 s3, s3, 6144
  v_add_u32 v240, s3, v7
  buffer_load_dwordx4 v11, s[32:35], s59 offen offset:3072 lds
  s_xor_b32 s3, s4, 2
  s_mul_i32 s3, s3, 6144
  v_add_u32 v241, s3, v7
  s_xor_b32 s3, s4, 3
  s_mul_i32 s3, s3, 6144
  v_add_u32 v242, s3, v7
  s_add_u32 m0, s0, 8192
  s_add_u32 s59, s54, 1179648
  buffer_load_dwordx4 v8, s[32:35], s59 offen lds
  s_mul_i32 s3, s4, 6144
  v_add_u32 v243, s3, v7
  v_and_b32 v2, 31, v1
  v_mul_u32_u24 v245, 144, v2
  v_lshrrev_b32 v4, 5, v1
  v_lshl_add_u32 v245, v4, 4, v245
  buffer_load_dwordx4 v9, s[32:35], s59 offen offset:1024 lds
  s_mul_i32 s3, s10, 4608
  s_lshl_b32 s68, s11, 5
  s_add_u32 s3, s3, s68
  v_add_u32 v245, s3, v245
  s_lshl2_add_u32 s3, s8, s4
  s_mul_i32 s68, s3, 14336
  s_lshl_b32 s3, s7, 7
  s_add_u32 s68, s68, s3
  buffer_load_dwordx4 v10, s[32:35], s59 offen offset:2048 lds
  v_lshlrev_b32 v252, 16, v252
  v_pk_add_f32 v[224:225], v[224:225], v[252:253] op_sel_hi:[1,0]
  v_pk_add_f32 v[226:227], v[226:227], v[252:253] op_sel_hi:[1,0]
  v_pk_add_f32 v[228:229], v[228:229], v[252:253] op_sel_hi:[1,0]
  v_pk_add_f32 v[230:231], v[230:231], v[252:253] op_sel_hi:[1,0]
  buffer_load_dwordx4 v11, s[32:35], s59 offen offset:3072 lds
  v_pk_add_f32 v[232:233], v[232:233], v[252:253] op_sel_hi:[1,0]
  v_pk_add_f32 v[234:235], v[234:235], v[252:253] op_sel_hi:[1,0]
  v_pk_add_f32 v[236:237], v[236:237], v[252:253] op_sel_hi:[1,0]
  v_pk_add_f32 v[238:239], v[238:239], v[252:253] op_sel_hi:[1,0]
  s_add_u32 m0, s0, 12288
  s_add_u32 s59, s54, 1310720
  buffer_load_dwordx4 v8, s[32:35], s59 offen lds
  buffer_load_dwordx4 v9, s[32:35], s59 offen offset:1024 lds
  buffer_load_dwordx4 v10, s[32:35], s59 offen offset:2048 lds
  buffer_load_dwordx4 v11, s[32:35], s59 offen offset:3072 lds
  s_waitcnt vmcnt(12)
  buffer_load_dword v6, v15, s[12:15], s60 offen sc1
  s_waitcnt vmcnt(0)
L_h3_37:
  v_cmp_eq_u32 vcc, -1, v6
  s_nop 4
  s_cbranch_vccz L_h3o_38
  s_sub_u32 s96, s96, 1
  s_cbranch_scc1 L_end
  buffer_load_dword v6, v15, s[12:15], s60 offen sc1
  s_waitcnt vmcnt(0)
  s_branch L_h3_37
L_h3o_38:
  s_cmp_eq_u32 s95, 7
  s_cbranch_scc1 L_no4
  s_add_u32 s71, s64, 0
  buffer_load_dwordx4 v[112:115], v7, s[12:15], s71 offen offset:0 sc1
  buffer_load_dwordx4 v[116:119], v7, s[12:15], s71 offen offset:1024 sc1
  buffer_load_dwordx4 v[120:123], v7, s[12:15], s71 offen offset:2048 sc1
  buffer_load_dwordx4 v[124:127], v7, s[12:15], s71 offen offset:3072 sc1
  s_add_u32 s72, s64, 4096
  buffer_load_dwordx4 v[128:131], v7, s[12:15], s72 offen offset:0 sc1
  buffer_load_dwordx4 v[132:135], v7, s[12:15], s72 offen offset:1024 sc1
  buffer_load_dwordx4 v[136:139], v7, s[12:15], s72 offen offset:2048 sc1
  buffer_load_dwordx4 v[140:143], v7, s[12:15], s72 offen offset:3072 sc1
  s_add_u32 s73, s64, 8192
  buffer_load_dwordx4 v[144:147], v7, s[12:15], s73 offen offset:0 sc1
  buffer_load_dwordx4 v[148:151], v7, s[12:15], s73 offen offset:1024 sc1
  buffer_load_dwordx4 v[152:155], v7, s[12:15], s73 offen offset:2048 sc1
  buffer_load_dwordx4 v[156:159], v7, s[12:15], s73 offen offset:3072 sc1
  v_mov_b32 v14, 0xbdd2d3e8
  v_mov_b32 v15, 0xc0135761
  s_lshl2_add_u32 s3, s7, s4
  s_lshl_b32 s3, s3, 10
  s_add_u32 s60, s3, 9109504
  s_waitcnt vmcnt(8)
  v_max3_u32 v2, v112, v116, v120
  v_max_u32 v2, v2, v124
  v_cmp_eq_u32 vcc, -1, v2
  s_nop 4
  s_cbranch_vccnz L_rt_40
L_ck_39:
  v_mfma_f32_32x32x16_bf16 v[192:207], a[192:195], v[112:115], 0
  v_mfma_f32_32x32x16_bf16 v[208:223], a[196:199], v[112:115], 0
  s_add_u32 s71, s64, 12288
  buffer_load_dwordx4 v[112:115], v7, s[12:15], s71 offen offset:0 sc1
  v_mfma_f32_32x32x16_bf16 v[192:207], a[200:203], v[116:119], v[192:207]
  v_mfma_f32_32x32x16_bf16 v[208:223], a[204:207], v[116:119], v[208:223]
  buffer_load_dwordx4 v[116:119], v7, s[12:15], s71 offen offset:1024 sc1
  v_mfma_f32_32x32x16_bf16 v[192:207], a[208:211], v[120:123], v[192:207]
  v_mfma_f32_32x32x16_bf16 v[208:223], a[212:215], v[120:123], v[208:223]
  buffer_load_dwordx4 v[120:123], v7, s[12:15], s71 offen offset:2048 sc1
  v_mfma_f32_32x32x16_bf16 v[192:207], a[216:219], v[124:127], v[192:207]
  s_waitcnt vmcnt(7)
  v_max3_u32 v2, v128, v132, v136
  v_max_u32 v2, v2, v140
  v_cmp_eq_u32 vcc, -1, v2
  v_mfma_f32_32x32x16_bf16 v[208:223], a[220:223], v[124:127], v[208:223]
  buffer_load_dwordx4 v[124:127], v7, s[12:15], s71 offen offset:3072 sc1
  s_nop 2
  s_cbranch_vccnz L_rt_42
L_ck_41:
  v_mfma_f32_32x32x16_bf16 v[192:207], a[224:227], v[128:131], v[192:207]
  v_mfma_f32_32x32x16_bf16 v[208:223], a[228:231], v[128:131], v[208:223]
  s_add_u32 s72, s64, 16384
  buffer_load_dwordx4 v[128:131], v7, s[12:15], s72 offen offset:0 sc1
  v_mfma_f32_32x32x16_bf16 v[192:207], a[232:235], v[132:135], v[192:207]
  v_mfma_f32_32x32x16_bf16 v[208:223], a[236:239], v[132:135], v[208:223]
  buffer_load_dwordx4 v[132:135], v7, s[12:15], s72 offen offset:1024 sc1
  v_mfma_f32_32x32x16_bf16 v[192:207], a[240:243], v[136:139], v[192:207]
  v_mfma_f32_32x32x16_bf16 v[208:223], a[244:247], v[136:139], v[208:223]
  buffer_load_dwordx4 v[136:139], v7, s[12:15], s72 offen offset:2048 sc1
  v_mfma_f32_32x32x16_bf16 v[192:207], a[248:251], v[140:143], v[192:207]
  s_waitcnt vmcnt(7)
  v_max3_u32 v2, v144, v148, v152
  v_max_u32 v2, v2, v156
  v_cmp_eq_u32 vcc, -1, v2
  v_mfma_f32_32x32x16_bf16 v[208:223], a[252:255], v[140:143], v[208:223]
  buffer_load_dwordx4 v[140:143], v7, s[12:15], s72 offen offset:3072 sc1
  s_nop 2
  s_cbranch_vccnz L_rt_44
L_ck_43:
  v_mfma_f32_32x32x16_bf16 v[192:207], a[128:131], v[144:147], v[192:207]
  v_mfma_f32_32x32x16_bf16 v[208:223], a[132:135], v[144:147], v[208:223]
  s_add_u32 s73, s64, 20480
  buffer_load_dwordx4 v[144:147], v7, s[12:15], s73 offen offset:0 sc1
  v_mfma_f32_32x32x16_bf16 v[192:207], a[136:139], v[148:151], v[192:207]
  v_mfma_f32_32x32x16_bf16 v[208:223], a[140:143], v[148:151], v[208:223]
  buffer_load_dwordx4 v[148:151], v7, s[12:15], s73 offen offset:1024 sc1
  v_mfma_f32_32x32x16_bf16 v[192:207], a[144:147], v[152:155], v[192:207]
  v_mfma_f32_32x32x16_bf16 v[208:223], a[148:151], v[152:155], v[208:223]
  buffer_load_dwordx4 v[152:155], v7, s[12:15], s73 offen offset:2048 sc1
  v_mfma_f32_32x32x16_bf16 v[192:207], a[152:155], v[156:159], v[192:207]
  s_waitcnt vmcnt(7)
  v_max3_u32 v2, v112, v116, v120
  v_max_u32 v2, v2, v124
  v_cmp_eq_u32 vcc, -1, v2
  v_mfma_f32_32x32x16_bf16 v[208:223], a[156:159], v[156:159], v[208:223]
  buffer_load_dwordx4 v[156:159], v7, s[12:15], s73 offen offset:3072 sc1
  s_nop 2
  s_cbranch_vccnz L_rt_46
L_ck_45:
  v_mfma_f32_32x32x16_bf16 v[192:207], a[160:163], v[112:115], v[192:207]
  v_mfma_f32_32x32x16_bf16 v[208:223], a[164:167], v[112:115], v[208:223]
  s_add_u32 s71, s64, 24576
  buffer_load_dwordx4 v[112:115], v7, s[12:15], s71 offen offset:0 sc1
  v_mfma_f32_32x32x16_bf16 v[192:207], a[168:171], v[116:119], v[192:207]
  v_mfma_f32_32x32x16_bf16 v[208:223], a[172:175], v[116:119], v[208:223]
  buffer_load_dwordx4 v[116:119], v7, s[12:15], s71 offen offset:1024 sc1
  v_mfma_f32_32x32x16_bf16 v[192:207], a[176:179], v[120:123], v[192:207]
  v_mfma_f32_32x32x16_bf16 v[208:223], a[180:183], v[120:123], v[208:223]
  buffer_load_dwordx4 v[120:123], v7, s[12:15], s71 offen offset:2048 sc1
  v_mfma_f32_32x32x16_bf16 v[192:207], a[184:187], v[124:127], v[192:207]
  s_waitcnt vmcnt(7)
  v_max3_u32 v2, v128, v132, v136
  v_max_u32 v2, v2, v140
  v_cmp_eq_u32 vcc, -1, v2
  v_mfma_f32_32x32x16_bf16 v[208:223], a[188:191], v[124:127], v[208:223]
  buffer_load_dwordx4 v[124:127], v7, s[12:15], s71 offen offset:3072 sc1
  s_nop 2
  s_cbranch_vccnz L_rt_48
L_ck_47:
  v_mfma_f32_32x32x16_bf16 v[192:207], a[0:3], v[128:131], v[192:207]
  v_mfma_f32_32x32x16_bf16 v[208:223], a[4:7], v[128:131], v[208:223]
  s_add_u32 s72, s64, 28672
  buffer_load_dwordx4 v[128:131], v7, s[12:15], s72 offen offset:0 sc1
  v_mfma_f32_32x32x16_bf16 v[192:207], a[8:11], v[132:135], v[192:207]
  v_mfma_f32_32x32x16_bf16 v[208:223], a[12:15], v[132:135], v[208:223]
  buffer_load_dwordx4 v[132:135], v7, s[12:15], s72 offen offset:1024 sc1
  v_mfma_f32_32x32x16_bf16 v[192:207], a[16:19], v[136:139], v[192:207]
  v_mfma_f32_32x32x16_bf16 v[208:223], a[20:23], v[136:139], v[208:223]
  buffer_load_dwordx4 v[136:139], v7, s[12:15], s72 offen offset:2048 sc1
  v_mfma_f32_32x32x16_bf16 v[192:207], a[24:27], v[140:143], v[192:207]
  s_waitcnt vmcnt(7)
  v_max3_u32 v2, v144, v148, v152
  v_max_u32 v2, v2, v156
  v_cmp_eq_u32 vcc, -1, v2
  v_mfma_f32_32x32x16_bf16 v[208:223], a[28:31], v[140:143], v[208:223]
  buffer_load_dwordx4 v[140:143], v7, s[12:15], s72 offen offset:3072 sc1
  s_nop 2
  s_cbranch_vccnz L_rt_50
L_ck_49:
  v_mfma_f32_32x32x16_bf16 v[192:207], a[32:35], v[144:147], v[192:207]
  v_mfma_f32_32x32x16_bf16 v[208:223], a[36:39], v[144:147], v[208:223]
  s_add_u32 s73, s65, 0
  buffer_load_dwordx4 v[144:147], v7, s[12:15], s73 offen offset:0 sc1
  v_mfma_f32_32x32x16_bf16 v[192:207], a[40:43], v[148:151], v[192:207]
  v_mfma_f32_32x32x16_bf16 v[208:223], a[44:47], v[148:151], v[208:223]
  buffer_load_dwordx4 v[148:151], v7, s[12:15], s73 offen offset:1024 sc1
  v_mfma_f32_32x32x16_bf16 v[192:207], a[48:51], v[152:155], v[192:207]
  v_mfma_f32_32x32x16_bf16 v[208:223], a[52:55], v[152:155], v[208:223]
  buffer_load_dwordx4 v[152:155], v7, s[12:15], s73 offen offset:2048 sc1
  v_mfma_f32_32x32x16_bf16 v[192:207], a[56:59], v[156:159], v[192:207]
  s_waitcnt vmcnt(7)
  v_max3_u32 v2, v112, v116, v120
  v_max_u32 v2, v2, v124
  v_cmp_eq_u32 vcc, -1, v2
  v_mfma_f32_32x32x16_bf16 v[208:223], a[60:63], v[156:159], v[208:223]
  buffer_load_dwordx4 v[156:159], v7, s[12:15], s73 offen offset:3072 sc1
  s_nop 2
  s_cbranch_vccnz L_rt_52
L_ck_51:
  v_mfma_f32_32x32x16_bf16 v[192:207], a[64:67], v[112:115], v[192:207]
  v_mfma_f32_32x32x16_bf16 v[208:223], a[68:71], v[112:115], v[208:223]
  s_add_u32 s71, s65, 4096
  buffer_load_dwordx4 v[112:115], v7, s[12:15], s71 offen offset:0 sc1
  v_mfma_f32_32x32x16_bf16 v[192:207], a[72:75], v[116:119], v[192:207]
  v_mfma_f32_32x32x16_bf16 v[208:223], a[76:79], v[116:119], v[208:223]
  buffer_load_dwordx4 v[116:119], v7, s[12:15], s71 offen offset:1024 sc1
  v_mfma_f32_32x32x16_bf16 v[192:207], a[80:83], v[120:123], v[192:207]
  v_mfma_f32_32x32x16_bf16 v[208:223], a[84:87], v[120:123], v[208:223]
  buffer_load_dwordx4 v[120:123], v7, s[12:15], s71 offen offset:2048 sc1
  v_mfma_f32_32x32x16_bf16 v[192:207], a[88:91], v[124:127], v[192:207]
  s_waitcnt vmcnt(7)
  v_max3_u32 v2, v128, v132, v136
  v_max_u32 v2, v2, v140
  v_cmp_eq_u32 vcc, -1, v2
  v_mfma_f32_32x32x16_bf16 v[208:223], a[92:95], v[124:127], v[208:223]
  buffer_load_dwordx4 v[124:127], v7, s[12:15], s71 offen offset:3072 sc1
  s_nop 2
  s_cbranch_vccnz L_rt_54
L_ck_53:
  v_mfma_f32_32x32x16_bf16 v[192:207], a[96:99], v[128:131], v[192:207]
  v_mfma_f32_32x32x16_bf16 v[208:223], a[100:103], v[128:131], v[208:223]
  s_add_u32 s72, s65, 8192
  buffer_load_dwordx4 v[128:131], v7, s[12:15], s72 offen offset:0 sc1
  v_mfma_f32_32x32x16_bf16 v[192:207], a[104:107], v[132:135], v[192:207]
  v_mfma_f32_32x32x16_bf16 v[208:223], a[108:111], v[132:135], v[208:223]
  buffer_load_dwordx4 v[132:135], v7, s[12:15], s72 offen offset:1024 sc1
  v_mfma_f32_32x32x16_bf16 v[192:207], a[112:115], v[136:139], v[192:207]
  s_barrier
  s_mov_b64 exec, 1
  buffer_store_dword v1, off, s[20:23], s57 sc1
  s_mov_b64 exec, -1
  s_add_u32 s57, s57, 32768
  v_mfma_f32_32x32x16_bf16 v[208:223], a[116:119], v[136:139], v[208:223]
  buffer_load_dwordx4 v[136:139], v7, s[12:15], s72 offen offset:2048 sc1
  v_mfma_f32_32x32x16_bf16 v[192:207], a[120:123], v[140:143], v[192:207]
  s_waitcnt vmcnt(8)
  v_max3_u32 v2, v144, v148, v152
  v_max_u32 v2, v2, v156
  v_cmp_eq_u32 vcc, -1, v2
  v_mfma_f32_32x32x16_bf16 v[208:223], a[124:127], v[140:143], v[208:223]
  buffer_load_dwordx4 v[140:143], v7, s[12:15], s72 offen offset:3072 sc1
  s_nop 2
  s_cbranch_vccnz L_rt_56
L_ck_55:
  v_mfma_f32_32x32x16_bf16 v[160:175], a[192:195], v[144:147], 0
  v_mfma_f32_32x32x16_bf16 v[176:191], a[196:199], v[144:147], 0
  s_add_u32 s73, s65, 12288
  buffer_load_dwordx4 v[144:147], v7, s[12:15], s73 offen offset:0 sc1
  s_nop 2
  ds_write_b128 v241, v[208:211] offset:2048
  v_lshlrev_b32 v4, 16, v248
  v_and_b32 v5, 0xffff0000, v248
  v_add_f32 v192, v192, v4
  v_mfma_f32_32x32x16_bf16 v[160:175], a[200:203], v[148:151], v[160:175]
  v_mfma_f32_32x32x16_bf16 v[176:191], a[204:207], v[148:151], v[176:191]
  buffer_load_dwordx4 v[148:151], v7, s[12:15], s73 offen offset:1024 sc1
  ds_write_b128 v241, v[212:215] offset:3072
  v_add_f32 v193, v193, v5
  v_lshlrev_b32 v4, 16, v249
  v_and_b32 v5, 0xffff0000, v249
  v_mfma_f32_32x32x16_bf16 v[160:175], a[208:211], v[152:155], v[160:175]
  v_mfma_f32_32x32x16_bf16 v[176:191], a[212:215], v[152:155], v[176:191]
  buffer_load_dwordx4 v[152:155], v7, s[12:15], s73 offen offset:2048 sc1
  ds_write_b128 v242, v[216:219] offset:4096
  v_add_f32 v194, v194, v4
  v_add_f32 v195, v195, v5
  v_lshlrev_b32 v4, 16, v250
  v_mfma_f32_32x32x16_bf16 v[160:175], a[216:219], v[156:159], v[160:175]
  s_waitcnt vmcnt(8)
  v_max3_u32 v2, v112, v116, v120
  v_max_u32 v2, v2, v124
  v_cmp_eq_u32 vcc, -1, v2
  v_mfma_f32_32x32x16_bf16 v[176:191], a[220:223], v[156:159], v[176:191]
  buffer_load_dwordx4 v[156:159], v7, s[12:15], s73 offen offset:3072 sc1
  ds_write_b128 v242, v[220:223] offset:5120
  v_and_b32 v5, 0xffff0000, v250
  v_add_f32 v196, v196, v4
  v_add_f32 v197, v197, v5
  s_cbranch_vccnz L_rt_58
L_ck_57:
  v_mfma_f32_32x32x16_bf16 v[160:175], a[224:227], v[112:115], v[160:175]
  v_mfma_f32_32x32x16_bf16 v[176:191], a[228:231], v[112:115], v[176:191]
  s_add_u32 s71, s65, 16384
  buffer_load_dwordx4 v[112:115], v7, s[12:15], s71 offen offset:0 sc1
  ds_write_b128 v240, v[200:203] offset:0
  v_lshlrev_b32 v4, 16, v251
  v_and_b32 v5, 0xffff0000, v251
  v_add_f32 v198, v198, v4
  v_mfma_f32_32x32x16_bf16 v[160:175], a[232:235], v[116:119], v[160:175]
  v_mfma_f32_32x32x16_bf16 v[176:191], a[236:239], v[116:119], v[176:191]
  buffer_load_dwordx4 v[116:119], v7, s[12:15], s71 offen offset:1024 sc1
  ds_write_b128 v240, v[204:207] offset:1024
  v_add_f32 v199, v199, v5
  v_mfma_f32_32x32x16_bf16 v[160:175], a[240:243], v[120:123], v[160:175]
  v_mfma_f32_32x32x16_bf16 v[176:191], a[244:247], v[120:123], v[176:191]
  buffer_load_dwordx4 v[120:123], v7, s[12:15], s71 offen offset:2048 sc1
  s_waitcnt lgkmcnt(0)
  s_barrier
  ds_read_b128 v[200:203], v243 offset:0
  ds_read_b128 v[204:207], v243 offset:1024
  ds_read_b128 v[208:211], v243 offset:2048
  v_mfma_f32_32x32x16_bf16 v[160:175], a[248:251], v[124:127], v[160:175]
  s_waitcnt vmcnt(7)
  v_max3_u32 v2, v128, v132, v136
  v_max_u32 v2, v2, v140
  v_cmp_eq_u32 vcc, -1, v2
  ds_read_b128 v[212:215], v243 offset:3072
  ds_read_b128 v[216:219], v243 offset:4096
  ds_read_b128 v[220:223], v243 offset:5120
  v_mfma_f32_32x32x16_bf16 v[176:191], a[252:255], v[124:127], v[176:191]
  buffer_load_dwordx4 v[124:127], v7, s[12:15], s71 offen offset:3072 sc1
  s_cbranch_vccnz L_rt_60
L_ck_59:
  v_mfma_f32_32x32x16_bf16 v[160:175], a[128:131], v[128:131], v[160:175]
  v_mfma_f32_32x32x16_bf16 v[176:191], a[132:135], v[128:131], v[176:191]
  s_add_u32 s72, s65, 20480
  buffer_load_dwordx4 v[128:131], v7, s[12:15], s72 offen offset:0 sc1
  s_waitcnt lgkmcnt(4)
  v_add_f32 v192, v192, v200
  v_add_f32 v193, v193, v201
  v_add_f32 v194, v194, v202
  v_add_f32 v195, v195, v203
  v_mfma_f32_32x32x16_bf16 v[160:175], a[136:139], v[132:135], v[160:175]
  v_add_f32 v196, v196, v204
  v_add_f32 v197, v197, v205
  v_add_f32 v198, v198, v206
  v_add_f32 v199, v199, v207
  s_waitcnt lgkmcnt(2)
  v_add_f32 v192, v192, v208
  v_add_f32 v193, v193, v209
  v_mfma_f32_32x32x16_bf16 v[176:191], a[140:143], v[132:135], v[176:191]
  buffer_load_dwordx4 v[132:135], v7, s[12:15], s72 offen offset:1024 sc1
  v_add_f32 v194, v194, v210
  v_add_f32 v195, v195, v211
  v_add_f32 v196, v196, v212
  v_add_f32 v197, v197, v213
  v_add_f32 v198, v198, v214
  v_mfma_f32_32x32x16_bf16 v[160:175], a[144:147], v[136:139], v[160:175]
  v_add_f32 v199, v199, v215
  s_waitcnt lgkmcnt(0)
  v_add_f32 v192, v192, v216
  v_add_f32 v193, v193, v217
  v_add_f32 v194, v194, v218
  v_add_f32 v195, v195, v219
  v_add_f32 v196, v196, v220
  v_mfma_f32_32x32x16_bf16 v[176:191], a[148:151], v[136:139], v[176:191]
  buffer_load_dwordx4 v[136:139], v7, s[12:15], s72 offen offset:2048 sc1
  v_add_f32 v197, v197, v221
  v_add_f32 v198, v198, v222
  v_add_f32 v199, v199, v223
  v_mul_f32 v200, v192, v192
  v_mul_f32 v201, v193, v193
  v_mfma_f32_32x32x16_bf16 v[160:175], a[152:155], v[140:143], v[160:175]
  s_waitcnt vmcnt(7)
  v_max3_u32 v2, v144, v148, v152
  v_max_u32 v2, v2, v156
  v_cmp_eq_u32 vcc, -1, v2
  v_mul_f32 v202, v194, v194
  v_mul_f32 v203, v195, v195
  v_mul_f32 v204, v196, v196
  v_mul_f32 v205, v197, v197
  v_mfma_f32_32x32x16_bf16 v[176:191], a[156:159], v[140:143], v[176:191]
  buffer_load_dwordx4 v[140:143], v7, s[12:15], s72 offen offset:3072 sc1
  v_mul_f32 v206, v198, v198
  v_mul_f32 v207, v199, v199
  v_fma_f32 v200, v200, v14, v15
  v_fma_f32 v201, v201, v14, v15
  v_fma_f32 v202, v202, v14, v15
  s_cbranch_vccnz L_rt_62
L_ck_61:
  v_mfma_f32_32x32x16_bf16 v[160:175], a[160:163], v[144:147], v[160:175]
  v_fma_f32 v203, v203, v14, v15
  v_fma_f32 v204, v204, v14, v15
  v_fma_f32 v205, v205, v14, v15
  v_fma_f32 v206, v206, v14, v15
  v_fma_f32 v207, v207, v14, v15
  v_mul_f32 v200, v200, v192
  v_mul_f32 v201, v201, v193
  v_mfma_f32_32x32x16_bf16 v[176:191], a[164:167], v[144:147], v[176:191]
  s_add_u32 s73, s65, 24576
  buffer_load_dwordx4 v[144:147], v7, s[12:15], s73 offen offset:0 sc1
  v_mul_f32 v202, v202, v194
  v_mul_f32 v203, v203, v195
  v_mul_f32 v204, v204, v196
  v_mul_f32 v205, v205, v197
  v_mul_f32 v206, v206, v198
  v_mfma_f32_32x32x16_bf16 v[160:175], a[168:171], v[148:151], v[160:175]
  s_add_u32 s3, s57, 32768
  s_mov_b64 exec, 1
  buffer_store_dword v1, off, s[20:23], s3 sc1
  s_mov_b64 exec, -1
  v_mul_f32 v207, v207, v199
  v_exp_f32 v200, v200
  v_exp_f32 v201, v201
  v_mfma_f32_32x32x16_bf16 v[176:191], a[172:175], v[148:151], v[176:191]
  buffer_load_dwordx4 v[148:151], v7, s[12:15], s73 offen offset:1024 sc1
  v_exp_f32 v202, v202
  v_exp_f32 v203, v203
  v_exp_f32 v204, v204
  v_mfma_f32_32x32x16_bf16 v[160:175], a[176:179], v[152:155], v[160:175]
  v_exp_f32 v205, v205
  v_exp_f32 v206, v206
  v_exp_f32 v207, v207
  v_add_f32 v200, 1.0, v200
  v_mfma_f32_32x32x16_bf16 v[176:191], a[180:183], v[152:155], v[176:191]
  buffer_load_dwordx4 v[152:155], v7, s[12:15], s73 offen offset:2048 sc1
  v_add_f32 v201, 1.0, v201
  v_add_f32 v202, 1.0, v202
  v_add_f32 v203, 1.0, v203
  v_add_f32 v204, 1.0, v204
  v_add_f32 v205, 1.0, v205
  v_mfma_f32_32x32x16_bf16 v[160:175], a[184:187], v[156:159], v[160:175]
  s_waitcnt vmcnt(8)
  v_max3_u32 v2, v112, v116, v120
  v_max_u32 v2, v2, v124
  v_cmp_eq_u32 vcc, -1, v2
  v_add_f32 v206, 1.0, v206
  v_add_f32 v207, 1.0, v207
  v_rcp_f32 v200, v200
  v_mfma_f32_32x32x16_bf16 v[176:191], a[188:191], v[156:159], v[176:191]
  buffer_load_dwordx4 v[156:159], v7, s[12:15], s73 offen offset:3072 sc1
  v_rcp_f32 v201, v201
  v_rcp_f32 v202, v202
  v_rcp_f32 v203, v203
  s_cbranch_vccnz L_rt_64
L_ck_63:
  v_mfma_f32_32x32x16_bf16 v[160:175], a[0:3], v[112:115], v[160:175]
  v_rcp_f32 v204, v204
  v_rcp_f32 v205, v205
  v_rcp_f32 v206, v206
  v_rcp_f32 v207, v207
  v_mfma_f32_32x32x16_bf16 v[176:191], a[4:7], v[112:115], v[176:191]
  s_add_u32 s71, s65, 28672
  buffer_load_dwordx4 v[112:115], v7, s[12:15], s71 offen offset:0 sc1
  v_mul_f32 v192, v192, v200
  v_mul_f32 v193, v193, v201
  v_mul_f32 v194, v194, v202
  v_mul_f32 v195, v195, v203
  v_mul_f32 v196, v196, v204
  v_mfma_f32_32x32x16_bf16 v[160:175], a[8:11], v[116:119], v[160:175]
  v_mul_f32 v197, v197, v205
  v_mul_f32 v198, v198, v206
  v_mul_f32 v199, v199, v207
  v_cvt_pk_bf16_f32 v208, v192, v193
  v_cvt_pk_bf16_f32 v209, v194, v195
  v_cvt_pk_bf16_f32 v210, v196, v197
  v_cvt_pk_bf16_f32 v211, v198, v199
  v_mfma_f32_32x32x16_bf16 v[176:191], a[12:15], v[116:119], v[176:191]
  buffer_load_dwordx4 v[116:119], v7, s[12:15], s71 offen offset:1024 sc1
  v_min_u32 v208, -2, v208
  buffer_store_dwordx4 v[208:211], v254, s[84:87], s100 offen sc1
  s_barrier
  v_mfma_f32_32x32x16_bf16 v[160:175], a[16:19], v[120:123], v[160:175]
  v_mfma_f32_32x32x16_bf16 v[176:191], a[20:23], v[120:123], v[176:191]
  buffer_load_dwordx4 v[120:123], v7, s[12:15], s71 offen offset:2048 sc1
  v_mfma_f32_32x32x16_bf16 v[160:175], a[24:27], v[124:127], v[160:175]
  s_waitcnt vmcnt(9)
  v_max3_u32 v2, v128, v132, v136
  v_max_u32 v2, v2, v140
  v_cmp_eq_u32 vcc, -1, v2
  v_mfma_f32_32x32x16_bf16 v[176:191], a[28:31], v[124:127], v[176:191]
  buffer_load_dwordx4 v[124:127], v7, s[12:15], s71 offen offset:3072 sc1
L_pad5:
  s_cbranch_execz L_tour1
  s_waitcnt vmcnt(55)
  s_nop 1
  s_cbranch_vccnz L_rt_66
L_ck_65:
  v_mfma_f32_32x32x16_bf16 v[160:175], a[32:35], v[128:131], v[160:175]
  s_add_u32 m0, s0, 16384
  s_add_u32 s59, s54, 1441792
  buffer_load_dwordx4 v8, s[32:35], s59 offen lds
  v_mfma_f32_32x32x16_bf16 v[176:191], a[36:39], v[128:131], v[176:191]
  v_mfma_f32_32x32x16_bf16 v[160:175], a[40:43], v[132:135], v[160:175]
  buffer_load_dwordx4 v9, s[32:35], s59 offen offset:1024 lds
  v_mfma_f32_32x32x16_bf16 v[176:191], a[44:47], v[132:135], v[176:191]
  v_mfma_f32_32x32x16_bf16 v[160:175], a[48:51], v[136:139], v[160:175]
  buffer_load_dwordx4 v10, s[32:35], s59 offen offset:2048 lds
  v_mfma_f32_32x32x16_bf16 v[176:191], a[52:55], v[136:139], v[176:191]
  v_mfma_f32_32x32x16_bf16 v[160:175], a[56:59], v[140:143], v[160:175]
  s_waitcnt vmcnt(8)
  v_max3_u32 v2, v144, v148, v152
  v_max_u32 v2, v2, v156
  v_cmp_eq_u32 vcc, -1, v2
  buffer_load_dwordx4 v11, s[32:35], s59 offen offset:3072 lds
  v_mfma_f32_32x32x16_bf16 v[176:191], a[60:63], v[140:143], v[176:191]
  s_nop 2
  s_cbranch_vccnz L_rt_68
L_ck_67:
  v_mfma_f32_32x32x16_bf16 v[176:191], a[68:71], v[144:147], v[176:191]
  s_add_u32 m0, s61, 0
  s_add_u32 s59, s54, 1572864
  buffer_load_dwordx4 v8, s[32:35], s59 offen lds
  v_mfma_f32_32x32x16_bf16 v[176:191], a[76:79], v[148:151], v[176:191]
  v_mfma_f32_32x32x16_bf16 v[176:191], a[84:87], v[152:155], v[176:191]
  s_waitcnt vmcnt(5)
  v_max3_u32 v2, v112, v116, v120
  v_max_u32 v2, v2, v124
  v_cmp_eq_u32 vcc, -1, v2
  buffer_load_dwordx4 v9, s[32:35], s59 offen offset:1024 lds
  s_add_u32 s60, s60, 32768
  buffer_load_dword v3, v244, s[12:15], s60 offen sc1
  v_mfma_f32_32x32x16_bf16 v[176:191], a[92:95], v[156:159], v[176:191]
  s_nop 0
  s_cbranch_vccnz L_rt_70
L_ck_69:
  v_mfma_f32_32x32x16_bf16 v[176:191], a[100:103], v[112:115], v[176:191]
  buffer_load_dwordx4 v10, s[32:35], s59 offen offset:2048 lds
  v_mfma_f32_32x32x16_bf16 v[176:191], a[108:111], v[116:119], v[176:191]
  v_mfma_f32_32x32x16_bf16 v[176:191], a[116:119], v[120:123], v[176:191]
  buffer_load_dwordx4 v11, s[32:35], s59 offen offset:3072 lds
  v_mfma_f32_32x32x16_bf16 v[176:191], a[124:127], v[124:127], v[176:191]
  v_mfma_f32_32x32x16_bf16 v[160:175], a[64:67], v[144:147], v[160:175]
  s_add_u32 m0, s0, 20480
  s_add_u32 s59, s54, 1703936
  buffer_load_dwordx4 v8, s[32:35], s59 offen lds
  s_mov_b64 exec, 1
  buffer_store_dword v1, off, s[20:23], s57 sc1
  s_mov_b64 exec, -1
  s_add_u32 s57, s57, 32768
  v_mfma_f32_32x32x16_bf16 v[160:175], a[72:75], v[148:151], v[160:175]
  v_mfma_f32_32x32x16_bf16 v[160:175], a[80:83], v[152:155], v[160:175]
  buffer_load_dwordx4 v9, s[32:35], s59 offen offset:1024 lds
  s_nop 0
  ds_write_b128 v241, v[176:179] offset:2048
  v_mfma_f32_32x32x16_bf16 v[160:175], a[88:91], v[156:159], v[160:175]
  ds_write_b128 v241, v[180:183] offset:3072
  v_mfma_f32_32x32x16_bf16 v[160:175], a[96:99], v[112:115], v[160:175]
  buffer_load_dwordx4 v10, s[32:35], s59 offen offset:2048 lds
  v_mfma_f32_32x32x16_bf16 v[160:175], a[104:107], v[116:119], v[160:175]
  ds_write_b128 v242, v[184:187] offset:4096
  v_mfma_f32_32x32x16_bf16 v[160:175], a[112:115], v[120:123], v[160:175]
  buffer_load_dwordx4 v11, s[32:35], s59 offen offset:3072 lds
  ds_write_b128 v242, v[188:191] offset:5120
  v_mfma_f32_32x32x16_bf16 v[160:175], a[120:123], v[124:127], v[160:175]
  s_nop 11
  ds_write_b128 v240, v[168:171] offset:0
  ds_write_b128 v240, v[172:175] offset:1024
  v_lshlrev_b32 v4, 16, v248
  v_and_b32 v5, 0xffff0000, v248
  v_pk_add_f32 v[160:161], v[160:161], v[4:5]
  v_lshlrev_b32 v4, 16, v249
  v_and_b32 v5, 0xffff0000, v249
  v_pk_add_f32 v[162:163], v[162:163], v[4:5]
  v_lshlrev_b32 v4, 16, v250
  v_and_b32 v5, 0xffff0000, v250
  v_pk_add_f32 v[164:165], v[164:165], v[4:5]
  v_lshlrev_b32 v4, 16, v251
  v_and_b32 v5, 0xffff0000, v251
  v_pk_add_f32 v[166:167], v[166:167], v[4:5]
  s_waitcnt vmcnt(7)
  v_cmp_eq_u32 s[74:75], -1, v3
  s_mov_b32 s79, s66
  s_nop 0
  s_cmp_lg_u64 s[74:75], 0
  s_cselect_b32 s66, s14, s66
  s_add_u32 s72, s66, 0
  buffer_load_dwordx4 v[128:131], v7, s[12:15], s72 offen offset:0 sc1
  buffer_load_dwordx4 v[132:135], v7, s[12:15], s72 offen offset:1024 sc1
  buffer_load_dwordx4 v[136:139], v7, s[12:15], s72 offen offset:2048 sc1
  buffer_load_dwordx4 v[140:143], v7, s[12:15], s72 offen offset:3072 sc1
  s_waitcnt lgkmcnt(0)
  s_barrier
  ds_read_b128 v[168:171], v243 offset:0
  ds_read_b128 v[172:175], v243 offset:1024
  ds_read_b128 v[176:179], v243 offset:2048
  ds_read_b128 v[180:183], v243 offset:3072
  ds_read_b128 v[184:187], v243 offset:4096
  ds_read_b128 v[188:191], v243 offset:5120
  s_add_u32 s73, s66, 4096
  buffer_load_dwordx4 v[144:147], v7, s[12:15], s73 offen offset:0 sc1
  buffer_load_dwordx4 v[148:151], v7, s[12:15], s73 offen offset:1024 sc1
  s_waitcnt lgkmcnt(4)
  v_pk_add_f32 v[160:161], v[160:161], v[168:169]
  v_pk_add_f32 v[162:163], v[162:163], v[170:171]
  v_pk_add_f32 v[164:165], v[164:165], v[172:173]
  v_pk_add_f32 v[166:167], v[166:167], v[174:175]
  s_waitcnt lgkmcnt(2)
  v_pk_add_f32 v[160:161], v[160:161], v[176:177]
  v_pk_add_f32 v[162:163], v[162:163], v[178:179]
  buffer_load_dwordx4 v[152:155], v7, s[12:15], s73 offen offset:2048 sc1
  v_pk_add_f32 v[164:165], v[164:165], v[180:181]
  v_pk_add_f32 v[166:167], v[166:167], v[182:183]
  s_waitcnt lgkmcnt(0)
  v_pk_add_f32 v[160:161], v[160:161], v[184:185]
  v_pk_add_f32 v[162:163], v[162:163], v[186:187]
  v_pk_add_f32 v[164:165], v[164:165], v[188:189]
  v_pk_add_f32 v[166:167], v[166:167], v[190:191]
  v_pk_mul_f32 v[168:169], v[160:161], v[160:161]
  buffer_load_dwordx4 v[156:159], v7, s[12:15], s73 offen offset:3072 sc1
  v_pk_mul_f32 v[170:171], v[162:163], v[162:163]
  v_pk_mul_f32 v[172:173], v[164:165], v[164:165]
  v_pk_mul_f32 v[174:175], v[166:167], v[166:167]
  v_pk_fma_f32 v[168:169], v[168:169], v[14:15], v[14:15] op_sel:[0,0,1] op_sel_hi:[1,0,1]
  v_pk_fma_f32 v[170:171], v[170:171], v[14:15], v[14:15] op_sel:[0,0,1] op_sel_hi:[1,0,1]
  v_pk_fma_f32 v[172:173], v[172:173], v[14:15], v[14:15] op_sel:[0,0,1] op_sel_hi:[1,0,1]
  v_pk_fma_f32 v[174:175], v[174:175], v[14:15], v[14:15] op_sel:[0,0,1] op_sel_hi:[1,0,1]
  v_pk_mul_f32 v[168:169], v[168:169], v[160:161]
  s_add_u32 s71, s66, 8192
  buffer_load_dwordx4 v[112:115], v7, s[12:15], s71 offen offset:0 sc1
  v_pk_mul_f32 v[170:171], v[170:171], v[162:163]
  v_pk_mul_f32 v[172:173], v[172:173], v[164:165]
  v_pk_mul_f32 v[174:175], v[174:175], v[166:167]
  v_exp_f32 v168, v168
  v_exp_f32 v169, v169
  v_exp_f32 v170, v170
  v_exp_f32 v171, v171
  v_exp_f32 v172, v172
  buffer_load_dwordx4 v[116:119], v7, s[12:15], s71 offen offset:1024 sc1
  v_exp_f32 v173, v173
  v_exp_f32 v174, v174
  v_exp_f32 v175, v175
  v_pk_add_f32 v[168:169], v[168:169], 1.0 op_sel_hi:[1,0]
  v_pk_add_f32 v[170:171], v[170:171], 1.0 op_sel_hi:[1,0]
  v_pk_add_f32 v[172:173], v[172:173], 1.0 op_sel_hi:[1,0]
  v_pk_add_f32 v[174:175], v[174:175], 1.0 op_sel_hi:[1,0]
  v_rcp_f32 v168, v168
  buffer_load_dwordx4 v[120:123], v7, s[12:15], s71 offen offset:2048 sc1
  v_rcp_f32 v169, v169
  v_rcp_f32 v170, v170
  v_rcp_f32 v171, v171
  v_rcp_f32 v172, v172
  v_rcp_f32 v173, v173
  v_rcp_f32 v174, v174
  v_rcp_f32 v175, v175
  v_pk_mul_f32 v[160:161], v[160:161], v[168:169]
  buffer_load_dwordx4 v[124:127], v7, s[12:15], s71 offen offset:3072 sc1
  v_pk_mul_f32 v[162:163], v[162:163], v[170:171]
  v_pk_mul_f32 v[164:165], v[164:165], v[172:173]
  v_pk_mul_f32 v[166:167], v[166:167], v[174:175]
  v_cvt_pk_bf16_f32 v176, v160, v161
  v_cvt_pk_bf16_f32 v177, v162, v163
  v_cvt_pk_bf16_f32 v178, v164, v165
  v_cvt_pk_bf16_f32 v179, v166, v167
  v_min_u32 v176, -2, v176
  buffer_store_dwordx4 v[176:179], v254, s[84:87], s78 offen sc1
  s_mov_b32 s66, s79
  s_cmp_eq_u64 s[74:75], 0
  s_cbranch_scc1 L_nj_71
L_wait4:
  s_waitcnt vmcnt(0)
L_h4a_72:
  v_cmp_eq_u32 vcc, -1, v3
  s_nop 4
  s_cbranch_vccz L_h4ao_73
  s_sub_u32 s96, s96, 1
  s_cbranch_scc1 L_end
  buffer_load_dword v3, v244, s[12:15], s60 offen sc1
  s_waitcnt vmcnt(0)
  s_branch L_h4a_72
L_h4ao_73:
  s_add_u32 s72, s66, 0
  buffer_load_dwordx4 v[128:131], v7, s[12:15], s72 offen offset:0 sc1
  buffer_load_dwordx4 v[132:135], v7, s[12:15], s72 offen offset:1024 sc1
  buffer_load_dwordx4 v[136:139], v7, s[12:15], s72 offen offset:2048 sc1
  buffer_load_dwordx4 v[140:143], v7, s[12:15], s72 offen offset:3072 sc1
  s_add_u32 s73, s66, 4096
  buffer_load_dwordx4 v[144:147], v7, s[12:15], s73 offen offset:0 sc1
  buffer_load_dwordx4 v[148:151], v7, s[12:15], s73 offen offset:1024 sc1
  buffer_load_dwordx4 v[152:155], v7, s[12:15], s73 offen offset:2048 sc1
  buffer_load_dwordx4 v[156:159], v7, s[12:15], s73 offen offset:3072 sc1
  s_add_u32 s71, s66, 8192
  buffer_load_dwordx4 v[112:115], v7, s[12:15], s71 offen offset:0 sc1
  buffer_load_dwordx4 v[116:119], v7, s[12:15], s71 offen offset:1024 sc1
  buffer_load_dwordx4 v[120:123], v7, s[12:15], s71 offen offset:2048 sc1
  buffer_load_dwordx4 v[124:127], v7, s[12:15], s71 offen offset:3072 sc1
  s_waitcnt vmcnt(0)
L_nj_71:
  s_waitcnt vmcnt(9)
  v_max3_u32 v2, v128, v132, v136
  v_max_u32 v2, v2, v140
  v_cmp_eq_u32 vcc, -1, v2
  s_nop 4
  s_cbranch_vccnz L_rt_75
L_ck_74:
  v_mfma_f32_32x32x16_bf16 v[192:207], v[128:131], v[16:19], 0
  ds_read_b64_tr_b16 a[192:193], v246 offset:4096
  ds_read_b64_tr_b16 a[194:195], v246 offset:5120
  v_mfma_f32_32x32x16_bf16 v[208:223], v[128:131], v[20:23], 0
  s_add_u32 s72, s66, 12288
  buffer_load_dwordx4 v[128:131], v7, s[12:15], s72 offen offset:0 sc1
  ds_read_b64_tr_b16 a[196:197], v247 offset:4096
  ds_read_b64_tr_b16 a[198:199], v247 offset:5120
  v_mfma_f32_32x32x16_bf16 v[192:207], v[132:135], v[24:27], v[192:207]
  ds_read_b64_tr_b16 a[200:201], v246 offset:6144
  ds_read_b64_tr_b16 a[202:203], v246 offset:7168
  v_mfma_f32_32x32x16_bf16 v[208:223], v[132:135], v[28:31], v[208:223]
  buffer_load_dwordx4 v[132:135], v7, s[12:15], s72 offen offset:1024 sc1
  ds_read_b64_tr_b16 a[204:205], v247 offset:6144
  ds_read_b64_tr_b16 a[206:207], v247 offset:7168
  v_mfma_f32_32x32x16_bf16 v[192:207], v[136:139], v[32:35], v[192:207]
  ds_read_b64_tr_b16 a[208:209], v12 offset:0
  ds_read_b64_tr_b16 a[210:211], v12 offset:1024
  v_mfma_f32_32x32x16_bf16 v[208:223], v[136:139], v[36:39], v[208:223]
  buffer_load_dwordx4 v[136:139], v7, s[12:15], s72 offen offset:2048 sc1
  ds_read_b64_tr_b16 a[212:213], v13 offset:0
  ds_read_b64_tr_b16 a[214:215], v13 offset:1024
  v_mfma_f32_32x32x16_bf16 v[192:207], v[140:143], v[40:43], v[192:207]
  s_waitcnt vmcnt(8)
  v_max3_u32 v2, v144, v148, v152
  v_max_u32 v2, v2, v156
  v_cmp_eq_u32 vcc, -1, v2
  ds_read_b64_tr_b16 a[216:217], v12 offset:2048
  ds_read_b64_tr_b16 a[218:219], v12 offset:3072
  v_mfma_f32_32x32x16_bf16 v[208:223], v[140:143], v[44:47], v[208:223]
  buffer_load_dwordx4 v[140:143], v7, s[12:15], s72 offen offset:3072 sc1
  ds_read_b64_tr_b16 a[220:221], v13 offset:2048
  ds_read_b64_tr_b16 a[222:223], v13 offset:3072
  s_cbranch_vccnz L_rt_77
L_ck_76:
  v_mfma_f32_32x32x16_bf16 v[192:207], v[144:147], v[48:51], v[192:207]
  ds_read_b64_tr_b16 a[224:225], v12 offset:4096
  ds_read_b64_tr_b16 a[226:227], v12 offset:5120
  v_mfma_f32_32x32x16_bf16 v[208:223], v[144:147], v[52:55], v[208:223]
  s_add_u32 s73, s66, 16384
  buffer_load_dwordx4 v[144:147], v7, s[12:15], s73 offen offset:0 sc1
  ds_read_b64_tr_b16 a[228:229], v13 offset:4096
  ds_read_b64_tr_b16 a[230:231], v13 offset:5120
  v_mfma_f32_32x32x16_bf16 v[192:207], v[148:151], v[56:59], v[192:207]
  ds_read_b64_tr_b16 a[232:233], v12 offset:6144
  ds_read_b64_tr_b16 a[234:235], v12 offset:7168
  v_mfma_f32_32x32x16_bf16 v[208:223], v[148:151], v[60:63], v[208:223]
  buffer_load_dwordx4 v[148:151], v7, s[12:15], s73 offen offset:1024 sc1
  ds_read_b64_tr_b16 a[236:237], v13 offset:6144
  ds_read_b64_tr_b16 a[238:239], v13 offset:7168
  v_mfma_f32_32x32x16_bf16 v[192:207], v[152:155], v[64:67], v[192:207]
  ds_read_b64_tr_b16 a[240:241], v12 offset:8192
  ds_read_b64_tr_b16 a[242:243], v12 offset:9216
  s_add_u32 s60, s60, 32768
  buffer_load_dword v3, v244, s[12:15], s60 offen sc1
  v_mfma_f32_32x32x16_bf16 v[208:223], v[152:155], v[68:71], v[208:223]
  buffer_load_dwordx4 v[152:155], v7, s[12:15], s73 offen offset:2048 sc1
  ds_read_b64_tr_b16 a[244:245], v13 offset:8192
  ds_read_b64_tr_b16 a[246:247], v13 offset:9216
  v_mfma_f32_32x32x16_bf16 v[192:207], v[156:159], v[72:75], v[192:207]
  s_waitcnt vmcnt(9)
  v_max3_u32 v2, v112, v116, v120
  v_max_u32 v2, v2, v124
  v_cmp_eq_u32 vcc, -1, v2
  ds_read_b64_tr_b16 a[248:249], v12 offset:10240
  ds_read_b64_tr_b16 a[250:251], v12 offset:11264
  v_mfma_f32_32x32x16_bf16 v[208:223], v[156:159], v[76:79], v[208:223]
  buffer_load_dwordx4 v[156:159], v7, s[12:15], s73 offen offset:3072 sc1
  ds_read_b64_tr_b16 a[252:253], v13 offset:10240
  ds_read_b64_tr_b16 a[254:255], v13 offset:11264
  s_cbranch_vccnz L_rt_79
L_ck_78:
  v_mfma_f32_32x32x16_bf16 v[192:207], v[112:115], v[80:83], v[192:207]
  ds_read_b64_tr_b16 a[128:129], v12 offset:12288
  ds_read_b64_tr_b16 a[130:131], v12 offset:13312
  v_mfma_f32_32x32x16_bf16 v[208:223], v[112:115], v[84:87], v[208:223]
  s_add_u32 s71, s66, 20480
  buffer_load_dwordx4 v[112:115], v7, s[12:15], s71 offen offset:0 sc1
  ds_read_b64_tr_b16 a[132:133], v13 offset:12288
  ds_read_b64_tr_b16 a[134:135], v13 offset:13312
  v_mfma_f32_32x32x16_bf16 v[192:207], v[116:119], v[88:91], v[192:207]
  ds_read_b64_tr_b16 a[136:137], v12 offset:14336
  ds_read_b64_tr_b16 a[138:139], v12 offset:15360
  v_mfma_f32_32x32x16_bf16 v[208:223], v[116:119], v[92:95], v[208:223]
  buffer_load_dwordx4 v[116:119], v7, s[12:15], s71 offen offset:1024 sc1
  ds_read_b64_tr_b16 a[140:141], v13 offset:14336
  ds_read_b64_tr_b16 a[142:143], v13 offset:15360
  s_waitcnt vmcnt(24)
  v_mfma_f32_32x32x16_bf16 v[192:207], v[120:123], v[96:99], v[192:207]
  ds_read_b64_tr_b16 a[144:145], v12 offset:16384
  ds_read_b64_tr_b16 a[146:147], v12 offset:17408
  v_mfma_f32_32x32x16_bf16 v[208:223], v[120:123], v[100:103], v[208:223]
  buffer_load_dwordx4 v[120:123], v7, s[12:15], s71 offen offset:2048 sc1
  ds_read_b64_tr_b16 a[148:149], v13 offset:16384
  ds_read_b64_tr_b16 a[150:151], v13 offset:17408
  v_mfma_f32_32x32x16_bf16 v[192:207], v[124:127], v[104:107], v[192:207]
  s_waitcnt vmcnt(8)
  v_max3_u32 v2, v128, v132, v136
  v_max_u32 v2, v2, v140
  v_cmp_eq_u32 vcc, -1, v2
  ds_read_b64_tr_b16 a[152:153], v12 offset:18432
  ds_read_b64_tr_b16 a[154:155], v12 offset:19456
  v_mfma_f32_32x32x16_bf16 v[208:223], v[124:127], v[108:111], v[208:223]
  buffer_load_dwordx4 v[124:127], v7, s[12:15], s71 offen offset:3072 sc1
  ds_read_b64_tr_b16 a[156:157], v13 offset:18432
  ds_read_b64_tr_b16 a[158:159], v13 offset:19456
  s_cbranch_vccnz L_rt_81
L_ck_80:
  s_waitcnt lgkmcnt(15)
  v_mfma_f32_32x32x16_bf16 v[192:207], v[128:131], a[192:195], v[192:207]
  ds_read_b64_tr_b16 a[160:161], v246 offset:0
  ds_read_b64_tr_b16 a[162:163], v246 offset:1024
  v_mfma_f32_32x32x16_bf16 v[208:223], v[128:131], a[196:199], v[208:223]
  s_add_u32 s72, s66, 24576
  buffer_load_dwordx4 v[128:131], v7, s[12:15], s72 offen offset:0 sc1
  ds_read_b64_tr_b16 a[164:165], v247 offset:0
  ds_read_b64_tr_b16 a[166:167], v247 offset:1024
  v_mfma_f32_32x32x16_bf16 v[192:207], v[132:135], a[200:203], v[192:207]
  ds_read_b64_tr_b16 a[168:169], v246 offset:2048
  ds_read_b64_tr_b16 a[170:171], v246 offset:3072
  v_mfma_f32_32x32x16_bf16 v[208:223], v[132:135], a[204:207], v[208:223]
  buffer_load_dwordx4 v[132:135], v7, s[12:15], s72 offen offset:1024 sc1
  ds_read_b64_tr_b16 a[172:173], v247 offset:2048
  ds_read_b64_tr_b16 a[174:175], v247 offset:3072
  v_mfma_f32_32x32x16_bf16 v[192:207], v[136:139], a[208:211], v[192:207]
  ds_read_b64_tr_b16 a[176:177], v12 offset:20480
  ds_read_b64_tr_b16 a[178:179], v12 offset:21504
  v_mfma_f32_32x32x16_bf16 v[208:223], v[136:139], a[212:215], v[208:223]
  buffer_load_dwordx4 v[136:139], v7, s[12:15], s72 offen offset:2048 sc1
  ds_read_b64_tr_b16 a[180:181], v13 offset:20480
  ds_read_b64_tr_b16 a[182:183], v13 offset:21504
  v_mfma_f32_32x32x16_bf16 v[192:207], v[140:143], a[216:219], v[192:207]
  s_waitcnt vmcnt(7)
  v_max3_u32 v2, v144, v148, v152
  v_max_u32 v2, v2, v156
  v_cmp_eq_u32 vcc, -1, v2
  ds_read_b64_tr_b16 a[184:185], v12 offset:22528
  ds_read_b64_tr_b16 a[186:187], v12 offset:23552
  v_mfma_f32_32x32x16_bf16 v[208:223], v[140:143], a[220:223], v[208:223]
  buffer_load_dwordx4 v[140:143], v7, s[12:15], s72 offen offset:3072 sc1
  ds_read_b64_tr_b16 a[188:189], v13 offset:22528
  ds_read_b64_tr_b16 a[190:191], v13 offset:23552
  s_cbranch_vccnz L_rt_83
L_ck_82:
  s_waitcnt lgkmcnt(15)
  s_waitcnt vmcnt(10)
L_h4b_90:
  v_cmp_eq_u32 vcc, -1, v3
  s_nop 4
  s_cbranch_vccz L_h4bo_91
  s_sub_u32 s96, s96, 1
  s_cbranch_scc1 L_end
  buffer_load_dword v3, v244, s[12:15], s60 offen sc1
  s_waitcnt vmcnt(0)
  s_branch L_h4b_90
L_h4bo_91:
  v_mfma_f32_32x32x16_bf16 v[192:207], v[144:147], a[224:227], v[192:207]
  v_mfma_f32_32x32x16_bf16 v[208:223], v[144:147], a[228:231], v[208:223]
  s_add_u32 s73, s67, 0
  buffer_load_dwordx4 v[144:147], v7, s[12:15], s73 offen offset:0 sc1
  v_mfma_f32_32x32x16_bf16 v[192:207], v[148:151], a[232:235], v[192:207]
  v_mfma_f32_32x32x16_bf16 v[208:223], v[148:151], a[236:239], v[208:223]
  buffer_load_dwordx4 v[148:151], v7, s[12:15], s73 offen offset:1024 sc1
  v_mfma_f32_32x32x16_bf16 v[192:207], v[152:155], a[240:243], v[192:207]
  v_mfma_f32_32x32x16_bf16 v[208:223], v[152:155], a[244:247], v[208:223]
  buffer_load_dwordx4 v[152:155], v7, s[12:15], s73 offen offset:2048 sc1
  v_mfma_f32_32x32x16_bf16 v[192:207], v[156:159], a[248:251], v[192:207]
  s_waitcnt vmcnt(7)
  v_max3_u32 v2, v112, v116, v120
  v_max_u32 v2, v2, v124
  v_cmp_eq_u32 vcc, -1, v2
  v_mfma_f32_32x32x16_bf16 v[208:223], v[156:159], a[252:255], v[208:223]
  buffer_load_dwordx4 v[156:159], v7, s[12:15], s73 offen offset:3072 sc1
  s_nop 2
  s_cbranch_vccnz L_rt_85
L_ck_84:
  s_waitcnt lgkmcnt(15)
  v_mfma_f32_32x32x16_bf16 v[192:207], v[112:115], a[128:131], v[192:207]
  v_mfma_f32_32x32x16_bf16 v[208:223], v[112:115], a[132:135], v[208:223]
  s_add_u32 s71, s67, 4096
  buffer_load_dwordx4 v[112:115], v7, s[12:15], s71 offen offset:0 sc1
  v_mfma_f32_32x32x16_bf16 v[192:207], v[116:119], a[136:139], v[192:207]
  v_mfma_f32_32x32x16_bf16 v[208:223], v[116:119], a[140:143], v[208:223]
  buffer_load_dwordx4 v[116:119], v7, s[12:15], s71 offen offset:1024 sc1
  v_mfma_f32_32x32x16_bf16 v[192:207], v[120:123], a[144:147], v[192:207]
  v_mfma_f32_32x32x16_bf16 v[208:223], v[120:123], a[148:151], v[208:223]
  buffer_load_dwordx4 v[120:123], v7, s[12:15], s71 offen offset:2048 sc1
  v_mfma_f32_32x32x16_bf16 v[192:207], v[124:127], a[152:155], v[192:207]
  s_waitcnt vmcnt(7)
  v_max3_u32 v2, v128, v132, v136
  v_max_u32 v2, v2, v140
  v_cmp_eq_u32 vcc, -1, v2
  v_mfma_f32_32x32x16_bf16 v[208:223], v[124:127], a[156:159], v[208:223]
  buffer_load_dwordx4 v[124:127], v7, s[12:15], s71 offen offset:3072 sc1
  s_nop 2
  s_cbranch_vccnz L_rt_87
L_ck_86:
  s_waitcnt lgkmcnt(0)
  v_mfma_f32_32x32x16_bf16 v[192:207], v[128:131], a[160:163], v[192:207]
  v_mfma_f32_32x32x16_bf16 v[208:223], v[128:131], a[164:167], v[208:223]
  s_add_u32 s72, s67, 8192
  buffer_load_dwordx4 v[128:131], v7, s[12:15], s72 offen offset:0 sc1
  v_mfma_f32_32x32x16_bf16 v[192:207], v[132:135], a[168:171], v[192:207]
  v_mfma_f32_32x32x16_bf16 v[208:223], v[132:135], a[172:175], v[208:223]
  buffer_load_dwordx4 v[132:135], v7, s[12:15], s72 offen offset:1024 sc1
  v_mfma_f32_32x32x16_bf16 v[192:207], v[136:139], a[176:179], v[192:207]
  v_mfma_f32_32x32x16_bf16 v[208:223], v[136:139], a[180:183], v[208:223]
  buffer_load_dwordx4 v[136:139], v7, s[12:15], s72 offen offset:2048 sc1
  v_mfma_f32_32x32x16_bf16 v[192:207], v[140:143], a[184:187], v[192:207]
  s_waitcnt vmcnt(7)
  v_max3_u32 v2, v144, v148, v152
  v_max_u32 v2, v2, v156
  v_cmp_eq_u32 vcc, -1, v2
  v_mfma_f32_32x32x16_bf16 v[208:223], v[140:143], a[188:191], v[208:223]
  buffer_load_dwordx4 v[140:143], v7, s[12:15], s72 offen offset:3072 sc1
  s_nop 2
  s_cbranch_vccnz L_rt_89
L_ck_88:
  v_mfma_f32_32x32x16_bf16 v[160:175], v[144:147], v[16:19], 0
  v_mfma_f32_32x32x16_bf16 v[176:191], v[144:147], v[20:23], 0
  s_add_u32 s73, s67, 12288
  buffer_load_dwordx4 v[144:147], v7, s[12:15], s73 offen offset:0 sc1
  s_barrier
  s_nop 1
  ds_write_b128 v240, v[208:211] offset:2048
  v_mfma_f32_32x32x16_bf16 v[160:175], v[148:151], v[24:27], v[160:175]
  v_add_f32 v192, v192, v224
  v_add_f32 v193, v193, v225
  v_mfma_f32_32x32x16_bf16 v[176:191], v[148:151], v[28:31], v[176:191]
  buffer_load_dwordx4 v[148:151], v7, s[12:15], s73 offen offset:1024 sc1
  v_mfma_f32_32x32x16_bf16 v[160:175], v[152:155], v[32:35], v[160:175]
  ds_write_b128 v240, v[212:215] offset:3072
  v_add_f32 v194, v194, v226
  v_add_f32 v195, v195, v227
  v_mfma_f32_32x32x16_bf16 v[176:191], v[152:155], v[36:39], v[176:191]
  buffer_load_dwordx4 v[152:155], v7, s[12:15], s73 offen offset:2048 sc1
  v_mfma_f32_32x32x16_bf16 v[160:175], v[156:159], v[40:43], v[160:175]
  s_waitcnt vmcnt(7)
  v_max3_u32 v2, v112, v116, v120
  v_max_u32 v2, v2, v124
  v_cmp_eq_u32 vcc, -1, v2
  ds_write_b128 v242, v[216:219] offset:4096
  v_mfma_f32_32x32x16_bf16 v[176:191], v[156:159], v[44:47], v[176:191]
  buffer_load_dwordx4 v[156:159], v7, s[12:15], s73 offen offset:3072 sc1
  v_add_f32 v196, v196, v228
  v_add_f32 v197, v197, v229
  s_cbranch_vccnz L_rt_93
L_ck_92:
  v_mfma_f32_32x32x16_bf16 v[160:175], v[112:115], v[48:51], v[160:175]
  v_mfma_f32_32x32x16_bf16 v[176:191], v[112:115], v[52:55], v[176:191]
  s_add_u32 s71, s67, 16384
  buffer_load_dwordx4 v[112:115], v7, s[12:15], s71 offen offset:0 sc1
  ds_write_b128 v242, v[220:223] offset:5120
  v_add_f32 v198, v198, v230
  v_mfma_f32_32x32x16_bf16 v[160:175], v[116:119], v[56:59], v[160:175]
  v_add_f32 v199, v199, v231
  v_mfma_f32_32x32x16_bf16 v[176:191], v[116:119], v[60:63], v[176:191]
  buffer_load_dwordx4 v[116:119], v7, s[12:15], s71 offen offset:1024 sc1
  v_mfma_f32_32x32x16_bf16 v[160:175], v[120:123], v[64:67], v[160:175]
  ds_write_b128 v241, v[200:203] offset:0
  v_mfma_f32_32x32x16_bf16 v[176:191], v[120:123], v[68:71], v[176:191]
  buffer_load_dwordx4 v[120:123], v7, s[12:15], s71 offen offset:2048 sc1
  v_mfma_f32_32x32x16_bf16 v[160:175], v[124:127], v[72:75], v[160:175]
  s_waitcnt vmcnt(7)
  v_max3_u32 v2, v128, v132, v136
  v_max_u32 v2, v2, v140
  v_cmp_eq_u32 vcc, -1, v2
  ds_write_b128 v241, v[204:207] offset:1024
  v_mfma_f32_32x32x16_bf16 v[176:191], v[124:127], v[76:79], v[176:191]
  buffer_load_dwordx4 v[124:127], v7, s[12:15], s71 offen offset:3072 sc1
  s_nop 1
  s_cbranch_vccnz L_rt_95
L_ck_94:
  v_mfma_f32_32x32x16_bf16 v[160:175], v[128:131], v[80:83], v[160:175]
  v_mfma_f32_32x32x16_bf16 v[176:191], v[128:131], v[84:87], v[176:191]
  s_add_u32 s72, s67, 20480
  buffer_load_dwordx4 v[128:131], v7, s[12:15], s72 offen offset:0 sc1
  v_mfma_f32_32x32x16_bf16 v[160:175], v[132:135], v[88:91], v[160:175]
  s_waitcnt lgkmcnt(0)
  s_barrier
  ds_read_b128 v[200:203], v243 offset:0
  ds_read_b128 v[204:207], v243 offset:1024
  ds_read_b128 v[208:211], v243 offset:2048
  v_mfma_f32_32x32x16_bf16 v[176:191], v[132:135], v[92:95], v[176:191]
  buffer_load_dwordx4 v[132:135], v7, s[12:15], s72 offen offset:1024 sc1
  ds_read_b128 v[212:215], v243 offset:3072
  ds_read_b128 v[216:219], v243 offset:4096
  ds_read_b128 v[220:223], v243 offset:5120
  v_mfma_f32_32x32x16_bf16 v[160:175], v[136:139], v[96:99], v[160:175]
  v_mfma_f32_32x32x16_bf16 v[176:191], v[136:139], v[100:103], v[176:191]
  buffer_load_dwordx4 v[136:139], v7, s[12:15], s72 offen offset:2048 sc1
  v_mfma_f32_32x32x16_bf16 v[160:175], v[140:143], v[104:107], v[160:175]
  s_waitcnt vmcnt(7)
  v_max3_u32 v2, v144, v148, v152
  v_max_u32 v2, v2, v156
  v_cmp_eq_u32 vcc, -1, v2
  v_mfma_f32_32x32x16_bf16 v[176:191], v[140:143], v[108:111], v[176:191]
  buffer_load_dwordx4 v[140:143], v7, s[12:15], s72 offen offset:3072 sc1
  s_waitcnt lgkmcnt(4)
  v_add_f32 v192, v192, v200
  v_add_f32 v193, v193, v201
  s_cbranch_vccnz L_rt_97
L_ck_96:
  v_mfma_f32_32x32x16_bf16 v[160:175], v[144:147], a[192:195], v[160:175]
  v_add_f32 v194, v194, v202
  v_add_f32 v195, v195, v203
  v_add_f32 v196, v196, v204
  v_add_f32 v197, v197, v205
  v_add_f32 v198, v198, v206
  v_mfma_f32_32x32x16_bf16 v[176:191], v[144:147], a[196:199], v[176:191]
  s_add_u32 s73, s67, 24576
  buffer_load_dwordx4 v[144:147], v7, s[12:15], s73 offen offset:0 sc1
  v_add_f32 v199, v199, v207
  s_waitcnt lgkmcnt(2)
  v_add_f32 v192, v192, v208
  v_mfma_f32_32x32x16_bf16 v[160:175], v[148:151], a[200:203], v[160:175]
  v_add_f32 v193, v193, v209
  v_add_f32 v194, v194, v210
  v_add_f32 v195, v195, v211
  v_add_f32 v196, v196, v212
  v_add_f32 v197, v197, v213
  v_mfma_f32_32x32x16_bf16 v[176:191], v[148:151], a[204:207], v[176:191]
  buffer_load_dwordx4 v[148:151], v7, s[12:15], s73 offen offset:1024 sc1
  v_add_f32 v198, v198, v214
  v_add_f32 v199, v199, v215
  s_waitcnt lgkmcnt(0)
  v_mfma_f32_32x32x16_bf16 v[160:175], v[152:155], a[208:211], v[160:175]
  v_add_f32 v192, v192, v216
  v_add_f32 v193, v193, v217
  v_add_f32 v194, v194, v218
  v_add_f32 v195, v195, v219
  v_add_f32 v196, v196, v220
  v_mfma_f32_32x32x16_bf16 v[176:191], v[152:155], a[212:215], v[176:191]
  buffer_load_dwordx4 v[152:155], v7, s[12:15], s73 offen offset:2048 sc1
  v_add_f32 v197, v197, v221
  v_add_f32 v198, v198, v222
  v_add_f32 v199, v199, v223
  v_mfma_f32_32x32x16_bf16 v[160:175], v[156:159], a[216:219], v[160:175]
  s_waitcnt vmcnt(7)
  v_max3_u32 v2, v112, v116, v120
  v_max_u32 v2, v2, v124
  v_cmp_eq_u32 vcc, -1, v2
  v_cvt_pk_bf16_f32 v208, v192, v193
  v_cvt_pk_bf16_f32 v210, v196, v197
  v_mfma_f32_32x32x16_bf16 v[176:191], v[156:159], a[220:223], v[176:191]
  buffer_load_dwordx4 v[156:159], v7, s[12:15], s73 offen offset:3072 sc1
  v_cvt_pk_bf16_f32 v209, v194, v195
  v_cvt_pk_bf16_f32 v211, v198, v199
  v_permlane32_swap_b32 v208, v210
  s_cbranch_vccnz L_rt_99
L_ck_98:
  v_mfma_f32_32x32x16_bf16 v[160:175], v[112:115], a[224:227], v[160:175]
  v_permlane32_swap_b32 v209, v211
  ds_write_b128 v245, v[208:211] offset:59392
  v_lshrrev_b32 v4, 3, v1
  v_and_b32 v5, 7, v1
  v_mfma_f32_32x32x16_bf16 v[176:191], v[112:115], a[228:231], v[176:191]
  v_mul_u32_u24 v8, 144, v4
  v_mul_u32_u24 v9, 896, v4
  v_lshl_add_u32 v8, v5, 4, v8
  v_lshl_add_u32 v9, v5, 4, v9
  s_mul_i32 s3, s4, 2304
  v_add_u32 v8, s3, v8
  v_mfma_f32_32x32x16_bf16 v[160:175], v[116:119], a[232:235], v[160:175]
  v_add_u32 v10, 7168, v9
  s_barrier
  v_mfma_f32_32x32x16_bf16 v[176:191], v[116:119], a[236:239], v[176:191]
  v_mfma_f32_32x32x16_bf16 v[160:175], v[120:123], a[240:243], v[160:175]
  v_mfma_f32_32x32x16_bf16 v[176:191], v[120:123], a[244:247], v[176:191]
  v_mfma_f32_32x32x16_bf16 v[160:175], v[124:127], a[248:251], v[160:175]
  s_waitcnt vmcnt(4)
  v_max3_u32 v2, v128, v132, v136
  v_max_u32 v2, v2, v140
  v_cmp_eq_u32 vcc, -1, v2
  v_mfma_f32_32x32x16_bf16 v[176:191], v[124:127], a[252:255], v[176:191]
  s_nop 3
  s_cbranch_vccnz L_rt_101
L_ck_100:
  v_mfma_f32_32x32x16_bf16 v[176:191], v[128:131], a[132:135], v[176:191]
  v_mfma_f32_32x32x16_bf16 v[176:191], v[132:135], a[140:143], v[176:191]
  v_mfma_f32_32x32x16_bf16 v[176:191], v[136:139], a[148:151], v[176:191]
  s_waitcnt vmcnt(0)
  v_max3_u32 v2, v144, v148, v152
  v_max_u32 v2, v2, v156
  v_cmp_eq_u32 vcc, -1, v2
  v_mfma_f32_32x32x16_bf16 v[176:191], v[140:143], a[156:159], v[176:191]
  s_nop 3
  s_cbranch_vccnz L_rt_103
L_ck_102:
  v_mfma_f32_32x32x16_bf16 v[176:191], v[144:147], a[164:167], v[176:191]
  v_mfma_f32_32x32x16_bf16 v[176:191], v[148:151], a[172:175], v[176:191]
  v_mfma_f32_32x32x16_bf16 v[176:191], v[152:155], a[180:183], v[176:191]
  v_mfma_f32_32x32x16_bf16 v[176:191], v[156:159], a[188:191], v[176:191]
  v_mfma_f32_32x32x16_bf16 v[160:175], v[128:131], a[128:131], v[160:175]
  v_mfma_f32_32x32x16_bf16 v[160:175], v[132:135], a[136:139], v[160:175]
  v_mfma_f32_32x32x16_bf16 v[160:175], v[136:139], a[144:147], v[160:175]
  s_nop 8
  ds_write_b128 v240, v[176:179] offset:2048
  v_mfma_f32_32x32x16_bf16 v[160:175], v[140:143], a[152:155], v[160:175]
  ds_write_b128 v240, v[180:183] offset:3072
  v_mfma_f32_32x32x16_bf16 v[160:175], v[144:147], a[160:163], v[160:175]
  v_mfma_f32_32x32x16_bf16 v[160:175], v[148:151], a[168:171], v[160:175]
  ds_write_b128 v242, v[184:187] offset:4096
  v_mfma_f32_32x32x16_bf16 v[160:175], v[152:155], a[176:179], v[160:175]
  ds_write_b128 v242, v[188:191] offset:5120
  v_mfma_f32_32x32x16_bf16 v[160:175], v[156:159], a[184:187], v[160:175]
  s_nop 11
  ds_write_b128 v241, v[168:171] offset:0
  ds_write_b128 v241, v[172:175] offset:1024
  v_pk_add_f32 v[160:161], v[160:161], v[232:233]
  v_pk_add_f32 v[162:163], v[162:163], v[234:235]
  v_pk_add_f32 v[164:165], v[164:165], v[236:237]
  v_pk_add_f32 v[166:167], v[166:167], v[238:239]
  s_waitcnt lgkmcnt(0)
  s_barrier
  ds_read_b128 v[168:171], v243 offset:0
  ds_read_b128 v[172:175], v243 offset:1024
  ds_read_b128 v[176:179], v243 offset:2048
L_pad6:
  s_cbranch_execz L_tour1
  ds_read_b128 v[180:183], v243 offset:3072
  ds_read_b128 v[184:187], v243 offset:4096
  ds_read_b128 v[188:191], v243 offset:5120
  s_waitcnt lgkmcnt(4)
  v_pk_add_f32 v[160:161], v[160:161], v[168:169]
  v_pk_add_f32 v[162:163], v[162:163], v[170:171]
  v_pk_add_f32 v[164:165], v[164:165], v[172:173]
  v_pk_add_f32 v[166:167], v[166:167], v[174:175]
  s_waitcnt lgkmcnt(2)
  v_pk_add_f32 v[160:161], v[160:161], v[176:177]
  v_pk_add_f32 v[162:163], v[162:163], v[178:179]
  v_pk_add_f32 v[164:165], v[164:165], v[180:181]
  v_pk_add_f32 v[166:167], v[166:167], v[182:183]
  s_waitcnt lgkmcnt(0)
  v_pk_add_f32 v[160:161], v[160:161], v[184:185]
  v_pk_add_f32 v[162:163], v[162:163], v[186:187]
  v_pk_add_f32 v[164:165], v[164:165], v[188:189]
  v_pk_add_f32 v[166:167], v[166:167], v[190:191]
  v_cvt_pk_bf16_f32 v176, v160, v161
  v_cvt_pk_bf16_f32 v178, v164, v165
  v_cvt_pk_bf16_f32 v177, v162, v163
  v_cvt_pk_bf16_f32 v179, v166, v167
  v_permlane32_swap_b32 v176, v178
  s_nop 0
  v_permlane32_swap_b32 v177, v179
  ds_write_b128 v245, v[176:179] offset:59456
  s_waitcnt lgkmcnt(0)
  s_barrier
  ds_read_b128 v[160:163], v8 offset:59392
  ds_read_b128 v[164:167], v8 offset:60544
  s_waitcnt lgkmcnt(1)
  buffer_store_dwordx4 v[160:163], v9, s[44:47], s68 offen sc1
  s_waitcnt lgkmcnt(0)
  buffer_store_dwordx4 v[164:167], v10, s[44:47], s68 offen sc1
L_fin:
L_end:
  s_endpgm
L_idle:
  s_mov_b32 s30, 7340032
  v_mfma_f32_32x32x16_bf16 v[128:143], a[128:131], v[24:27], 0
  global_load_dwordx4 a[176:179], v7, s[54:55] offset:0 sc1
  s_nop 6
  v_exp_f32 v112, v112
  v_exp_f32 v113, v113
  v_exp_f32 v114, v114
  v_exp_f32 v115, v115
  v_cvt_pk_bf16_f32 v144, v112, v113
  v_cvt_pk_bf16_f32 v145, v114, v115
  v_exp_f32 v116, v116
  v_exp_f32 v117, v117
  v_exp_f32 v118, v118
  v_exp_f32 v119, v119
  v_cvt_pk_bf16_f32 v146, v116, v117
  v_cvt_pk_bf16_f32 v147, v118, v119
  v_mfma_f32_32x32x16_bf16 v[128:143], a[132:135], v[28:31], v[128:143]
  global_load_dwordx4 a[180:183], v7, s[54:55] offset:1024 sc1
  v_exp_f32 v120, v120
  v_exp_f32 v121, v121
  v_exp_f32 v122, v122
  v_exp_f32 v123, v123
  v_cvt_pk_bf16_f32 v148, v120, v121
  v_cvt_pk_bf16_f32 v149, v122, v123
  v_mfma_f32_32x32x16_bf16 v[48:63], a[136:139], v[144:147], 0
  v_exp_f32 v124, v124
  v_exp_f32 v125, v125
  v_exp_f32 v126, v126
  v_exp_f32 v127, v127
  v_cvt_pk_bf16_f32 v150, v124, v125
  v_cvt_pk_bf16_f32 v151, v126, v127
  v_mfma_f32_32x32x16_bf16 v[112:127], a[128:131], v[32:35], 0
  global_load_dwordx4 a[184:187], v7, s[54:55] offset:2048 sc1
  v_exp_f32 v128, v128
  v_exp_f32 v129, v129
  v_exp_f32 v130, v130
  v_exp_f32 v131, v131
  v_cvt_pk_bf16_f32 v144, v128, v129
  v_cvt_pk_bf16_f32 v145, v130, v131
  v_mfma_f32_32x32x16_bf16 v[48:63], a[140:143], v[148:151], v[48:63]
  v_exp_f32 v132, v132
  v_exp_f32 v133, v133
  v_exp_f32 v134, v134
  v_exp_f32 v135, v135
  v_cvt_pk_bf16_f32 v146, v132, v133
  v_cvt_pk_bf16_f32 v147, v134, v135
  v_mfma_f32_32x32x16_bf16 v[112:127], a[132:135], v[36:39], v[112:127]
  global_load_dwordx4 a[188:191], v7, s[54:55] offset:3072 sc1
  v_exp_f32 v136, v136
  v_exp_f32 v137, v137
  v_exp_f32 v138, v138
  v_exp_f32 v139, v139
  v_cvt_pk_bf16_f32 v148, v136, v137
  v_cvt_pk_bf16_f32 v149, v138, v139
  v_mfma_f32_32x32x16_bf16 v[64:79], a[136:139], v[144:147], 0
  v_exp_f32 v140, v140
  v_exp_f32 v141, v141
  v_exp_f32 v142, v142
  v_exp_f32 v143, v143
  v_cvt_pk_bf16_f32 v150, v140, v141
  v_cvt_pk_bf16_f32 v151, v142, v143
  v_mfma_f32_32x32x16_bf16 v[128:143], a[128:131], v[40:43], 0
  s_add_u32 m0, s79, 8192
  s_add_u32 s58, s58, 28672
  buffer_load_dwordx4 v212, s[24:27], s58 offen lds
  v_exp_f32 v112, v112
  v_exp_f32 v113, v113
  v_exp_f32 v114, v114
  v_exp_f32 v115, v115
  v_cvt_pk_bf16_f32 v144, v112, v113
  v_cvt_pk_bf16_f32 v145, v114, v115
  v_mfma_f32_32x32x16_bf16 v[64:79], a[140:143], v[148:151], v[64:79]
  s_waitcnt vmcnt(9)
  v_accvgpr_read_b32 v2, a144
  v_accvgpr_read_b32 v3, a148
  v_accvgpr_read_b32 v4, a152
  v_accvgpr_read_b32 v10, a156
  v_max3_u32 v2, v2, v3, v4
  v_max_u32 v2, v2, v10
  v_cmp_eq_u32 vcc, -1, v2
  v_exp_f32 v116, v116
  v_exp_f32 v117, v117
  v_exp_f32 v118, v118
  v_exp_f32 v119, v119
  v_cvt_pk_bf16_f32 v146, v116, v117
  v_cvt_pk_bf16_f32 v147, v118, v119
  v_mfma_f32_32x32x16_bf16 v[128:143], a[132:135], v[44:47], v[128:143]
  buffer_load_dwordx4 v213, s[24:27], s58 offen offset:1024 lds
  v_exp_f32 v120, v120
  v_exp_f32 v121, v121
  v_exp_f32 v122, v122
  v_exp_f32 v123, v123
  v_cvt_pk_bf16_f32 v148, v120, v121
  v_cvt_pk_bf16_f32 v149, v122, v123
  v_mfma_f32_32x32x16_bf16 v[80:95], a[136:139], v[144:147], 0
  s_cbranch_vccnz L_krt_4
L_kck_3:
  v_exp_f32 v124, v124
  v_exp_f32 v125, v125
  v_exp_f32 v126, v126
  v_exp_f32 v127, v127
  v_cvt_pk_bf16_f32 v150, v124, v125
  v_cvt_pk_bf16_f32 v151, v126, v127
  v_mfma_f32_32x32x16_bf16 v[112:127], a[144:147], v[16:19], 0
  buffer_load_dwordx4 v214, s[24:27], s58 offen offset:2048 lds
  v_exp_f32 v128, v128
  v_exp_f32 v129, v129
  v_exp_f32 v130, v130
  v_exp_f32 v131, v131
  v_cvt_pk_bf16_f32 v144, v128, v129
  v_cvt_pk_bf16_f32 v145, v130, v131
  v_mfma_f32_32x32x16_bf16 v[80:95], a[140:143], v[148:151], v[80:95]
  v_exp_f32 v132, v132
  v_exp_f32 v133, v133
  v_exp_f32 v134, v134
  v_exp_f32 v135, v135
  v_cvt_pk_bf16_f32 v146, v132, v133
  v_cvt_pk_bf16_f32 v147, v134, v135
  v_mfma_f32_32x32x16_bf16 v[112:127], a[148:151], v[20:23], v[112:127]
  buffer_load_dwordx4 v215, s[24:27], s58 offen offset:3072 lds
  v_exp_f32 v136, v136
  v_exp_f32 v137, v137
  v_exp_f32 v138, v138
  v_exp_f32 v139, v139
  v_cvt_pk_bf16_f32 v148, v136, v137
  v_cvt_pk_bf16_f32 v149, v138, v139
  v_mfma_f32_32x32x16_bf16 v[96:111], a[136:139], v[144:147], 0
  v_exp_f32 v140, v140
  v_exp_f32 v141, v141
  v_exp_f32 v142, v142
  v_exp_f32 v143, v143
  v_cvt_pk_bf16_f32 v150, v140, v141
  v_cvt_pk_bf16_f32 v151, v142, v143
  v_mfma_f32_32x32x16_bf16 v[128:143], a[144:147], v[24:27], 0
  s_add_u32 m0, s79, 12288
  s_add_u32 s58, s58, 28672
  buffer_load_dwordx4 v212, s[24:27], s58 offen lds
  v_exp_f32 v112, v112
  v_exp_f32 v113, v113
  v_exp_f32 v114, v114
  v_exp_f32 v115, v115
  v_cvt_pk_bf16_f32 v144, v112, v113
  v_cvt_pk_bf16_f32 v145, v114, v115
  v_mfma_f32_32x32x16_bf16 v[96:111], a[140:143], v[148:151], v[96:111]
  v_exp_f32 v116, v116
  v_exp_f32 v117, v117
  v_exp_f32 v118, v118
  v_exp_f32 v119, v119
  v_cvt_pk_bf16_f32 v146, v116, v117
  v_cvt_pk_bf16_f32 v147, v118, v119
  v_mfma_f32_32x32x16_bf16 v[128:143], a[148:151], v[28:31], v[128:143]
  buffer_load_dwordx4 v213, s[24:27], s58 offen offset:1024 lds
  v_exp_f32 v120, v120
  v_exp_f32 v121, v121
  v_exp_f32 v122, v122
  v_exp_f32 v123, v123
  v_cvt_pk_bf16_f32 v148, v120, v121
  v_cvt_pk_bf16_f32 v149, v122, v123
  v_mfma_f32_32x32x16_bf16 v[48:63], a[152:155], v[144:147], v[48:63]
  v_exp_f32 v124, v124
  v_exp_f32 v125, v125
  v_exp_f32 v126, v126
  v_exp_f32 v127, v127
  v_cvt_pk_bf16_f32 v150, v124, v125
  v_cvt_pk_bf16_f32 v151, v126, v127
  v_mfma_f32_32x32x16_bf16 v[112:127], a[144:147], v[32:35], 0
  buffer_load_dwordx4 v214, s[24:27], s58 offen offset:2048 lds
  v_exp_f32 v128, v128
  v_exp_f32 v129, v129
  v_exp_f32 v130, v130
  v_exp_f32 v131, v131
  v_cvt_pk_bf16_f32 v144, v128, v129
  v_cvt_pk_bf16_f32 v145, v130, v131
  v_mfma_f32_32x32x16_bf16 v[48:63], a[156:159], v[148:151], v[48:63]
  buffer_load_dword v11, v253, s[12:15], 0 offen offset:48 sc1
  v_exp_f32 v132, v132
  v_exp_f32 v133, v133
  v_exp_f32 v134, v134
  v_exp_f32 v135, v135
  v_cvt_pk_bf16_f32 v146, v132, v133
  v_cvt_pk_bf16_f32 v147, v134, v135
  v_mfma_f32_32x32x16_bf16 v[112:127], a[148:151], v[36:39], v[112:127]
  s_mov_b64 exec, 63
  buffer_store_dword v224, v230, s[20:23], 0 offen sc1
  s_mov_b64 exec, -1
  v_exp_f32 v136, v136
  v_exp_f32 v137, v137
  v_exp_f32 v138, v138
  v_exp_f32 v139, v139
  v_cvt_pk_bf16_f32 v148, v136, v137
  v_cvt_pk_bf16_f32 v149, v138, v139
  v_mfma_f32_32x32x16_bf16 v[64:79], a[152:155], v[144:147], v[64:79]
  v_exp_f32 v140, v140
  v_exp_f32 v141, v141
  v_exp_f32 v142, v142
  v_exp_f32 v143, v143
  v_cvt_pk_bf16_f32 v150, v140, v141
  v_cvt_pk_bf16_f32 v151, v142, v143
  v_mfma_f32_32x32x16_bf16 v[128:143], a[144:147], v[40:43], 0
  buffer_store_dwordx4 v[224:227], v7, s[12:15], s97 offen sc1
  v_exp_f32 v112, v112
  v_exp_f32 v113, v113
  v_exp_f32 v114, v114
  v_exp_f32 v115, v115
  v_cvt_pk_bf16_f32 v144, v112, v113
  v_cvt_pk_bf16_f32 v145, v114, v115
  v_mfma_f32_32x32x16_bf16 v[64:79], a[156:159], v[148:151], v[64:79]
  s_waitcnt vmcnt(14)
  v_accvgpr_read_b32 v2, a160
  v_accvgpr_read_b32 v3, a164
  v_accvgpr_read_b32 v4, a168
  v_accvgpr_read_b32 v10, a172
  v_max3_u32 v2, v2, v3, v4
  v_max_u32 v2, v2, v10
  v_cmp_eq_u32 vcc, -1, v2
  v_exp_f32 v116, v116
  v_exp_f32 v117, v117
  v_exp_f32 v118, v118
  v_exp_f32 v119, v119
  v_cvt_pk_bf16_f32 v146, v116, v117
  v_cvt_pk_bf16_f32 v147, v118, v119
  v_mfma_f32_32x32x16_bf16 v[128:143], a[148:151], v[44:47], v[128:143]
  buffer_store_dwordx4 v[224:227], v7, s[12:15], s97 offen offset:1024 sc1
  v_exp_f32 v120, v120
  v_exp_f32 v121, v121
  v_exp_f32 v122, v122
  v_exp_f32 v123, v123
  v_cvt_pk_bf16_f32 v148, v120, v121
  v_cvt_pk_bf16_f32 v149, v122, v123
  v_mfma_f32_32x32x16_bf16 v[80:95], a[152:155], v[144:147], v[80:95]
  s_cbranch_vccnz L_krt_6
L_kck_5:
  v_exp_f32 v124, v124
  v_exp_f32 v125, v125
  v_exp_f32 v126, v126
  v_exp_f32 v127, v127
  v_cvt_pk_bf16_f32 v150, v124, v125
  v_cvt_pk_bf16_f32 v151, v126, v127
  v_mfma_f32_32x32x16_bf16 v[112:127], a[160:163], v[16:19], 0
  buffer_store_dword v224, v228, s[80:83], s98 offen sc1
  v_exp_f32 v128, v128
  v_exp_f32 v129, v129
  v_exp_f32 v130, v130
  v_exp_f32 v131, v131
  v_cvt_pk_bf16_f32 v144, v128, v129
  v_cvt_pk_bf16_f32 v145, v130, v131
  v_mfma_f32_32x32x16_bf16 v[80:95], a[156:159], v[148:151], v[80:95]
  s_waitcnt vmcnt(4)
  v_cmp_ne_u32 vcc, 1, v11
  v_exp_f32 v132, v132
  v_exp_f32 v133, v133
  v_exp_f32 v134, v134
  v_exp_f32 v135, v135
  v_cvt_pk_bf16_f32 v146, v132, v133
  v_cvt_pk_bf16_f32 v147, v134, v135
  v_mfma_f32_32x32x16_bf16 v[112:127], a[164:167], v[20:23], v[112:127]
  buffer_store_dwordx4 v[224:227], v14, s[80:83], s99 offen sc1
  v_exp_f32 v136, v136
  v_exp_f32 v137, v137
  v_exp_f32 v138, v138
  v_exp_f32 v139, v139
  v_cvt_pk_bf16_f32 v148, v136, v137
  v_cvt_pk_bf16_f32 v149, v138, v139
  v_mfma_f32_32x32x16_bf16 v[96:111], a[152:155], v[144:147], v[96:111]
  s_cbranch_vccnz L_f2r_8
L_f2_7:
  s_add_u32 s54, s54, 8192
  s_addc_u32 s55, s55, 0
  v_exp_f32 v140, v140
  v_exp_f32 v141, v141
  v_exp_f32 v142, v142
  v_exp_f32 v143, v143
  v_cvt_pk_bf16_f32 v150, v140, v141
  v_cvt_pk_bf16_f32 v151, v142, v143
  v_mfma_f32_32x32x16_bf16 v[128:143], a[160:163], v[24:27], 0
  global_load_dwordx4 a[0:3], v7, s[54:55] offset:-4096 sc1
  v_exp_f32 v112, v112
  v_exp_f32 v113, v113
  v_exp_f32 v114, v114
  v_exp_f32 v115, v115
  v_cvt_pk_bf16_f32 v144, v112, v113
  v_cvt_pk_bf16_f32 v145, v114, v115
  v_mfma_f32_32x32x16_bf16 v[96:111], a[156:159], v[148:151], v[96:111]
  global_load_dwordx4 a[4:7], v7, s[54:55] offset:-3072 sc1
  v_exp_f32 v116, v116
  v_exp_f32 v117, v117
  v_exp_f32 v118, v118
  v_exp_f32 v119, v119
  v_cvt_pk_bf16_f32 v146, v116, v117
  v_cvt_pk_bf16_f32 v147, v118, v119
  v_mfma_f32_32x32x16_bf16 v[128:143], a[164:167], v[28:31], v[128:143]
  global_load_dwordx4 a[8:11], v7, s[54:55] offset:-2048 sc1
  v_exp_f32 v120, v120
  v_exp_f32 v121, v121
  v_exp_f32 v122, v122
  v_exp_f32 v123, v123
  v_cvt_pk_bf16_f32 v148, v120, v121
  v_cvt_pk_bf16_f32 v149, v122, v123
  v_mfma_f32_32x32x16_bf16 v[48:63], a[168:171], v[144:147], v[48:63]
  v_exp_f32 v124, v124
  v_exp_f32 v125, v125
  v_exp_f32 v126, v126
  v_exp_f32 v127, v127
  v_cvt_pk_bf16_f32 v150, v124, v125
  v_cvt_pk_bf16_f32 v151, v126, v127
  v_mfma_f32_32x32x16_bf16 v[112:127], a[160:163], v[32:35], 0
  global_load_dwordx4 a[12:15], v7, s[54:55] offset:-1024 sc1
  v_exp_f32 v128, v128
  v_exp_f32 v129, v129
  v_exp_f32 v130, v130
  v_exp_f32 v131, v131
  v_cvt_pk_bf16_f32 v144, v128, v129
  v_cvt_pk_bf16_f32 v145, v130, v131
  v_mfma_f32_32x32x16_bf16 v[48:63], a[172:175], v[148:151], v[48:63]
  global_load_dwordx4 a[16:19], v7, s[54:55] offset:0 sc1
  v_exp_f32 v132, v132
  v_exp_f32 v133, v133
  v_exp_f32 v134, v134
  v_exp_f32 v135, v135
  v_cvt_pk_bf16_f32 v146, v132, v133
  v_cvt_pk_bf16_f32 v147, v134, v135
  v_mfma_f32_32x32x16_bf16 v[112:127], a[164:167], v[36:39], v[112:127]
  global_load_dwordx4 a[20:23], v7, s[54:55] offset:1024 sc1
  v_exp_f32 v136, v136
  v_exp_f32 v137, v137
  v_exp_f32 v138, v138
  v_exp_f32 v139, v139
  v_cvt_pk_bf16_f32 v148, v136, v137
  v_cvt_pk_bf16_f32 v149, v138, v139
  v_mfma_f32_32x32x16_bf16 v[64:79], a[168:171], v[144:147], v[64:79]
  v_exp_f32 v140, v140
  v_exp_f32 v141, v141
  v_exp_f32 v142, v142
  v_exp_f32 v143, v143
  v_cvt_pk_bf16_f32 v150, v140, v141
  v_cvt_pk_bf16_f32 v151, v142, v143
  v_mfma_f32_32x32x16_bf16 v[128:143], a[160:163], v[40:43], 0
  global_load_dwordx4 a[24:27], v7, s[54:55] offset:2048 sc1
  v_exp_f32 v112, v112
  v_exp_f32 v113, v113
  v_exp_f32 v114, v114
  v_exp_f32 v115, v115
  v_cvt_pk_bf16_f32 v144, v112, v113
  v_cvt_pk_bf16_f32 v145, v114, v115
  v_mfma_f32_32x32x16_bf16 v[64:79], a[172:175], v[148:151], v[64:79]
  global_load_dwordx4 a[28:31], v7, s[54:55] offset:3072 sc1
  v_accvgpr_read_b32 v2, a176
  v_accvgpr_read_b32 v3, a180
  v_accvgpr_read_b32 v4, a184
  v_accvgpr_read_b32 v10, a188
  v_max3_u32 v2, v2, v3, v4
  v_max_u32 v2, v2, v10
  v_cmp_eq_u32 vcc, -1, v2
  v_exp_f32 v116, v116
  v_exp_f32 v117, v117
  v_exp_f32 v118, v118
  v_exp_f32 v119, v119
  v_cvt_pk_bf16_f32 v146, v116, v117
  v_cvt_pk_bf16_f32 v147, v118, v119
  v_mfma_f32_32x32x16_bf16 v[128:143], a[164:167], v[44:47], v[128:143]
  s_add_u32 s54, s54, 8192
  s_addc_u32 s55, s55, 0
  global_load_dwordx4 a[32:35], v7, s[54:55] offset:-4096 sc1
  v_exp_f32 v120, v120
  v_exp_f32 v121, v121
  v_exp_f32 v122, v122
  v_exp_f32 v123, v123
  v_cvt_pk_bf16_f32 v148, v120, v121
  v_cvt_pk_bf16_f32 v149, v122, v123
  v_mfma_f32_32x32x16_bf16 v[80:95], a[168:171], v[144:147], v[80:95]
  s_cbranch_vccnz L_krt_10
L_kck_9:
  v_exp_f32 v124, v124
  v_exp_f32 v125, v125
  v_exp_f32 v126, v126
  v_exp_f32 v127, v127
  v_cvt_pk_bf16_f32 v150, v124, v125
  v_cvt_pk_bf16_f32 v151, v126, v127
  v_mfma_f32_32x32x16_bf16 v[112:127], a[176:179], v[16:19], 0
  global_load_dwordx4 a[36:39], v7, s[54:55] offset:-3072 sc1
  v_exp_f32 v128, v128
  v_exp_f32 v129, v129
  v_exp_f32 v130, v130
  v_exp_f32 v131, v131
  v_cvt_pk_bf16_f32 v144, v128, v129
  v_cvt_pk_bf16_f32 v145, v130, v131
  v_mfma_f32_32x32x16_bf16 v[80:95], a[172:175], v[148:151], v[80:95]
  global_load_dwordx4 a[40:43], v7, s[54:55] offset:-2048 sc1
  v_exp_f32 v132, v132
  v_exp_f32 v133, v133
  v_exp_f32 v134, v134
  v_exp_f32 v135, v135
  v_cvt_pk_bf16_f32 v146, v132, v133
  v_cvt_pk_bf16_f32 v147, v134, v135
  v_mfma_f32_32x32x16_bf16 v[112:127], a[180:183], v[20:23], v[112:127]
  global_load_dwordx4 a[44:47], v7, s[54:55] offset:-1024 sc1
  v_exp_f32 v136, v136
  v_exp_f32 v137, v137
  v_exp_f32 v138, v138
  v_exp_f32 v139, v139
  v_cvt_pk_bf16_f32 v148, v136, v137
  v_cvt_pk_bf16_f32 v149, v138, v139
  v_mfma_f32_32x32x16_bf16 v[96:111], a[168:171], v[144:147], v[96:111]
  v_exp_f32 v140, v140
  v_exp_f32 v141, v141
  v_exp_f32 v142, v142
  v_exp_f32 v143, v143
  v_cvt_pk_bf16_f32 v150, v140, v141
  v_cvt_pk_bf16_f32 v151, v142, v143
  v_mfma_f32_32x32x16_bf16 v[128:143], a[176:179], v[24:27], 0
  global_load_dwordx4 a[48:51], v7, s[54:55] offset:0 sc1
  v_exp_f32 v112, v112
  v_exp_f32 v113, v113
  v_exp_f32 v114, v114
  v_exp_f32 v115, v115
  v_cvt_pk_bf16_f32 v144, v112, v113
  v_cvt_pk_bf16_f32 v145, v114, v115
  v_mfma_f32_32x32x16_bf16 v[96:111], a[172:175], v[148:151], v[96:111]
  global_load_dwordx4 a[52:55], v7, s[54:55] offset:1024 sc1
  v_exp_f32 v116, v116
  v_exp_f32 v117, v117
  v_exp_f32 v118, v118
  v_exp_f32 v119, v119
  v_cvt_pk_bf16_f32 v146, v116, v117
  v_cvt_pk_bf16_f32 v147, v118, v119
  v_mfma_f32_32x32x16_bf16 v[128:143], a[180:183], v[28:31], v[128:143]
  global_load_dwordx4 a[56:59], v7, s[54:55] offset:2048 sc1
  v_exp_f32 v120, v120
  v_exp_f32 v121, v121
  v_exp_f32 v122, v122
  v_exp_f32 v123, v123
  v_cvt_pk_bf16_f32 v148, v120, v121
  v_cvt_pk_bf16_f32 v149, v122, v123
  v_mfma_f32_32x32x16_bf16 v[48:63], a[184:187], v[144:147], v[48:63]
  v_exp_f32 v124, v124
  v_exp_f32 v125, v125
  v_exp_f32 v126, v126
  v_exp_f32 v127, v127
  v_cvt_pk_bf16_f32 v150, v124, v125
  v_cvt_pk_bf16_f32 v151, v126, v127
  v_mfma_f32_32x32x16_bf16 v[112:127], a[176:179], v[32:35], 0
  global_load_dwordx4 a[60:63], v7, s[54:55] offset:3072 sc1
  v_exp_f32 v128, v128
  v_exp_f32 v129, v129
  v_exp_f32 v130, v130
  v_exp_f32 v131, v131
  v_cvt_pk_bf16_f32 v144, v128, v129
  v_cvt_pk_bf16_f32 v145, v130, v131
  v_mfma_f32_32x32x16_bf16 v[48:63], a[188:191], v[148:151], v[48:63]
  s_add_u32 s54, s54, 8192
  s_addc_u32 s55, s55, 0
  global_load_dwordx4 a[64:67], v7, s[54:55] offset:-4096 sc1
  v_exp_f32 v132, v132
  v_exp_f32 v133, v133
  v_exp_f32 v134, v134
  v_exp_f32 v135, v135
  v_cvt_pk_bf16_f32 v146, v132, v133
  v_cvt_pk_bf16_f32 v147, v134, v135
  v_mfma_f32_32x32x16_bf16 v[112:127], a[180:183], v[36:39], v[112:127]
  global_load_dwordx4 a[68:71], v7, s[54:55] offset:-3072 sc1
  v_exp_f32 v136, v136
  v_exp_f32 v137, v137
  v_exp_f32 v138, v138
  v_exp_f32 v139, v139
  v_cvt_pk_bf16_f32 v148, v136, v137
  v_cvt_pk_bf16_f32 v149, v138, v139
  v_mfma_f32_32x32x16_bf16 v[64:79], a[184:187], v[144:147], v[64:79]
  v_exp_f32 v140, v140
  v_exp_f32 v141, v141
  v_exp_f32 v142, v142
  v_exp_f32 v143, v143
  v_cvt_pk_bf16_f32 v150, v140, v141
  v_cvt_pk_bf16_f32 v151, v142, v143
  v_mfma_f32_32x32x16_bf16 v[128:143], a[176:179], v[40:43], 0
  global_load_dwordx4 a[72:75], v7, s[54:55] offset:-2048 sc1
  v_exp_f32 v112, v112
  v_exp_f32 v113, v113
  v_exp_f32 v114, v114
  v_exp_f32 v115, v115
  v_cvt_pk_bf16_f32 v144, v112, v113
  v_cvt_pk_bf16_f32 v145, v114, v115
  v_mfma_f32_32x32x16_bf16 v[64:79], a[188:191], v[148:151], v[64:79]
  global_load_dwordx4 a[76:79], v7, s[54:55] offset:-1024 sc1
  v_exp_f32 v116, v116
  v_exp_f32 v117, v117
  v_exp_f32 v118, v118
  v_exp_f32 v119, v119
  v_cvt_pk_bf16_f32 v146, v116, v117
  v_cvt_pk_bf16_f32 v147, v118, v119
  v_mfma_f32_32x32x16_bf16 v[128:143], a[180:183], v[44:47], v[128:143]
  global_load_dwordx4 a[80:83], v7, s[54:55] offset:0 sc1
  v_exp_f32 v120, v120
  v_exp_f32 v121, v121
  v_exp_f32 v122, v122
  v_exp_f32 v123, v123
  v_cvt_pk_bf16_f32 v148, v120, v121
  v_cvt_pk_bf16_f32 v149, v122, v123
  v_mfma_f32_32x32x16_bf16 v[80:95], a[184:187], v[144:147], v[80:95]
  s_waitcnt vmcnt(17)
  v_exp_f32 v124, v124
  v_exp_f32 v125, v125
  v_exp_f32 v126, v126
  v_exp_f32 v127, v127
  v_cvt_pk_bf16_f32 v150, v124, v125
  v_cvt_pk_bf16_f32 v151, v126, v127
  v_mfma_f32_32x32x16_bf16 v[112:127], a[0:3], v[16:19], 0
  global_load_dwordx4 a[84:87], v7, s[54:55] offset:1024 sc1
  v_exp_f32 v128, v128
  v_exp_f32 v129, v129
  v_exp_f32 v130, v130
  v_exp_f32 v131, v131
  v_cvt_pk_bf16_f32 v144, v128, v129
  v_cvt_pk_bf16_f32 v145, v130, v131
  v_mfma_f32_32x32x16_bf16 v[80:95], a[188:191], v[148:151], v[80:95]
  global_load_dwordx4 a[88:91], v7, s[54:55] offset:2048 sc1
  v_exp_f32 v132, v132
  v_exp_f32 v133, v133
  v_exp_f32 v134, v134
  v_exp_f32 v135, v135
  v_cvt_pk_bf16_f32 v146, v132, v133
  v_cvt_pk_bf16_f32 v147, v134, v135
  v_mfma_f32_32x32x16_bf16 v[112:127], a[4:7], v[20:23], v[112:127]
  global_load_dwordx4 a[92:95], v7, s[54:55] offset:3072 sc1
  v_exp_f32 v136, v136
  v_exp_f32 v137, v137
  v_exp_f32 v138, v138
  v_exp_f32 v139, v139
  v_cvt_pk_bf16_f32 v148, v136, v137
  v_cvt_pk_bf16_f32 v149, v138, v139
  v_mfma_f32_32x32x16_bf16 v[96:111], a[184:187], v[144:147], v[96:111]
  s_add_u32 s54, s54, 8192
  s_addc_u32 s55, s55, 0
  v_exp_f32 v140, v140
  v_exp_f32 v141, v141
  v_exp_f32 v142, v142
  v_exp_f32 v143, v143
  v_cvt_pk_bf16_f32 v150, v140, v141
  v_cvt_pk_bf16_f32 v151, v142, v143
  v_mfma_f32_32x32x16_bf16 v[128:143], a[0:3], v[24:27], 0
  global_load_dwordx4 a[96:99], v7, s[54:55] offset:-4096 sc1
  v_exp_f32 v112, v112
  v_exp_f32 v113, v113
  v_exp_f32 v114, v114
  v_exp_f32 v115, v115
  v_cvt_pk_bf16_f32 v144, v112, v113
  v_cvt_pk_bf16_f32 v145, v114, v115
  v_mfma_f32_32x32x16_bf16 v[96:111], a[188:191], v[148:151], v[96:111]
  global_load_dwordx4 a[100:103], v7, s[54:55] offset:-3072 sc1
  v_exp_f32 v116, v116
  v_exp_f32 v117, v117
  v_exp_f32 v118, v118
  v_exp_f32 v119, v119
  v_cvt_pk_bf16_f32 v146, v116, v117
  v_cvt_pk_bf16_f32 v147, v118, v119
  v_mfma_f32_32x32x16_bf16 v[128:143], a[4:7], v[28:31], v[128:143]
  global_load_dwordx4 a[104:107], v7, s[54:55] offset:-2048 sc1
  v_exp_f32 v120, v120
  v_exp_f32 v121, v121
  v_exp_f32 v122, v122
  v_exp_f32 v123, v123
  v_cvt_pk_bf16_f32 v148, v120, v121
  v_cvt_pk_bf16_f32 v149, v122, v123
  v_mfma_f32_32x32x16_bf16 v[48:63], a[8:11], v[144:147], v[48:63]
  v_exp_f32 v124, v124
  v_exp_f32 v125, v125
  v_exp_f32 v126, v126
  v_exp_f32 v127, v127
  v_cvt_pk_bf16_f32 v150, v124, v125
  v_cvt_pk_bf16_f32 v151, v126, v127
  v_mfma_f32_32x32x16_bf16 v[112:127], a[0:3], v[32:35], 0
  global_load_dwordx4 a[108:111], v7, s[54:55] offset:-1024 sc1
  v_exp_f32 v128, v128
  v_exp_f32 v129, v129
  v_exp_f32 v130, v130
  v_exp_f32 v131, v131
  v_cvt_pk_bf16_f32 v144, v128, v129
  v_cvt_pk_bf16_f32 v145, v130, v131
  v_mfma_f32_32x32x16_bf16 v[48:63], a[12:15], v[148:151], v[48:63]
  v_exp_f32 v132, v132
  v_exp_f32 v133, v133
  v_exp_f32 v134, v134
  v_exp_f32 v135, v135
  v_cvt_pk_bf16_f32 v146, v132, v133
  v_cvt_pk_bf16_f32 v147, v134, v135
  v_mfma_f32_32x32x16_bf16 v[112:127], a[4:7], v[36:39], v[112:127]
  v_exp_f32 v136, v136
  v_exp_f32 v137, v137
  v_exp_f32 v138, v138
  v_exp_f32 v139, v139
  v_cvt_pk_bf16_f32 v148, v136, v137
  v_cvt_pk_bf16_f32 v149, v138, v139
  v_mfma_f32_32x32x16_bf16 v[64:79], a[8:11], v[144:147], v[64:79]
  v_exp_f32 v140, v140
  v_exp_f32 v141, v141
  v_exp_f32 v142, v142
  v_exp_f32 v143, v143
  v_cvt_pk_bf16_f32 v150, v140, v141
  v_cvt_pk_bf16_f32 v151, v142, v143
  v_mfma_f32_32x32x16_bf16 v[128:143], a[0:3], v[40:43], 0
  buffer_load_dword v5, v222, s[28:31], s70 offen
  s_add_u32 s70, s70, 458752
  v_exp_f32 v112, v112
  v_exp_f32 v113, v113
  v_exp_f32 v114, v114
  v_exp_f32 v115, v115
  v_cvt_pk_bf16_f32 v144, v112, v113
  v_cvt_pk_bf16_f32 v145, v114, v115
  v_mfma_f32_32x32x16_bf16 v[64:79], a[12:15], v[148:151], v[64:79]
  v_exp_f32 v116, v116
  v_exp_f32 v117, v117
  v_exp_f32 v118, v118
  v_exp_f32 v119, v119
  v_cvt_pk_bf16_f32 v146, v116, v117
  v_cvt_pk_bf16_f32 v147, v118, v119
  v_mfma_f32_32x32x16_bf16 v[128:143], a[4:7], v[44:47], v[128:143]
  v_exp_f32 v120, v120
  v_exp_f32 v121, v121
  v_exp_f32 v122, v122
  v_exp_f32 v123, v123
  v_cvt_pk_bf16_f32 v148, v120, v121
  v_cvt_pk_bf16_f32 v149, v122, v123
  v_mfma_f32_32x32x16_bf16 v[80:95], a[8:11], v[144:147], v[80:95]
  s_waitcnt vmcnt(21)
  v_exp_f32 v124, v124
  v_exp_f32 v125, v125
  v_exp_f32 v126, v126
  v_exp_f32 v127, v127
  v_cvt_pk_bf16_f32 v150, v124, v125
  v_cvt_pk_bf16_f32 v151, v126, v127
  v_mfma_f32_32x32x16_bf16 v[112:127], a[16:19], v[16:19], 0
  v_exp_f32 v128, v128
  v_exp_f32 v129, v129
  v_exp_f32 v130, v130
  v_exp_f32 v131, v131
  v_cvt_pk_bf16_f32 v144, v128, v129
  v_cvt_pk_bf16_f32 v145, v130, v131
  v_mfma_f32_32x32x16_bf16 v[80:95], a[12:15], v[148:151], v[80:95]
  v_exp_f32 v132, v132
  v_exp_f32 v133, v133
  v_exp_f32 v134, v134
  v_exp_f32 v135, v135
  v_cvt_pk_bf16_f32 v146, v132, v133
  v_cvt_pk_bf16_f32 v147, v134, v135
  v_mfma_f32_32x32x16_bf16 v[112:127], a[20:23], v[20:23], v[112:127]
  v_exp_f32 v136, v136
  v_exp_f32 v137, v137
  v_exp_f32 v138, v138
  v_exp_f32 v139, v139
  v_cvt_pk_bf16_f32 v148, v136, v137
  v_cvt_pk_bf16_f32 v149, v138, v139
  v_mfma_f32_32x32x16_bf16 v[96:111], a[8:11], v[144:147], v[96:111]
  v_exp_f32 v140, v140
  v_exp_f32 v141, v141
  v_exp_f32 v142, v142
  v_exp_f32 v143, v143
  v_cvt_pk_bf16_f32 v150, v140, v141
  v_cvt_pk_bf16_f32 v151, v142, v143
  v_mfma_f32_32x32x16_bf16 v[128:143], a[16:19], v[24:27], 0
  v_exp_f32 v112, v112
  v_exp_f32 v113, v113
  v_exp_f32 v114, v114
  v_exp_f32 v115, v115
  v_cvt_pk_bf16_f32 v144, v112, v113
  v_cvt_pk_bf16_f32 v145, v114, v115
  v_mfma_f32_32x32x16_bf16 v[96:111], a[12:15], v[148:151], v[96:111]
  v_exp_f32 v116, v116
  v_exp_f32 v117, v117
  v_exp_f32 v118, v118
  v_exp_f32 v119, v119
  v_cvt_pk_bf16_f32 v146, v116, v117
  v_cvt_pk_bf16_f32 v147, v118, v119
  v_mfma_f32_32x32x16_bf16 v[128:143], a[20:23], v[28:31], v[128:143]
  v_exp_f32 v120, v120
  v_exp_f32 v121, v121
  v_exp_f32 v122, v122
  v_exp_f32 v123, v123
  v_cvt_pk_bf16_f32 v148, v120, v121
  v_cvt_pk_bf16_f32 v149, v122, v123
  v_mfma_f32_32x32x16_bf16 v[48:63], a[24:27], v[144:147], v[48:63]
  v_exp_f32 v124, v124
  v_exp_f32 v125, v125
  v_exp_f32 v126, v126
  v_exp_f32 v127, v127
  v_cvt_pk_bf16_f32 v150, v124, v125
  v_cvt_pk_bf16_f32 v151, v126, v127
  v_mfma_f32_32x32x16_bf16 v[112:127], a[16:19], v[32:35], 0
  v_exp_f32 v128, v128
  v_exp_f32 v129, v129
  v_exp_f32 v130, v130
  v_exp_f32 v131, v131
  v_cvt_pk_bf16_f32 v144, v128, v129
  v_cvt_pk_bf16_f32 v145, v130, v131
  v_mfma_f32_32x32x16_bf16 v[48:63], a[28:31], v[148:151], v[48:63]
  v_exp_f32 v132, v132
  v_exp_f32 v133, v133
  v_exp_f32 v134, v134
  v_exp_f32 v135, v135
  v_cvt_pk_bf16_f32 v146, v132, v133
  v_cvt_pk_bf16_f32 v147, v134, v135
  v_mfma_f32_32x32x16_bf16 v[112:127], a[20:23], v[36:39], v[112:127]
  v_exp_f32 v136, v136
  v_exp_f32 v137, v137
  v_exp_f32 v138, v138
  v_exp_f32 v139, v139
  v_cvt_pk_bf16_f32 v148, v136, v137
  v_cvt_pk_bf16_f32 v149, v138, v139
  v_mfma_f32_32x32x16_bf16 v[64:79], a[24:27], v[144:147], v[64:79]
  v_exp_f32 v140, v140
  v_exp_f32 v141, v141
  v_exp_f32 v142, v142
  v_exp_f32 v143, v143
  v_cvt_pk_bf16_f32 v150, v140, v141
  v_cvt_pk_bf16_f32 v151, v142, v143
  v_mfma_f32_32x32x16_bf16 v[128:143], a[16:19], v[40:43], 0
  v_exp_f32 v112, v112
  v_exp_f32 v113, v113
  v_exp_f32 v114, v114
  v_exp_f32 v115, v115
  v_cvt_pk_bf16_f32 v144, v112, v113
  v_cvt_pk_bf16_f32 v145, v114, v115
  v_mfma_f32_32x32x16_bf16 v[64:79], a[28:31], v[148:151], v[64:79]
  v_exp_f32 v116, v116
  v_exp_f32 v117, v117
  v_exp_f32 v118, v118
  v_exp_f32 v119, v119
  v_cvt_pk_bf16_f32 v146, v116, v117
  v_cvt_pk_bf16_f32 v147, v118, v119
  v_mfma_f32_32x32x16_bf16 v[128:143], a[20:23], v[44:47], v[128:143]
  v_exp_f32 v120, v120
  v_exp_f32 v121, v121
  v_exp_f32 v122, v122
  v_exp_f32 v123, v123
  v_cvt_pk_bf16_f32 v148, v120, v121
  v_cvt_pk_bf16_f32 v149, v122, v123
  v_mfma_f32_32x32x16_bf16 v[80:95], a[24:27], v[144:147], v[80:95]
  s_waitcnt vmcnt(17)
  v_exp_f32 v124, v124
  v_exp_f32 v125, v125
  v_exp_f32 v126, v126
  v_exp_f32 v127, v127
  v_cvt_pk_bf16_f32 v150, v124, v125
  v_cvt_pk_bf16_f32 v151, v126, v127
  v_mfma_f32_32x32x16_bf16 v[112:127], a[32:35], v[16:19], 0
  global_load_dwordx4 a[112:115], v7, s[54:55] offset:0 sc1
  v_exp_f32 v128, v128
  v_exp_f32 v129, v129
  v_exp_f32 v130, v130
  v_exp_f32 v131, v131
  v_cvt_pk_bf16_f32 v144, v128, v129
  v_cvt_pk_bf16_f32 v145, v130, v131
  v_mfma_f32_32x32x16_bf16 v[80:95], a[28:31], v[148:151], v[80:95]
  global_load_dwordx4 a[116:119], v7, s[54:55] offset:1024 sc1
  v_exp_f32 v132, v132
  v_exp_f32 v133, v133
  v_exp_f32 v134, v134
  v_exp_f32 v135, v135
  v_cvt_pk_bf16_f32 v146, v132, v133
  v_cvt_pk_bf16_f32 v147, v134, v135
  v_mfma_f32_32x32x16_bf16 v[112:127], a[36:39], v[20:23], v[112:127]
  global_load_dwordx4 a[120:123], v7, s[54:55] offset:2048 sc1
  v_exp_f32 v136, v136
  v_exp_f32 v137, v137
  v_exp_f32 v138, v138
  v_exp_f32 v139, v139
  v_cvt_pk_bf16_f32 v148, v136, v137
  v_cvt_pk_bf16_f32 v149, v138, v139
  v_mfma_f32_32x32x16_bf16 v[96:111], a[24:27], v[144:147], v[96:111]
  v_exp_f32 v140, v140
  v_exp_f32 v141, v141
  v_exp_f32 v142, v142
  v_exp_f32 v143, v143
  v_cvt_pk_bf16_f32 v150, v140, v141
  v_cvt_pk_bf16_f32 v151, v142, v143
  v_mfma_f32_32x32x16_bf16 v[128:143], a[32:35], v[24:27], 0
  global_load_dwordx4 a[124:127], v7, s[54:55] offset:3072 sc1
  v_exp_f32 v112, v112
  v_exp_f32 v113, v113
  v_exp_f32 v114, v114
  v_exp_f32 v115, v115
  v_cvt_pk_bf16_f32 v144, v112, v113
  v_cvt_pk_bf16_f32 v145, v114, v115
  v_mfma_f32_32x32x16_bf16 v[96:111], a[28:31], v[148:151], v[96:111]
  s_add_u32 s54, s54, 8192
  s_addc_u32 s55, s55, 0
  global_load_dwordx4 v[152:155], v7, s[54:55] offset:-4096 sc1
  v_exp_f32 v116, v116
  v_exp_f32 v117, v117
  v_exp_f32 v118, v118
  v_exp_f32 v119, v119
  v_cvt_pk_bf16_f32 v146, v116, v117
  v_cvt_pk_bf16_f32 v147, v118, v119
  v_mfma_f32_32x32x16_bf16 v[128:143], a[36:39], v[28:31], v[128:143]
  global_load_dwordx4 v[156:159], v7, s[54:55] offset:-3072 sc1
  v_exp_f32 v120, v120
  v_exp_f32 v121, v121
  v_exp_f32 v122, v122
  v_exp_f32 v123, v123
  v_cvt_pk_bf16_f32 v148, v120, v121
  v_cvt_pk_bf16_f32 v149, v122, v123
  v_mfma_f32_32x32x16_bf16 v[48:63], a[40:43], v[144:147], v[48:63]
  v_exp_f32 v124, v124
  v_exp_f32 v125, v125
  v_exp_f32 v126, v126
  v_exp_f32 v127, v127
  v_cvt_pk_bf16_f32 v150, v124, v125
  v_cvt_pk_bf16_f32 v151, v126, v127
  v_mfma_f32_32x32x16_bf16 v[112:127], a[32:35], v[32:35], 0
  global_load_dwordx4 v[160:163], v7, s[54:55] offset:-2048 sc1
  v_exp_f32 v128, v128
  v_exp_f32 v129, v129
  v_exp_f32 v130, v130
  v_exp_f32 v131, v131
  v_cvt_pk_bf16_f32 v144, v128, v129
  v_cvt_pk_bf16_f32 v145, v130, v131
  v_mfma_f32_32x32x16_bf16 v[48:63], a[44:47], v[148:151], v[48:63]
  global_load_dwordx4 v[164:167], v7, s[54:55] offset:-1024 sc1
  v_exp_f32 v132, v132
  v_exp_f32 v133, v133
  v_exp_f32 v134, v134
  v_exp_f32 v135, v135
  v_cvt_pk_bf16_f32 v146, v132, v133
  v_cvt_pk_bf16_f32 v147, v134, v135
  v_mfma_f32_32x32x16_bf16 v[112:127], a[36:39], v[36:39], v[112:127]
  buffer_store_dwordx4 v[224:227], v14, s[80:83], s99 offen offset:1024 sc1
  v_exp_f32 v136, v136
  v_exp_f32 v137, v137
  v_exp_f32 v138, v138
  v_exp_f32 v139, v139
  v_cvt_pk_bf16_f32 v148, v136, v137
  v_cvt_pk_bf16_f32 v149, v138, v139
  v_mfma_f32_32x32x16_bf16 v[64:79], a[40:43], v[144:147], v[64:79]
  v_exp_f32 v140, v140
  v_exp_f32 v141, v141
  v_exp_f32 v142, v142
  v_exp_f32 v143, v143
  v_cvt_pk_bf16_f32 v150, v140, v141
  v_cvt_pk_bf16_f32 v151, v142, v143
  v_mfma_f32_32x32x16_bf16 v[128:143], a[32:35], v[40:43], 0
  buffer_store_dwordx4 v[224:227], v7, s[84:87], s100 offen sc1
  v_exp_f32 v112, v112
  v_exp_f32 v113, v113
  v_exp_f32 v114, v114
  v_exp_f32 v115, v115
  v_cvt_pk_bf16_f32 v144, v112, v113
  v_cvt_pk_bf16_f32 v145, v114, v115
  v_mfma_f32_32x32x16_bf16 v[64:79], a[44:47], v[148:151], v[64:79]
  buffer_store_dwordx4 v[224:227], v7, s[84:87], s78 offen sc1
  v_exp_f32 v116, v116
  v_exp_f32 v117, v117
  v_exp_f32 v118, v118
  v_exp_f32 v119, v119
  v_cvt_pk_bf16_f32 v146, v116, v117
  v_cvt_pk_bf16_f32 v147, v118, v119
  v_mfma_f32_32x32x16_bf16 v[128:143], a[36:39], v[44:47], v[128:143]
  global_load_dwordx4 v[168:171], v7, s[54:55] offset:0 sc1
  v_exp_f32 v120, v120
  v_exp_f32 v121, v121
  v_exp_f32 v122, v122
  v_exp_f32 v123, v123
  v_cvt_pk_bf16_f32 v148, v120, v121
  v_cvt_pk_bf16_f32 v149, v122, v123
  v_mfma_f32_32x32x16_bf16 v[80:95], a[40:43], v[144:147], v[80:95]
  s_waitcnt vmcnt(25)
  v_exp_f32 v124, v124
  v_exp_f32 v125, v125
  v_exp_f32 v126, v126
  v_exp_f32 v127, v127
  v_cvt_pk_bf16_f32 v150, v124, v125
  v_cvt_pk_bf16_f32 v151, v126, v127
  v_mfma_f32_32x32x16_bf16 v[112:127], a[48:51], v[16:19], 0
  global_load_dwordx4 v[172:175], v7, s[54:55] offset:1024 sc1
  v_exp_f32 v128, v128
  v_exp_f32 v129, v129
  v_exp_f32 v130, v130
  v_exp_f32 v131, v131
  v_cvt_pk_bf16_f32 v144, v128, v129
  v_cvt_pk_bf16_f32 v145, v130, v131
  v_mfma_f32_32x32x16_bf16 v[80:95], a[44:47], v[148:151], v[80:95]
  global_load_dwordx4 v[176:179], v7, s[54:55] offset:2048 sc1
  v_exp_f32 v132, v132
  v_exp_f32 v133, v133
  v_exp_f32 v134, v134
  v_exp_f32 v135, v135
  v_cvt_pk_bf16_f32 v146, v132, v133
  v_cvt_pk_bf16_f32 v147, v134, v135
  v_mfma_f32_32x32x16_bf16 v[112:127], a[52:55], v[20:23], v[112:127]
  global_load_dwordx4 v[180:183], v7, s[54:55] offset:3072 sc1
  v_exp_f32 v136, v136
  v_exp_f32 v137, v137
  v_exp_f32 v138, v138
  v_exp_f32 v139, v139
  v_cvt_pk_bf16_f32 v148, v136, v137
  v_cvt_pk_bf16_f32 v149, v138, v139
  v_mfma_f32_32x32x16_bf16 v[96:111], a[40:43], v[144:147], v[96:111]
  s_add_u32 s54, s54, 8192
  s_addc_u32 s55, s55, 0
  v_exp_f32 v140, v140
  v_exp_f32 v141, v141
  v_exp_f32 v142, v142
  v_exp_f32 v143, v143
  v_cvt_pk_bf16_f32 v150, v140, v141
  v_cvt_pk_bf16_f32 v151, v142, v143
  v_mfma_f32_32x32x16_bf16 v[128:143], a[48:51], v[24:27], 0
  global_load_dwordx4 v[184:187], v7, s[54:55] offset:-4096 sc1
  v_exp_f32 v112, v112
  v_exp_f32 v113, v113
  v_exp_f32 v114, v114
  v_exp_f32 v115, v115
  v_cvt_pk_bf16_f32 v144, v112, v113
  v_cvt_pk_bf16_f32 v145, v114, v115
  v_mfma_f32_32x32x16_bf16 v[96:111], a[44:47], v[148:151], v[96:111]
  global_load_dwordx4 v[188:191], v7, s[54:55] offset:-3072 sc1
  v_exp_f32 v116, v116
  v_exp_f32 v117, v117
  v_exp_f32 v118, v118
  v_exp_f32 v119, v119
  v_cvt_pk_bf16_f32 v146, v116, v117
  v_cvt_pk_bf16_f32 v147, v118, v119
  v_mfma_f32_32x32x16_bf16 v[128:143], a[52:55], v[28:31], v[128:143]
  global_load_dwordx4 v[192:195], v7, s[54:55] offset:-2048 sc1
  v_exp_f32 v120, v120
  v_exp_f32 v121, v121
  v_exp_f32 v122, v122
  v_exp_f32 v123, v123
  v_cvt_pk_bf16_f32 v148, v120, v121
  v_cvt_pk_bf16_f32 v149, v122, v123
  v_mfma_f32_32x32x16_bf16 v[48:63], a[56:59], v[144:147], v[48:63]
  v_exp_f32 v124, v124
  v_exp_f32 v125, v125
  v_exp_f32 v126, v126
  v_exp_f32 v127, v127
  v_cvt_pk_bf16_f32 v150, v124, v125
  v_cvt_pk_bf16_f32 v151, v126, v127
  v_mfma_f32_32x32x16_bf16 v[112:127], a[48:51], v[32:35], 0
  global_load_dwordx4 v[196:199], v7, s[54:55] offset:-1024 sc1
  v_exp_f32 v128, v128
  v_exp_f32 v129, v129
  v_exp_f32 v130, v130
  v_exp_f32 v131, v131
  v_cvt_pk_bf16_f32 v144, v128, v129
  v_cvt_pk_bf16_f32 v145, v130, v131
  v_mfma_f32_32x32x16_bf16 v[48:63], a[60:63], v[148:151], v[48:63]
  global_load_dwordx4 v[200:203], v7, s[54:55] offset:0 sc1
  v_exp_f32 v132, v132
  v_exp_f32 v133, v133
  v_exp_f32 v134, v134
  v_exp_f32 v135, v135
  v_cvt_pk_bf16_f32 v146, v132, v133
  v_cvt_pk_bf16_f32 v147, v134, v135
  v_mfma_f32_32x32x16_bf16 v[112:127], a[52:55], v[36:39], v[112:127]
  global_load_dwordx4 v[204:207], v7, s[54:55] offset:1024 sc1
  v_exp_f32 v136, v136
  v_exp_f32 v137, v137
  v_exp_f32 v138, v138
  v_exp_f32 v139, v139
  v_cvt_pk_bf16_f32 v148, v136, v137
  v_cvt_pk_bf16_f32 v149, v138, v139
  v_mfma_f32_32x32x16_bf16 v[64:79], a[56:59], v[144:147], v[64:79]
  v_exp_f32 v140, v140
  v_exp_f32 v141, v141
  v_exp_f32 v142, v142
  v_exp_f32 v143, v143
  v_cvt_pk_bf16_f32 v150, v140, v141
  v_cvt_pk_bf16_f32 v151, v142, v143
  v_mfma_f32_32x32x16_bf16 v[128:143], a[48:51], v[40:43], 0
  global_load_dwordx4 v[208:211], v7, s[54:55] offset:2048 sc1
  v_exp_f32 v112, v112
  v_exp_f32 v113, v113
  v_exp_f32 v114, v114
  v_exp_f32 v115, v115
  v_cvt_pk_bf16_f32 v144, v112, v113
  v_cvt_pk_bf16_f32 v145, v114, v115
  v_mfma_f32_32x32x16_bf16 v[64:79], a[60:63], v[148:151], v[64:79]
  global_load_dwordx4 v[212:215], v7, s[54:55] offset:3072 sc1
  v_exp_f32 v116, v116
  v_exp_f32 v117, v117
  v_exp_f32 v118, v118
  v_exp_f32 v119, v119
  v_cvt_pk_bf16_f32 v146, v116, v117
  v_cvt_pk_bf16_f32 v147, v118, v119
  v_mfma_f32_32x32x16_bf16 v[128:143], a[52:55], v[44:47], v[128:143]
  buffer_load_dwordx4 v[240:243], v244, s[16:19], s65 offen offset:0
  v_exp_f32 v120, v120
  v_exp_f32 v121, v121
  v_exp_f32 v122, v122
  v_exp_f32 v123, v123
  v_cvt_pk_bf16_f32 v148, v120, v121
  v_cvt_pk_bf16_f32 v149, v122, v123
  v_mfma_f32_32x32x16_bf16 v[80:95], a[56:59], v[144:147], v[80:95]
  s_waitcnt vmcnt(33)
  v_exp_f32 v124, v124
  v_exp_f32 v125, v125
  v_exp_f32 v126, v126
  v_exp_f32 v127, v127
  v_cvt_pk_bf16_f32 v150, v124, v125
  v_cvt_pk_bf16_f32 v151, v126, v127
  v_mfma_f32_32x32x16_bf16 v[112:127], a[64:67], v[16:19], 0
  buffer_load_dwordx4 v[244:247], v244, s[16:19], s65 offen offset:64
  v_exp_f32 v128, v128
  v_exp_f32 v129, v129
  v_exp_f32 v130, v130
  v_exp_f32 v131, v131
  v_cvt_pk_bf16_f32 v144, v128, v129
  v_cvt_pk_bf16_f32 v145, v130, v131
  v_mfma_f32_32x32x16_bf16 v[80:95], a[60:63], v[148:151], v[80:95]
  buffer_load_dwordx2 v[248:249], v250, s[36:39], s66 offen offset:0
  v_exp_f32 v132, v132
  v_exp_f32 v133, v133
  v_exp_f32 v134, v134
  v_exp_f32 v135, v135
  v_cvt_pk_bf16_f32 v146, v132, v133
  v_cvt_pk_bf16_f32 v147, v134, v135
  v_mfma_f32_32x32x16_bf16 v[112:127], a[68:71], v[20:23], v[112:127]
  buffer_load_dwordx2 v[250:251], v250, s[36:39], s66 offen offset:16
  v_exp_f32 v136, v136
  v_exp_f32 v137, v137
  v_exp_f32 v138, v138
  v_exp_f32 v139, v139
  v_cvt_pk_bf16_f32 v148, v136, v137
  v_cvt_pk_bf16_f32 v149, v138, v139
  v_mfma_f32_32x32x16_bf16 v[96:111], a[56:59], v[144:147], v[96:111]
  v_exp_f32 v140, v140
  v_exp_f32 v141, v141
  v_exp_f32 v142, v142
  v_exp_f32 v143, v143
  v_cvt_pk_bf16_f32 v150, v140, v141
  v_cvt_pk_bf16_f32 v151, v142, v143
  v_mfma_f32_32x32x16_bf16 v[128:143], a[64:67], v[24:27], 0
  buffer_load_ushort v252, v252, s[40:43], s68 offen
  v_exp_f32 v112, v112
  v_exp_f32 v113, v113
  v_exp_f32 v114, v114
  v_exp_f32 v115, v115
  v_cvt_pk_bf16_f32 v144, v112, v113
  v_cvt_pk_bf16_f32 v145, v114, v115
  v_mfma_f32_32x32x16_bf16 v[96:111], a[60:63], v[148:151], v[96:111]
  v_exp_f32 v116, v116
  v_exp_f32 v117, v117
  v_exp_f32 v118, v118
  v_exp_f32 v119, v119
  v_cvt_pk_bf16_f32 v146, v116, v117
  v_cvt_pk_bf16_f32 v147, v118, v119
  v_mfma_f32_32x32x16_bf16 v[128:143], a[68:71], v[28:31], v[128:143]
  v_exp_f32 v120, v120
  v_exp_f32 v121, v121
  v_exp_f32 v122, v122
  v_exp_f32 v123, v123
  v_cvt_pk_bf16_f32 v148, v120, v121
  v_cvt_pk_bf16_f32 v149, v122, v123
  v_mfma_f32_32x32x16_bf16 v[48:63], a[72:75], v[144:147], v[48:63]
  s_waitcnt vmcnt(17)
  s_mov_b64 exec, 7
  buffer_store_dword v224, v233, s[12:15], s101 offen offset:16 sc1
  s_mov_b64 exec, -1
  v_exp_f32 v124, v124
  v_exp_f32 v125, v125
  v_exp_f32 v126, v126
  v_exp_f32 v127, v127
  v_cvt_pk_bf16_f32 v150, v124, v125
  v_cvt_pk_bf16_f32 v151, v126, v127
  v_mfma_f32_32x32x16_bf16 v[112:127], a[64:67], v[32:35], 0
  v_exp_f32 v128, v128
  v_exp_f32 v129, v129
  v_exp_f32 v130, v130
  v_exp_f32 v131, v131
  v_cvt_pk_bf16_f32 v144, v128, v129
  v_cvt_pk_bf16_f32 v145, v130, v131
  v_mfma_f32_32x32x16_bf16 v[48:63], a[76:79], v[148:151], v[48:63]
  buffer_load_dword v5, v222, s[28:31], s70 offen
  s_add_u32 s70, s70, 458752
  v_exp_f32 v132, v132
  v_exp_f32 v133, v133
  v_exp_f32 v134, v134
  v_exp_f32 v135, v135
  v_cvt_pk_bf16_f32 v146, v132, v133
  v_cvt_pk_bf16_f32 v147, v134, v135
  v_mfma_f32_32x32x16_bf16 v[112:127], a[68:71], v[36:39], v[112:127]
  v_exp_f32 v136, v136
  v_exp_f32 v137, v137
  v_exp_f32 v138, v138
  v_exp_f32 v139, v139
  v_cvt_pk_bf16_f32 v148, v136, v137
  v_cvt_pk_bf16_f32 v149, v138, v139
  v_mfma_f32_32x32x16_bf16 v[64:79], a[72:75], v[144:147], v[64:79]
  v_exp_f32 v140, v140
  v_exp_f32 v141, v141
  v_exp_f32 v142, v142
  v_exp_f32 v143, v143
  v_cvt_pk_bf16_f32 v150, v140, v141
  v_cvt_pk_bf16_f32 v151, v142, v143
  v_mfma_f32_32x32x16_bf16 v[128:143], a[64:67], v[40:43], 0
  v_exp_f32 v112, v112
  v_exp_f32 v113, v113
  v_exp_f32 v114, v114
  v_exp_f32 v115, v115
  v_cvt_pk_bf16_f32 v144, v112, v113
  v_cvt_pk_bf16_f32 v145, v114, v115
  v_mfma_f32_32x32x16_bf16 v[64:79], a[76:79], v[148:151], v[64:79]
  v_exp_f32 v116, v116
  v_exp_f32 v117, v117
  v_exp_f32 v118, v118
  v_exp_f32 v119, v119
  v_cvt_pk_bf16_f32 v146, v116, v117
  v_cvt_pk_bf16_f32 v147, v118, v119
  v_mfma_f32_32x32x16_bf16 v[128:143], a[68:71], v[44:47], v[128:143]
  v_exp_f32 v120, v120
  v_exp_f32 v121, v121
  v_exp_f32 v122, v122
  v_exp_f32 v123, v123
  v_cvt_pk_bf16_f32 v148, v120, v121
  v_cvt_pk_bf16_f32 v149, v122, v123
  v_mfma_f32_32x32x16_bf16 v[80:95], a[72:75], v[144:147], v[80:95]
  v_exp_f32 v124, v124
  v_exp_f32 v125, v125
  v_exp_f32 v126, v126
  v_exp_f32 v127, v127
  v_cvt_pk_bf16_f32 v150, v124, v125
  v_cvt_pk_bf16_f32 v151, v126, v127
  v_mfma_f32_32x32x16_bf16 v[112:127], a[80:83], v[16:19], 0
  v_exp_f32 v128, v128
  v_exp_f32 v129, v129
  v_exp_f32 v130, v130
  v_exp_f32 v131, v131
  v_cvt_pk_bf16_f32 v144, v128, v129
  v_cvt_pk_bf16_f32 v145, v130, v131
  v_mfma_f32_32x32x16_bf16 v[80:95], a[76:79], v[148:151], v[80:95]
  v_exp_f32 v132, v132
  v_exp_f32 v133, v133
  v_exp_f32 v134, v134
  v_exp_f32 v135, v135
  v_cvt_pk_bf16_f32 v146, v132, v133
  v_cvt_pk_bf16_f32 v147, v134, v135
  v_mfma_f32_32x32x16_bf16 v[112:127], a[84:87], v[20:23], v[112:127]
  v_exp_f32 v136, v136
  v_exp_f32 v137, v137
  v_exp_f32 v138, v138
  v_exp_f32 v139, v139
  v_cvt_pk_bf16_f32 v148, v136, v137
  v_cvt_pk_bf16_f32 v149, v138, v139
  v_mfma_f32_32x32x16_bf16 v[96:111], a[72:75], v[144:147], v[96:111]
  v_exp_f32 v140, v140
  v_exp_f32 v141, v141
  v_exp_f32 v142, v142
  v_exp_f32 v143, v143
  v_cvt_pk_bf16_f32 v150, v140, v141
  v_cvt_pk_bf16_f32 v151, v142, v143
  v_mfma_f32_32x32x16_bf16 v[128:143], a[80:83], v[24:27], 0
  v_exp_f32 v112, v112
  v_exp_f32 v113, v113
  v_exp_f32 v114, v114
  v_exp_f32 v115, v115
  v_cvt_pk_bf16_f32 v144, v112, v113
  v_cvt_pk_bf16_f32 v145, v114, v115
  v_mfma_f32_32x32x16_bf16 v[96:111], a[76:79], v[148:151], v[96:111]
  buffer_load_dword v5, v222, s[28:31], s70 offen
  s_add_u32 s70, s70, 458752
  v_exp_f32 v116, v116
  v_exp_f32 v117, v117
  v_exp_f32 v118, v118
  v_exp_f32 v119, v119
  v_cvt_pk_bf16_f32 v146, v116, v117
  v_cvt_pk_bf16_f32 v147, v118, v119
  v_mfma_f32_32x32x16_bf16 v[128:143], a[84:87], v[28:31], v[128:143]
  v_exp_f32 v120, v120
  v_exp_f32 v121, v121
  v_exp_f32 v122, v122
  v_exp_f32 v123, v123
  v_cvt_pk_bf16_f32 v148, v120, v121
  v_cvt_pk_bf16_f32 v149, v122, v123
  v_mfma_f32_32x32x16_bf16 v[48:63], a[88:91], v[144:147], v[48:63]
  v_exp_f32 v124, v124
  v_exp_f32 v125, v125
  v_exp_f32 v126, v126
  v_exp_f32 v127, v127
  v_cvt_pk_bf16_f32 v150, v124, v125
  v_cvt_pk_bf16_f32 v151, v126, v127
  v_mfma_f32_32x32x16_bf16 v[112:127], a[80:83], v[32:35], 0
  v_exp_f32 v128, v128
  v_exp_f32 v129, v129
  v_exp_f32 v130, v130
  v_exp_f32 v131, v131
  v_cvt_pk_bf16_f32 v144, v128, v129
  v_cvt_pk_bf16_f32 v145, v130, v131
  v_mfma_f32_32x32x16_bf16 v[48:63], a[92:95], v[148:151], v[48:63]
  v_exp_f32 v132, v132
  v_exp_f32 v133, v133
  v_exp_f32 v134, v134
  v_exp_f32 v135, v135
  v_cvt_pk_bf16_f32 v146, v132, v133
  v_cvt_pk_bf16_f32 v147, v134, v135
  v_mfma_f32_32x32x16_bf16 v[112:127], a[84:87], v[36:39], v[112:127]
  v_exp_f32 v136, v136
  v_exp_f32 v137, v137
  v_exp_f32 v138, v138
  v_exp_f32 v139, v139
  v_cvt_pk_bf16_f32 v148, v136, v137
  v_cvt_pk_bf16_f32 v149, v138, v139
  v_mfma_f32_32x32x16_bf16 v[64:79], a[88:91], v[144:147], v[64:79]
  v_exp_f32 v140, v140
  v_exp_f32 v141, v141
  v_exp_f32 v142, v142
  v_exp_f32 v143, v143
  v_cvt_pk_bf16_f32 v150, v140, v141
  v_cvt_pk_bf16_f32 v151, v142, v143
  v_mfma_f32_32x32x16_bf16 v[128:143], a[80:83], v[40:43], 0
  v_exp_f32 v112, v112
  v_exp_f32 v113, v113
  v_exp_f32 v114, v114
  v_exp_f32 v115, v115
  v_cvt_pk_bf16_f32 v144, v112, v113
  v_cvt_pk_bf16_f32 v145, v114, v115
  v_mfma_f32_32x32x16_bf16 v[64:79], a[92:95], v[148:151], v[64:79]
  v_exp_f32 v116, v116
  v_exp_f32 v117, v117
  v_exp_f32 v118, v118
  v_exp_f32 v119, v119
  v_cvt_pk_bf16_f32 v146, v116, v117
  v_cvt_pk_bf16_f32 v147, v118, v119
  v_mfma_f32_32x32x16_bf16 v[128:143], a[84:87], v[44:47], v[128:143]
  v_exp_f32 v120, v120
  v_exp_f32 v121, v121
  v_exp_f32 v122, v122
  v_exp_f32 v123, v123
  v_cvt_pk_bf16_f32 v148, v120, v121
  v_cvt_pk_bf16_f32 v149, v122, v123
  v_mfma_f32_32x32x16_bf16 v[80:95], a[88:91], v[144:147], v[80:95]
  v_exp_f32 v124, v124
  v_exp_f32 v125, v125
  v_exp_f32 v126, v126
  v_exp_f32 v127, v127
  v_cvt_pk_bf16_f32 v150, v124, v125
  v_cvt_pk_bf16_f32 v151, v126, v127
  v_mfma_f32_32x32x16_bf16 v[112:127], a[96:99], v[16:19], 0
  v_exp_f32 v128, v128
  v_exp_f32 v129, v129
  v_exp_f32 v130, v130
  v_exp_f32 v131, v131
  v_cvt_pk_bf16_f32 v144, v128, v129
  v_cvt_pk_bf16_f32 v145, v130, v131
  v_mfma_f32_32x32x16_bf16 v[80:95], a[92:95], v[148:151], v[80:95]
  buffer_load_dword v5, v222, s[28:31], s70 offen
  s_add_u32 s70, s70, 458752
  v_exp_f32 v132, v132
  v_exp_f32 v133, v133
  v_exp_f32 v134, v134
  v_exp_f32 v135, v135
  v_cvt_pk_bf16_f32 v146, v132, v133
  v_cvt_pk_bf16_f32 v147, v134, v135
  v_mfma_f32_32x32x16_bf16 v[112:127], a[100:103], v[20:23], v[112:127]
  v_exp_f32 v136, v136
  v_exp_f32 v137, v137
  v_exp_f32 v138, v138
  v_exp_f32 v139, v139
  v_cvt_pk_bf16_f32 v148, v136, v137
  v_cvt_pk_bf16_f32 v149, v138, v139
  v_mfma_f32_32x32x16_bf16 v[96:111], a[88:91], v[144:147], v[96:111]
  v_exp_f32 v140, v140
  v_exp_f32 v141, v141
  v_exp_f32 v142, v142
  v_exp_f32 v143, v143
  v_cvt_pk_bf16_f32 v150, v140, v141
  v_cvt_pk_bf16_f32 v151, v142, v143
  v_mfma_f32_32x32x16_bf16 v[128:143], a[96:99], v[24:27], 0
  buffer_load_dwordx4 v[232:235], v229, s[12:15], s69 offen sc1
  v_exp_f32 v112, v112
  v_exp_f32 v113, v113
  v_exp_f32 v114, v114
  v_exp_f32 v115, v115
  v_cvt_pk_bf16_f32 v144, v112, v113
  v_cvt_pk_bf16_f32 v145, v114, v115
  v_mfma_f32_32x32x16_bf16 v[96:111], a[92:95], v[148:151], v[96:111]
  v_exp_f32 v116, v116
  v_exp_f32 v117, v117
  v_exp_f32 v118, v118
  v_exp_f32 v119, v119
  v_cvt_pk_bf16_f32 v146, v116, v117
  v_cvt_pk_bf16_f32 v147, v118, v119
  v_mfma_f32_32x32x16_bf16 v[128:143], a[100:103], v[28:31], v[128:143]
  v_exp_f32 v120, v120
  v_exp_f32 v121, v121
  v_exp_f32 v122, v122
  v_exp_f32 v123, v123
  v_cvt_pk_bf16_f32 v148, v120, v121
  v_cvt_pk_bf16_f32 v149, v122, v123
  v_mfma_f32_32x32x16_bf16 v[48:63], a[104:107], v[144:147], v[48:63]
  v_exp_f32 v124, v124
  v_exp_f32 v125, v125
  v_exp_f32 v126, v126
  v_exp_f32 v127, v127
  v_cvt_pk_bf16_f32 v150, v124, v125
  v_cvt_pk_bf16_f32 v151, v126, v127
  v_mfma_f32_32x32x16_bf16 v[112:127], a[96:99], v[32:35], 0
  v_exp_f32 v128, v128
  v_exp_f32 v129, v129
  v_exp_f32 v130, v130
  v_exp_f32 v131, v131
  v_cvt_pk_bf16_f32 v144, v128, v129
  v_cvt_pk_bf16_f32 v145, v130, v131
  v_mfma_f32_32x32x16_bf16 v[48:63], a[108:111], v[148:151], v[48:63]
  v_exp_f32 v132, v132
  v_exp_f32 v133, v133
  v_exp_f32 v134, v134
  v_exp_f32 v135, v135
  v_cvt_pk_bf16_f32 v146, v132, v133
  v_cvt_pk_bf16_f32 v147, v134, v135
  v_mfma_f32_32x32x16_bf16 v[112:127], a[100:103], v[36:39], v[112:127]
  v_exp_f32 v136, v136
  v_exp_f32 v137, v137
  v_exp_f32 v138, v138
  v_exp_f32 v139, v139
  v_cvt_pk_bf16_f32 v148, v136, v137
  v_cvt_pk_bf16_f32 v149, v138, v139
  v_mfma_f32_32x32x16_bf16 v[64:79], a[104:107], v[144:147], v[64:79]
  v_exp_f32 v140, v140
  v_exp_f32 v141, v141
  v_exp_f32 v142, v142
  v_exp_f32 v143, v143
  v_cvt_pk_bf16_f32 v150, v140, v141
  v_cvt_pk_bf16_f32 v151, v142, v143
  v_mfma_f32_32x32x16_bf16 v[128:143], a[96:99], v[40:43], 0
  v_exp_f32 v112, v112
  v_exp_f32 v113, v113
  v_exp_f32 v114, v114
  v_exp_f32 v115, v115
  v_cvt_pk_bf16_f32 v144, v112, v113
  v_cvt_pk_bf16_f32 v145, v114, v115
  v_mfma_f32_32x32x16_bf16 v[64:79], a[108:111], v[148:151], v[64:79]
  buffer_load_dword v5, v223, s[32:35], s71 offen
  s_add_u32 s71, s71, 458752
  v_exp_f32 v116, v116
  v_exp_f32 v117, v117
  v_exp_f32 v118, v118
  v_exp_f32 v119, v119
  v_cvt_pk_bf16_f32 v146, v116, v117
  v_cvt_pk_bf16_f32 v147, v118, v119
  v_mfma_f32_32x32x16_bf16 v[128:143], a[100:103], v[44:47], v[128:143]
  v_exp_f32 v120, v120
  v_exp_f32 v121, v121
  v_exp_f32 v122, v122
  v_exp_f32 v123, v123
  v_cvt_pk_bf16_f32 v148, v120, v121
  v_cvt_pk_bf16_f32 v149, v122, v123
  v_mfma_f32_32x32x16_bf16 v[80:95], a[104:107], v[144:147], v[80:95]
  v_exp_f32 v124, v124
  v_exp_f32 v125, v125
  v_exp_f32 v126, v126
  v_exp_f32 v127, v127
  v_cvt_pk_bf16_f32 v150, v124, v125
  v_cvt_pk_bf16_f32 v151, v126, v127
  v_mfma_f32_32x32x16_bf16 v[112:127], a[112:115], v[16:19], 0
  v_exp_f32 v128, v128
  v_exp_f32 v129, v129
  v_exp_f32 v130, v130
  v_exp_f32 v131, v131
  v_cvt_pk_bf16_f32 v144, v128, v129
  v_cvt_pk_bf16_f32 v145, v130, v131
  v_mfma_f32_32x32x16_bf16 v[80:95], a[108:111], v[148:151], v[80:95]
  v_exp_f32 v132, v132
  v_exp_f32 v133, v133
  v_exp_f32 v134, v134
  v_exp_f32 v135, v135
  v_cvt_pk_bf16_f32 v146, v132, v133
  v_cvt_pk_bf16_f32 v147, v134, v135
  v_mfma_f32_32x32x16_bf16 v[112:127], a[116:119], v[20:23], v[112:127]
  v_exp_f32 v136, v136
  v_exp_f32 v137, v137
  v_exp_f32 v138, v138
  v_exp_f32 v139, v139
  v_cvt_pk_bf16_f32 v148, v136, v137
  v_cvt_pk_bf16_f32 v149, v138, v139
  v_mfma_f32_32x32x16_bf16 v[96:111], a[104:107], v[144:147], v[96:111]
  v_exp_f32 v140, v140
  v_exp_f32 v141, v141
  v_exp_f32 v142, v142
  v_exp_f32 v143, v143
  v_cvt_pk_bf16_f32 v150, v140, v141
  v_cvt_pk_bf16_f32 v151, v142, v143
  v_mfma_f32_32x32x16_bf16 v[128:143], a[112:115], v[24:27], 0
  v_exp_f32 v112, v112
  v_exp_f32 v113, v113
  v_exp_f32 v114, v114
  v_exp_f32 v115, v115
  v_cvt_pk_bf16_f32 v144, v112, v113
  v_cvt_pk_bf16_f32 v145, v114, v115
  v_mfma_f32_32x32x16_bf16 v[96:111], a[108:111], v[148:151], v[96:111]
  v_exp_f32 v116, v116
  v_exp_f32 v117, v117
  v_exp_f32 v118, v118
  v_exp_f32 v119, v119
  v_cvt_pk_bf16_f32 v146, v116, v117
  v_cvt_pk_bf16_f32 v147, v118, v119
  v_mfma_f32_32x32x16_bf16 v[128:143], a[116:119], v[28:31], v[128:143]
  v_exp_f32 v120, v120
  v_exp_f32 v121, v121
  v_exp_f32 v122, v122
  v_exp_f32 v123, v123
  v_cvt_pk_bf16_f32 v148, v120, v121
  v_cvt_pk_bf16_f32 v149, v122, v123
  v_mfma_f32_32x32x16_bf16 v[48:63], a[120:123], v[144:147], v[48:63]
  v_exp_f32 v124, v124
  v_exp_f32 v125, v125
  v_exp_f32 v126, v126
  v_exp_f32 v127, v127
  v_cvt_pk_bf16_f32 v150, v124, v125
  v_cvt_pk_bf16_f32 v151, v126, v127
  v_mfma_f32_32x32x16_bf16 v[112:127], a[112:115], v[32:35], 0
  v_exp_f32 v128, v128
  v_exp_f32 v129, v129
  v_exp_f32 v130, v130
  v_exp_f32 v131, v131
  v_cvt_pk_bf16_f32 v144, v128, v129
  v_cvt_pk_bf16_f32 v145, v130, v131
  v_mfma_f32_32x32x16_bf16 v[48:63], a[124:127], v[148:151], v[48:63]
  buffer_load_dword v5, v223, s[32:35], s71 offen
  s_add_u32 s71, s71, 458752
  v_exp_f32 v132, v132
  v_exp_f32 v133, v133
  v_exp_f32 v134, v134
  v_exp_f32 v135, v135
  v_cvt_pk_bf16_f32 v146, v132, v133
  v_cvt_pk_bf16_f32 v147, v134, v135
  v_mfma_f32_32x32x16_bf16 v[112:127], a[116:119], v[36:39], v[112:127]
  v_exp_f32 v136, v136
  v_exp_f32 v137, v137
  v_exp_f32 v138, v138
  v_exp_f32 v139, v139
  v_cvt_pk_bf16_f32 v148, v136, v137
  v_cvt_pk_bf16_f32 v149, v138, v139
  v_mfma_f32_32x32x16_bf16 v[64:79], a[120:123], v[144:147], v[64:79]
  v_exp_f32 v140, v140
  v_exp_f32 v141, v141
  v_exp_f32 v142, v142
  v_exp_f32 v143, v143
  v_cvt_pk_bf16_f32 v150, v140, v141
  v_cvt_pk_bf16_f32 v151, v142, v143
  v_mfma_f32_32x32x16_bf16 v[128:143], a[112:115], v[40:43], 0
  v_exp_f32 v112, v112
  v_exp_f32 v113, v113
  v_exp_f32 v114, v114
  v_exp_f32 v115, v115
  v_cvt_pk_bf16_f32 v144, v112, v113
  v_cvt_pk_bf16_f32 v145, v114, v115
  v_mfma_f32_32x32x16_bf16 v[64:79], a[124:127], v[148:151], v[64:79]
  v_exp_f32 v116, v116
  v_exp_f32 v117, v117
  v_exp_f32 v118, v118
  v_exp_f32 v119, v119
  v_cvt_pk_bf16_f32 v146, v116, v117
  v_cvt_pk_bf16_f32 v147, v118, v119
  v_mfma_f32_32x32x16_bf16 v[128:143], a[116:119], v[44:47], v[128:143]
  v_exp_f32 v120, v120
  v_exp_f32 v121, v121
  v_exp_f32 v122, v122
  v_exp_f32 v123, v123
  v_cvt_pk_bf16_f32 v148, v120, v121
  v_cvt_pk_bf16_f32 v149, v122, v123
  v_mfma_f32_32x32x16_bf16 v[80:95], a[120:123], v[144:147], v[80:95]
  v_exp_f32 v124, v124
  v_exp_f32 v125, v125
  v_exp_f32 v126, v126
  v_exp_f32 v127, v127
  v_cvt_pk_bf16_f32 v150, v124, v125
  v_cvt_pk_bf16_f32 v151, v126, v127
  v_mfma_f32_32x32x16_bf16 v[112:127], v[152:155], v[16:19], 0
  v_exp_f32 v128, v128
  v_exp_f32 v129, v129
  v_exp_f32 v130, v130
  v_exp_f32 v131, v131
  v_cvt_pk_bf16_f32 v144, v128, v129
  v_cvt_pk_bf16_f32 v145, v130, v131
  v_mfma_f32_32x32x16_bf16 v[80:95], a[124:127], v[148:151], v[80:95]
  v_exp_f32 v132, v132
  v_exp_f32 v133, v133
  v_exp_f32 v134, v134
  v_exp_f32 v135, v135
  v_cvt_pk_bf16_f32 v146, v132, v133
  v_cvt_pk_bf16_f32 v147, v134, v135
  v_mfma_f32_32x32x16_bf16 v[112:127], v[156:159], v[20:23], v[112:127]
  v_exp_f32 v136, v136
  v_exp_f32 v137, v137
  v_exp_f32 v138, v138
  v_exp_f32 v139, v139
  v_cvt_pk_bf16_f32 v148, v136, v137
  v_cvt_pk_bf16_f32 v149, v138, v139
  v_mfma_f32_32x32x16_bf16 v[96:111], a[120:123], v[144:147], v[96:111]
  s_waitcnt vmcnt(20)
  v_exp_f32 v140, v140
  v_exp_f32 v141, v141
  v_exp_f32 v142, v142
  v_exp_f32 v143, v143
  v_cvt_pk_bf16_f32 v150, v140, v141
  v_cvt_pk_bf16_f32 v151, v142, v143
  v_mfma_f32_32x32x16_bf16 v[128:143], v[168:171], v[16:19], 0
  v_exp_f32 v112, v112
  v_exp_f32 v113, v113
  v_exp_f32 v114, v114
  v_exp_f32 v115, v115
  v_cvt_pk_bf16_f32 v144, v112, v113
  v_cvt_pk_bf16_f32 v145, v114, v115
  v_mfma_f32_32x32x16_bf16 v[96:111], a[124:127], v[148:151], v[96:111]
  v_exp_f32 v116, v116
  v_exp_f32 v117, v117
  v_exp_f32 v118, v118
  v_exp_f32 v119, v119
  v_cvt_pk_bf16_f32 v146, v116, v117
  v_cvt_pk_bf16_f32 v147, v118, v119
  v_mfma_f32_32x32x16_bf16 v[128:143], v[172:175], v[20:23], v[128:143]
  v_exp_f32 v120, v120
  v_exp_f32 v121, v121
  v_exp_f32 v122, v122
  v_exp_f32 v123, v123
  v_cvt_pk_bf16_f32 v148, v120, v121
  v_cvt_pk_bf16_f32 v149, v122, v123
  v_mfma_f32_32x32x16_bf16 v[48:63], v[160:163], v[144:147], v[48:63]
  s_waitcnt vmcnt(16)
  v_exp_f32 v124, v124
  v_exp_f32 v125, v125
  v_exp_f32 v126, v126
  v_exp_f32 v127, v127
  v_cvt_pk_bf16_f32 v150, v124, v125
  v_cvt_pk_bf16_f32 v151, v126, v127
  v_mfma_f32_32x32x16_bf16 v[112:127], v[184:187], v[16:19], 0
  v_exp_f32 v128, v128
  v_exp_f32 v129, v129
  v_exp_f32 v130, v130
  v_exp_f32 v131, v131
  v_cvt_pk_bf16_f32 v144, v128, v129
  v_cvt_pk_bf16_f32 v145, v130, v131
  v_mfma_f32_32x32x16_bf16 v[48:63], v[164:167], v[148:151], v[48:63]
  v_exp_f32 v132, v132
  v_exp_f32 v133, v133
  v_exp_f32 v134, v134
  v_exp_f32 v135, v135
  v_cvt_pk_bf16_f32 v146, v132, v133
  v_cvt_pk_bf16_f32 v147, v134, v135
  v_mfma_f32_32x32x16_bf16 v[112:127], v[188:191], v[20:23], v[112:127]
  v_exp_f32 v136, v136
  v_exp_f32 v137, v137
  v_exp_f32 v138, v138
  v_exp_f32 v139, v139
  v_cvt_pk_bf16_f32 v148, v136, v137
  v_cvt_pk_bf16_f32 v149, v138, v139
  v_mfma_f32_32x32x16_bf16 v[48:63], v[176:179], v[144:147], v[48:63]
  s_waitcnt vmcnt(12)
  v_exp_f32 v140, v140
  v_exp_f32 v141, v141
  v_exp_f32 v142, v142
  v_exp_f32 v143, v143
  v_cvt_pk_bf16_f32 v150, v140, v141
  v_cvt_pk_bf16_f32 v151, v142, v143
  v_mfma_f32_32x32x16_bf16 v[128:143], v[200:203], v[16:19], 0
  v_exp_f32 v112, v112
  v_exp_f32 v113, v113
  v_exp_f32 v114, v114
  v_exp_f32 v115, v115
  v_cvt_pk_bf16_f32 v144, v112, v113
  v_cvt_pk_bf16_f32 v145, v114, v115
  v_mfma_f32_32x32x16_bf16 v[48:63], v[180:183], v[148:151], v[48:63]
  v_exp_f32 v116, v116
  v_exp_f32 v117, v117
  v_exp_f32 v118, v118
  v_exp_f32 v119, v119
  v_cvt_pk_bf16_f32 v146, v116, v117
  v_cvt_pk_bf16_f32 v147, v118, v119
  v_mfma_f32_32x32x16_bf16 v[128:143], v[204:207], v[20:23], v[128:143]
  v_exp_f32 v120, v120
  v_exp_f32 v121, v121
  v_exp_f32 v122, v122
  v_exp_f32 v123, v123
  v_cvt_pk_bf16_f32 v148, v120, v121
  v_cvt_pk_bf16_f32 v149, v122, v123
  v_mfma_f32_32x32x16_bf16 v[48:63], v[192:195], v[144:147], v[48:63]
  v_exp_f32 v124, v124
  v_exp_f32 v125, v125
  v_exp_f32 v126, v126
  v_exp_f32 v127, v127
  v_cvt_pk_bf16_f32 v150, v124, v125
  v_cvt_pk_bf16_f32 v151, v126, v127
  v_mfma_f32_32x32x16_bf16 v[112:127], v[152:155], v[24:27], 0
  v_exp_f32 v128, v128
  v_exp_f32 v129, v129
  v_exp_f32 v130, v130
  v_exp_f32 v131, v131
  v_cvt_pk_bf16_f32 v144, v128, v129
  v_cvt_pk_bf16_f32 v145, v130, v131
  v_mfma_f32_32x32x16_bf16 v[48:63], v[196:199], v[148:151], v[48:63]
  v_exp_f32 v132, v132
  v_exp_f32 v133, v133
  v_exp_f32 v134, v134
  v_exp_f32 v135, v135
  v_cvt_pk_bf16_f32 v146, v132, v133
  v_cvt_pk_bf16_f32 v147, v134, v135
  v_mfma_f32_32x32x16_bf16 v[112:127], v[156:159], v[28:31], v[112:127]
  v_exp_f32 v136, v136
  v_exp_f32 v137, v137
  v_exp_f32 v138, v138
  v_exp_f32 v139, v139
  v_cvt_pk_bf16_f32 v148, v136, v137
  v_cvt_pk_bf16_f32 v149, v138, v139
  v_mfma_f32_32x32x16_bf16 v[48:63], v[208:211], v[144:147], v[48:63]
  v_exp_f32 v140, v140
  v_exp_f32 v141, v141
  v_exp_f32 v142, v142
  v_exp_f32 v143, v143
  v_cvt_pk_bf16_f32 v150, v140, v141
  v_cvt_pk_bf16_f32 v151, v142, v143
  v_mfma_f32_32x32x16_bf16 v[128:143], v[168:171], v[24:27], 0
  v_exp_f32 v112, v112
  v_exp_f32 v113, v113
  v_exp_f32 v114, v114
  v_exp_f32 v115, v115
  v_cvt_pk_bf16_f32 v144, v112, v113
  v_cvt_pk_bf16_f32 v145, v114, v115
  v_mfma_f32_32x32x16_bf16 v[48:63], v[212:215], v[148:151], v[48:63]
  v_exp_f32 v116, v116
  v_exp_f32 v117, v117
  v_exp_f32 v118, v118
  v_exp_f32 v119, v119
  v_cvt_pk_bf16_f32 v146, v116, v117
  v_cvt_pk_bf16_f32 v147, v118, v119
  v_mfma_f32_32x32x16_bf16 v[128:143], v[172:175], v[28:31], v[128:143]
  v_exp_f32 v120, v120
  v_exp_f32 v121, v121
  v_exp_f32 v122, v122
  v_exp_f32 v123, v123
  v_cvt_pk_bf16_f32 v148, v120, v121
  v_cvt_pk_bf16_f32 v149, v122, v123
  v_mfma_f32_32x32x16_bf16 v[64:79], v[160:163], v[144:147], v[64:79]
  v_exp_f32 v124, v124
  v_exp_f32 v125, v125
  v_exp_f32 v126, v126
  v_exp_f32 v127, v127
  v_cvt_pk_bf16_f32 v150, v124, v125
  v_cvt_pk_bf16_f32 v151, v126, v127
  v_mfma_f32_32x32x16_bf16 v[112:127], v[184:187], v[24:27], 0
  v_exp_f32 v128, v128
  v_exp_f32 v129, v129
  v_exp_f32 v130, v130
  v_exp_f32 v131, v131
  v_cvt_pk_bf16_f32 v144, v128, v129
  v_cvt_pk_bf16_f32 v145, v130, v131
  v_mfma_f32_32x32x16_bf16 v[64:79], v[164:167], v[148:151], v[64:79]
  v_exp_f32 v132, v132
  v_exp_f32 v133, v133
  v_exp_f32 v134, v134
  v_exp_f32 v135, v135
  v_cvt_pk_bf16_f32 v146, v132, v133
  v_cvt_pk_bf16_f32 v147, v134, v135
  v_mfma_f32_32x32x16_bf16 v[112:127], v[188:191], v[28:31], v[112:127]
  v_exp_f32 v136, v136
  v_exp_f32 v137, v137
  v_exp_f32 v138, v138
  v_exp_f32 v139, v139
  v_cvt_pk_bf16_f32 v148, v136, v137
  v_cvt_pk_bf16_f32 v149, v138, v139
  v_mfma_f32_32x32x16_bf16 v[64:79], v[176:179], v[144:147], v[64:79]
  v_exp_f32 v140, v140
  v_exp_f32 v141, v141
  v_exp_f32 v142, v142
  v_exp_f32 v143, v143
  v_cvt_pk_bf16_f32 v150, v140, v141
  v_cvt_pk_bf16_f32 v151, v142, v143
  v_mfma_f32_32x32x16_bf16 v[128:143], v[200:203], v[24:27], 0
  v_exp_f32 v112, v112
  v_exp_f32 v113, v113
  v_exp_f32 v114, v114
  v_exp_f32 v115, v115
  v_cvt_pk_bf16_f32 v144, v112, v113
  v_cvt_pk_bf16_f32 v145, v114, v115
  v_mfma_f32_32x32x16_bf16 v[64:79], v[180:183], v[148:151], v[64:79]
  v_exp_f32 v116, v116
  v_exp_f32 v117, v117
  v_exp_f32 v118, v118
  v_exp_f32 v119, v119
  v_cvt_pk_bf16_f32 v146, v116, v117
  v_cvt_pk_bf16_f32 v147, v118, v119
  v_mfma_f32_32x32x16_bf16 v[128:143], v[204:207], v[28:31], v[128:143]
  v_exp_f32 v120, v120
  v_exp_f32 v121, v121
  v_exp_f32 v122, v122
  v_exp_f32 v123, v123
  v_cvt_pk_bf16_f32 v148, v120, v121
  v_cvt_pk_bf16_f32 v149, v122, v123
  v_mfma_f32_32x32x16_bf16 v[64:79], v[192:195], v[144:147], v[64:79]
  v_exp_f32 v124, v124
  v_exp_f32 v125, v125
  v_exp_f32 v126, v126
  v_exp_f32 v127, v127
  v_cvt_pk_bf16_f32 v150, v124, v125
  v_cvt_pk_bf16_f32 v151, v126, v127
  v_mfma_f32_32x32x16_bf16 v[112:127], v[152:155], v[32:35], 0
  v_exp_f32 v128, v128
  v_exp_f32 v129, v129
  v_exp_f32 v130, v130
  v_exp_f32 v131, v131
  v_cvt_pk_bf16_f32 v144, v128, v129
  v_cvt_pk_bf16_f32 v145, v130, v131
  v_mfma_f32_32x32x16_bf16 v[64:79], v[196:199], v[148:151], v[64:79]
  v_exp_f32 v132, v132
  v_exp_f32 v133, v133
  v_exp_f32 v134, v134
  v_exp_f32 v135, v135
  v_cvt_pk_bf16_f32 v146, v132, v133
  v_cvt_pk_bf16_f32 v147, v134, v135
  v_mfma_f32_32x32x16_bf16 v[112:127], v[156:159], v[36:39], v[112:127]
  v_exp_f32 v136, v136
  v_exp_f32 v137, v137
  v_exp_f32 v138, v138
  v_exp_f32 v139, v139
  v_cvt_pk_bf16_f32 v148, v136, v137
  v_cvt_pk_bf16_f32 v149, v138, v139
  v_mfma_f32_32x32x16_bf16 v[64:79], v[208:211], v[144:147], v[64:79]
  v_exp_f32 v140, v140
  v_exp_f32 v141, v141
  v_exp_f32 v142, v142
  v_exp_f32 v143, v143
  v_cvt_pk_bf16_f32 v150, v140, v141
  v_cvt_pk_bf16_f32 v151, v142, v143
  v_mfma_f32_32x32x16_bf16 v[128:143], v[168:171], v[32:35], 0
  v_exp_f32 v112, v112
  v_exp_f32 v113, v113
  v_exp_f32 v114, v114
  v_exp_f32 v115, v115
  v_cvt_pk_bf16_f32 v144, v112, v113
  v_cvt_pk_bf16_f32 v145, v114, v115
  v_mfma_f32_32x32x16_bf16 v[64:79], v[212:215], v[148:151], v[64:79]
  v_exp_f32 v116, v116
  v_exp_f32 v117, v117
  v_exp_f32 v118, v118
  v_exp_f32 v119, v119
  v_cvt_pk_bf16_f32 v146, v116, v117
  v_cvt_pk_bf16_f32 v147, v118, v119
  v_mfma_f32_32x32x16_bf16 v[128:143], v[172:175], v[36:39], v[128:143]
  v_exp_f32 v120, v120
  v_exp_f32 v121, v121
  v_exp_f32 v122, v122
  v_exp_f32 v123, v123
  v_cvt_pk_bf16_f32 v148, v120, v121
  v_cvt_pk_bf16_f32 v149, v122, v123
  v_mfma_f32_32x32x16_bf16 v[80:95], v[160:163], v[144:147], v[80:95]
  s_barrier
  v_exp_f32 v124, v124
  v_exp_f32 v125, v125
  v_exp_f32 v126, v126
  v_exp_f32 v127, v127
  v_cvt_pk_bf16_f32 v150, v124, v125
  v_cvt_pk_bf16_f32 v151, v126, v127
  v_mfma_f32_32x32x16_bf16 v[112:127], v[184:187], v[32:35], 0
  v_exp_f32 v128, v128
  v_exp_f32 v129, v129
  v_exp_f32 v130, v130
  v_exp_f32 v131, v131
  v_cvt_pk_bf16_f32 v144, v128, v129
  v_cvt_pk_bf16_f32 v145, v130, v131
  v_mfma_f32_32x32x16_bf16 v[80:95], v[164:167], v[148:151], v[80:95]
  ds_write_b128 v236, v[48:51] offset:0
  v_exp_f32 v132, v132
  v_exp_f32 v133, v133
  v_exp_f32 v134, v134
  v_exp_f32 v135, v135
  v_cvt_pk_bf16_f32 v146, v132, v133
  v_cvt_pk_bf16_f32 v147, v134, v135
  v_mfma_f32_32x32x16_bf16 v[112:127], v[188:191], v[36:39], v[112:127]
  v_exp_f32 v136, v136
  v_exp_f32 v137, v137
  v_exp_f32 v138, v138
  v_exp_f32 v139, v139
  v_cvt_pk_bf16_f32 v148, v136, v137
  v_cvt_pk_bf16_f32 v149, v138, v139
  v_mfma_f32_32x32x16_bf16 v[80:95], v[176:179], v[144:147], v[80:95]
  ds_write_b128 v236, v[52:55] offset:1024
  v_exp_f32 v140, v140
  v_exp_f32 v141, v141
  v_exp_f32 v142, v142
  v_exp_f32 v143, v143
  v_cvt_pk_bf16_f32 v150, v140, v141
  v_cvt_pk_bf16_f32 v151, v142, v143
  v_mfma_f32_32x32x16_bf16 v[128:143], v[200:203], v[32:35], 0
  v_exp_f32 v112, v112
  v_exp_f32 v113, v113
  v_exp_f32 v114, v114
  v_exp_f32 v115, v115
  v_cvt_pk_bf16_f32 v144, v112, v113
  v_cvt_pk_bf16_f32 v145, v114, v115
  v_mfma_f32_32x32x16_bf16 v[80:95], v[180:183], v[148:151], v[80:95]
  ds_write_b128 v236, v[56:59] offset:2048
  v_exp_f32 v116, v116
  v_exp_f32 v117, v117
  v_exp_f32 v118, v118
  v_exp_f32 v119, v119
  v_cvt_pk_bf16_f32 v146, v116, v117
  v_cvt_pk_bf16_f32 v147, v118, v119
  v_mfma_f32_32x32x16_bf16 v[128:143], v[204:207], v[36:39], v[128:143]
  v_exp_f32 v120, v120
  v_exp_f32 v121, v121
  v_exp_f32 v122, v122
  v_exp_f32 v123, v123
  v_cvt_pk_bf16_f32 v148, v120, v121
  v_cvt_pk_bf16_f32 v149, v122, v123
  v_mfma_f32_32x32x16_bf16 v[80:95], v[192:195], v[144:147], v[80:95]
  ds_write_b128 v236, v[60:63] offset:3072
  v_exp_f32 v124, v124
  v_exp_f32 v125, v125
  v_exp_f32 v126, v126
  v_exp_f32 v127, v127
  v_cvt_pk_bf16_f32 v150, v124, v125
  v_cvt_pk_bf16_f32 v151, v126, v127
  v_mfma_f32_32x32x16_bf16 v[112:127], v[152:155], v[40:43], 0
  v_exp_f32 v128, v128
  v_exp_f32 v129, v129
  v_exp_f32 v130, v130
  v_exp_f32 v131, v131
  v_cvt_pk_bf16_f32 v144, v128, v129
  v_cvt_pk_bf16_f32 v145, v130, v131
  v_mfma_f32_32x32x16_bf16 v[80:95], v[196:199], v[148:151], v[80:95]
  ds_write_b128 v237, v[64:67] offset:4096
  v_exp_f32 v132, v132
  v_exp_f32 v133, v133
  v_exp_f32 v134, v134
  v_exp_f32 v135, v135
  v_cvt_pk_bf16_f32 v146, v132, v133
  v_cvt_pk_bf16_f32 v147, v134, v135
  v_mfma_f32_32x32x16_bf16 v[112:127], v[156:159], v[44:47], v[112:127]
  v_exp_f32 v136, v136
  v_exp_f32 v137, v137
  v_exp_f32 v138, v138
  v_exp_f32 v139, v139
  v_cvt_pk_bf16_f32 v148, v136, v137
  v_cvt_pk_bf16_f32 v149, v138, v139
  v_mfma_f32_32x32x16_bf16 v[80:95], v[208:211], v[144:147], v[80:95]
  ds_write_b128 v237, v[68:71] offset:5120
  v_exp_f32 v140, v140
  v_exp_f32 v141, v141
  v_exp_f32 v142, v142
  v_exp_f32 v143, v143
  v_cvt_pk_bf16_f32 v150, v140, v141
  v_cvt_pk_bf16_f32 v151, v142, v143
  v_mfma_f32_32x32x16_bf16 v[128:143], v[168:171], v[40:43], 0
  v_exp_f32 v112, v112
  v_exp_f32 v113, v113
  v_exp_f32 v114, v114
  v_exp_f32 v115, v115
  v_cvt_pk_bf16_f32 v144, v112, v113
  v_cvt_pk_bf16_f32 v145, v114, v115
  v_mfma_f32_32x32x16_bf16 v[80:95], v[212:215], v[148:151], v[80:95]
  ds_write_b128 v237, v[72:75] offset:6144
  v_exp_f32 v116, v116
  v_exp_f32 v117, v117
  v_exp_f32 v118, v118
  v_exp_f32 v119, v119
  v_cvt_pk_bf16_f32 v146, v116, v117
  v_cvt_pk_bf16_f32 v147, v118, v119
  v_mfma_f32_32x32x16_bf16 v[128:143], v[172:175], v[44:47], v[128:143]
  v_exp_f32 v120, v120
  v_exp_f32 v121, v121
  v_exp_f32 v122, v122
  v_exp_f32 v123, v123
  v_cvt_pk_bf16_f32 v148, v120, v121
  v_cvt_pk_bf16_f32 v149, v122, v123
  v_mfma_f32_32x32x16_bf16 v[96:111], v[160:163], v[144:147], v[96:111]
  ds_write_b128 v237, v[76:79] offset:7168
  v_exp_f32 v124, v124
  v_exp_f32 v125, v125
  v_exp_f32 v126, v126
  v_exp_f32 v127, v127
  v_cvt_pk_bf16_f32 v150, v124, v125
  v_cvt_pk_bf16_f32 v151, v126, v127
  v_mfma_f32_32x32x16_bf16 v[112:127], v[184:187], v[40:43], 0
  s_waitcnt vmcnt(2)
  v_min3_u32 v2, v232, v233, v234
  v_min_u32 v2, v2, v235
  v_cmp_ne_u32 vcc, -1, v2
  v_exp_f32 v128, v128
  v_exp_f32 v129, v129
  v_exp_f32 v130, v130
  v_exp_f32 v131, v131
  v_cvt_pk_bf16_f32 v144, v128, v129
  v_cvt_pk_bf16_f32 v145, v130, v131
  v_mfma_f32_32x32x16_bf16 v[96:111], v[164:167], v[148:151], v[96:111]
  s_cbranch_vccnz L_cnr_12
L_cn_11:
  ds_write_b128 v238, v[80:83] offset:8192
  v_exp_f32 v132, v132
  v_exp_f32 v133, v133
  v_exp_f32 v134, v134
  v_exp_f32 v135, v135
  v_cvt_pk_bf16_f32 v146, v132, v133
  v_cvt_pk_bf16_f32 v147, v134, v135
  v_mfma_f32_32x32x16_bf16 v[112:127], v[188:191], v[44:47], v[112:127]
  s_waitcnt lgkmcnt(1)
  s_barrier
  v_exp_f32 v136, v136
  v_exp_f32 v137, v137
  v_exp_f32 v138, v138
  v_exp_f32 v139, v139
  v_cvt_pk_bf16_f32 v148, v136, v137
  v_cvt_pk_bf16_f32 v149, v138, v139
  v_mfma_f32_32x32x16_bf16 v[96:111], v[176:179], v[144:147], v[96:111]
  ds_write_b128 v238, v[84:87] offset:9216
  v_exp_f32 v140, v140
  v_exp_f32 v141, v141
  v_exp_f32 v142, v142
  v_exp_f32 v143, v143
  v_cvt_pk_bf16_f32 v150, v140, v141
  v_cvt_pk_bf16_f32 v151, v142, v143
  v_mfma_f32_32x32x16_bf16 v[128:143], v[200:203], v[40:43], 0
  ds_write_b128 v238, v[88:91] offset:10240
  v_exp_f32 v112, v112
  v_exp_f32 v113, v113
  v_exp_f32 v114, v114
  v_exp_f32 v115, v115
  v_cvt_pk_bf16_f32 v144, v112, v113
  v_cvt_pk_bf16_f32 v145, v114, v115
  v_mfma_f32_32x32x16_bf16 v[96:111], v[180:183], v[148:151], v[96:111]
  ds_read_b128 v[48:51], v239 offset:12288
  ds_read_b128 v[52:55], v239 offset:13312
  ds_read_b128 v[56:59], v239 offset:14336
  ds_read_b128 v[60:63], v239 offset:15360
  v_exp_f32 v116, v116
  v_exp_f32 v117, v117
  v_exp_f32 v118, v118
  v_exp_f32 v119, v119
  v_cvt_pk_bf16_f32 v146, v116, v117
  v_cvt_pk_bf16_f32 v147, v118, v119
  v_mfma_f32_32x32x16_bf16 v[128:143], v[204:207], v[44:47], v[128:143]
  ds_write_b128 v238, v[92:95] offset:11264
  v_exp_f32 v120, v120
  v_exp_f32 v121, v121
  v_exp_f32 v122, v122
  v_exp_f32 v123, v123
  v_cvt_pk_bf16_f32 v148, v120, v121
  v_cvt_pk_bf16_f32 v149, v122, v123
  v_mfma_f32_32x32x16_bf16 v[96:111], v[192:195], v[144:147], v[96:111]
  ds_read_b128 v[64:67], v239 offset:16384
  ds_read_b128 v[68:71], v239 offset:17408
  ds_read_b128 v[72:75], v239 offset:18432
  ds_read_b128 v[76:79], v239 offset:19456
  s_mov_b64 exec, 1
  buffer_store_dword v1, off, s[20:23], s2 sc1
  s_mov_b64 exec, -1
  v_exp_f32 v124, v124
  v_exp_f32 v125, v125
  v_exp_f32 v126, v126
  v_exp_f32 v127, v127
  v_cvt_pk_bf16_f32 v150, v124, v125
  v_cvt_pk_bf16_f32 v151, v126, v127
  v_exp_f32 v128, v128
  v_exp_f32 v129, v129
  v_exp_f32 v130, v130
  v_exp_f32 v131, v131
  v_cvt_pk_bf16_f32 v144, v128, v129
  v_cvt_pk_bf16_f32 v145, v130, v131
  v_mfma_f32_32x32x16_bf16 v[96:111], v[196:199], v[148:151], v[96:111]
  s_waitcnt lgkmcnt(0)
  s_barrier
  ds_read_b128 v[80:83], v239 offset:20480
  ds_read_b128 v[84:87], v239 offset:21504
  ds_read_b128 v[88:91], v239 offset:22528
  ds_read_b128 v[92:95], v239 offset:23552
  v_exp_f32 v132, v132
  v_exp_f32 v133, v133
  v_exp_f32 v134, v134
  v_exp_f32 v135, v135
  v_cvt_pk_bf16_f32 v146, v132, v133
  v_cvt_pk_bf16_f32 v147, v134, v135
  v_exp_f32 v136, v136
  v_exp_f32 v137, v137
  v_exp_f32 v138, v138
  v_exp_f32 v139, v139
  v_cvt_pk_bf16_f32 v148, v136, v137
  v_cvt_pk_bf16_f32 v149, v138, v139
  v_mfma_f32_32x32x16_bf16 v[96:111], v[208:211], v[144:147], v[96:111]
  v_exp_f32 v140, v140
  v_exp_f32 v141, v141
  v_exp_f32 v142, v142
  v_exp_f32 v143, v143
  v_cvt_pk_bf16_f32 v150, v140, v141
  v_cvt_pk_bf16_f32 v151, v142, v143
  s_mov_b32 s30, 0
  s_branch L_att_end
L_nopad:
L_gw:
  s_sub_u32 s96, s96, 1
  s_cbranch_scc1 L_end
  buffer_load_dword v200, v201, s[48:51], 0 offen sc1
  s_waitcnt vmcnt(0)
  v_cmp_ne_u32 vcc, 1, v200
  s_nop 4
  s_cbranch_vccnz L_gw
  s_branch L_go
L_flw:
  buffer_load_dword v206, v207, s[12:15], 0 offen sc1
  s_mov_b64 exec, 1
  buffer_store_dword v200, off, s[20:23], s73 offset:48 sc1
  s_mov_b64 exec, -1
  s_waitcnt vmcnt(1)
L_fl:
  v_cmp_ne_u32 vcc, 1, v206
  s_nop 4
  s_cbranch_vccz L_fl2
  s_sub_u32 s96, s96, 1
  s_cbranch_scc1 L_end
  buffer_load_dword v206, v207, s[12:15], 0 offen sc1
  s_waitcnt vmcnt(0)
  s_branch L_fl
L_fl2:
  s_branch L_flo
L_refkv:
  s_sub_u32 s96, s96, 1
  s_cbranch_scc1 L_end
  s_lshl2_add_u32 s3, s6, s4
  s_lshl_b32 s3, s3, 16
  buffer_load_dwordx4 a[128:131], v7, s[12:15], s3 offen offset:0 sc1
  buffer_load_dwordx4 a[132:135], v7, s[12:15], s3 offen offset:1024 sc1
  buffer_load_dwordx4 a[136:139], v7, s[12:15], s3 offen offset:2048 sc1
  buffer_load_dwordx4 a[140:143], v7, s[12:15], s3 offen offset:3072 sc1
  s_add_u32 s3, s3, 4096
  buffer_load_dwordx4 a[144:147], v7, s[12:15], s3 offen offset:0 sc1
  buffer_load_dwordx4 a[148:151], v7, s[12:15], s3 offen offset:1024 sc1
  buffer_load_dwordx4 a[152:155], v7, s[12:15], s3 offen offset:2048 sc1
  buffer_load_dwordx4 a[156:159], v7, s[12:15], s3 offen offset:3072 sc1
  s_add_u32 s3, s3, 4096
  buffer_load_dwordx4 a[160:163], v7, s[12:15], s3 offen offset:0 sc1
  buffer_load_dwordx4 a[164:167], v7, s[12:15], s3 offen offset:1024 sc1
  buffer_load_dwordx4 a[168:171], v7, s[12:15], s3 offen offset:2048 sc1
  buffer_load_dwordx4 a[172:175], v7, s[12:15], s3 offen offset:3072 sc1
  s_add_u32 s3, s3, 4096
  buffer_load_dwordx4 a[176:179], v7, s[12:15], s3 offen offset:0 sc1
  buffer_load_dwordx4 a[180:183], v7, s[12:15], s3 offen offset:1024 sc1
  buffer_load_dwordx4 a[184:187], v7, s[12:15], s3 offen offset:2048 sc1
  buffer_load_dwordx4 a[188:191], v7, s[12:15], s3 offen offset:3072 sc1
  s_add_u32 s3, s3, 4096
  s_waitcnt vmcnt(0)
  s_setpc_b64 s[76:77]
L_krt_2:
  s_call_b64 s[76:77], L_refkv
  v_accvgpr_read_b32 v2, a128
  v_accvgpr_read_b32 v3, a132
  v_accvgpr_read_b32 v4, a136
  v_accvgpr_read_b32 v10, a140
  v_max3_u32 v2, v2, v3, v4
  v_max_u32 v2, v2, v10
  v_cmp_eq_u32 vcc, -1, v2
  s_nop 4
  s_cbranch_vccnz L_krt_2
  s_branch L_kck_1
L_krt_4:
  s_call_b64 s[76:77], L_refkv
  v_accvgpr_read_b32 v2, a144
  v_accvgpr_read_b32 v3, a148
  v_accvgpr_read_b32 v4, a152
  v_accvgpr_read_b32 v10, a156
  v_max3_u32 v2, v2, v3, v4
  v_max_u32 v2, v2, v10
  v_cmp_eq_u32 vcc, -1, v2
  s_nop 4
  s_cbranch_vccnz L_krt_4
  s_branch L_kck_3
L_krt_6:
  s_call_b64 s[76:77], L_refkv
  v_accvgpr_read_b32 v2, a160
  v_accvgpr_read_b32 v3, a164
  v_accvgpr_read_b32 v4, a168
  v_accvgpr_read_b32 v10, a172
  v_max3_u32 v2, v2, v3, v4
  v_max_u32 v2, v2, v10
  v_cmp_eq_u32 vcc, -1, v2
  s_nop 4
  s_cbranch_vccnz L_krt_6
  s_branch L_kck_5
L_f2r_8:
  s_sub_u32 s96, s96, 1
  s_cbranch_scc1 L_end
  buffer_load_dword v11, v253, s[12:15], 0 offen offset:48 sc1
  s_waitcnt vmcnt(0)
  v_cmp_ne_u32 vcc, 1, v11
  s_nop 4
  s_cbranch_vccnz L_f2r_8
  s_branch L_f2_7
L_krt_10:
  s_call_b64 s[76:77], L_refkv
  v_accvgpr_read_b32 v2, a176
  v_accvgpr_read_b32 v3, a180
  v_accvgpr_read_b32 v4, a184
  v_accvgpr_read_b32 v10, a188
  v_max3_u32 v2, v2, v3, v4
  v_max_u32 v2, v2, v10
  v_cmp_eq_u32 vcc, -1, v2
  s_nop 4
  s_cbranch_vccnz L_krt_10
  s_branch L_kck_9
L_cnr_12:
  s_sub_u32 s96, s96, 1
  s_cbranch_scc1 L_end
  buffer_load_dwordx4 v[232:235], v229, s[12:15], s69 offen sc1
  s_waitcnt vmcnt(0)
  v_min3_u32 v2, v232, v233, v234
  v_min_u32 v2, v2, v235
  v_cmp_ne_u32 vcc, -1, v2
  s_nop 4
  s_cbranch_vccnz L_cnr_12
  s_branch L_cn_11
L_krt_14:
  s_call_b64 s[76:77], L_refkv
  v_accvgpr_read_b32 v2, a144
  v_accvgpr_read_b32 v3, a148
  v_accvgpr_read_b32 v4, a152
  v_accvgpr_read_b32 v10, a156
  v_max3_u32 v2, v2, v3, v4
  v_max_u32 v2, v2, v10
  v_cmp_eq_u32 vcc, -1, v2
  s_nop 4
  s_cbranch_vccnz L_krt_14
  s_branch L_kck_13
L_krt_16:
  s_call_b64 s[76:77], L_refkv
  v_accvgpr_read_b32 v2, a160
  v_accvgpr_read_b32 v3, a164
  v_accvgpr_read_b32 v4, a168
  v_accvgpr_read_b32 v10, a172
  v_max3_u32 v2, v2, v3, v4
  v_max_u32 v2, v2, v10
  v_cmp_eq_u32 vcc, -1, v2
  s_nop 4
  s_cbranch_vccnz L_krt_16
  s_branch L_kck_15
L_f2r_18:
  s_sub_u32 s96, s96, 1
  s_cbranch_scc1 L_end
  buffer_load_dword v11, v253, s[12:15], 0 offen offset:48 sc1
  s_waitcnt vmcnt(0)
  v_cmp_ne_u32 vcc, 1, v11
  s_nop 4
  s_cbranch_vccnz L_f2r_18
  s_branch L_f2_17
L_krt_20:
  s_call_b64 s[76:77], L_refkv
  v_accvgpr_read_b32 v2, a176
  v_accvgpr_read_b32 v3, a180
  v_accvgpr_read_b32 v4, a184
  v_accvgpr_read_b32 v10, a188
  v_max3_u32 v2, v2, v3, v4
  v_max_u32 v2, v2, v10
  v_cmp_eq_u32 vcc, -1, v2
  s_nop 4
  s_cbranch_vccnz L_krt_20
  s_branch L_kck_19
L_cnr_22:
  s_sub_u32 s96, s96, 1
  s_cbranch_scc1 L_end
  buffer_load_dwordx4 v[232:235], v229, s[12:15], s69 offen sc1
  s_waitcnt vmcnt(0)
  v_min3_u32 v2, v232, v233, v234
  v_min_u32 v2, v2, v235
  v_cmp_ne_u32 vcc, -1, v2
  s_nop 4
  s_cbranch_vccnz L_cnr_22
  s_branch L_cn_21
L_safe:
  s_lshl_b32 s54, s6, 18
  s_add_u32 s3, s54, 262144
  v_mov_b32 v2, 0xff800000
L_safe_max:
  buffer_load_dwordx4 v[152:155], v7, s[12:15], s54 offen offset:0 sc1
  buffer_load_dwordx4 v[156:159], v7, s[12:15], s54 offen offset:1024 sc1
  s_add_u32 s54, s54, 4096
  s_waitcnt vmcnt(0)
  v_mfma_f32_32x32x16_bf16 v[112:127], v[152:155], v[40:43], 0
  v_mfma_f32_32x32x16_bf16 v[112:127], v[156:159], v[44:47], v[112:127]
  s_nop 11
  v_max3_f32 v2, v2, v112, v113
  v_max3_f32 v2, v2, v114, v115
  v_max3_f32 v2, v2, v116, v117
  v_max3_f32 v2, v2, v118, v119
  v_max3_f32 v2, v2, v120, v121
  v_max3_f32 v2, v2, v122, v123
  v_max3_f32 v2, v2, v124, v125
  v_max3_f32 v2, v2, v126, v127
  s_cmp_lt_u32 s54, s3
  s_cbranch_scc1 L_safe_max
  v_mov_b32 v4, v2
  s_nop 1
  v_permlane32_swap_b32 v2, v4
  v_max_f32 v2, v2, v4
  v_sub_f32 v2, 0, v2
  v_and_b32 v4, 0xffff0000, v2
  v_sub_f32 v4, v2, v4
  v_and_b32 v5, 0xffff0000, v4
  v_sub_f32 v5, v4, v5
  s_mov_b32 s54, 0x07060302
  v_perm_b32 v2, v4, v2, s54
  v_lshrrev_b32 v5, 16, v5
  v_cndmask_b32 v46, v46, v2, s[74:75]
  v_cndmask_b32 v47, v47, v5, s[74:75]
  v_mov_b32 v96, 0
  v_mov_b32 v97, 0
  v_mov_b32 v98, 0
  v_mov_b32 v99, 0
  v_mov_b32 v100, 0
  v_mov_b32 v101, 0
  v_mov_b32 v102, 0
  v_mov_b32 v103, 0
  v_mov_b32 v104, 0
  v_mov_b32 v105, 0
  v_mov_b32 v106, 0
  v_mov_b32 v107, 0
  v_mov_b32 v108, 0
  v_mov_b32 v109, 0
  v_mov_b32 v110, 0
  v_mov_b32 v111, 0
  s_lshl_b32 s54, s6, 18
L_safe_pv:
  buffer_load_dwordx4 v[152:155], v7, s[12:15], s54 offen offset:0 sc1
  buffer_load_dwordx4 v[156:159], v7, s[12:15], s54 offen offset:1024 sc1
  buffer_load_dwordx4 v[160:163], v7, s[12:15], s54 offen offset:2048 sc1
  buffer_load_dwordx4 v[164:167], v7, s[12:15], s54 offen offset:3072 sc1
  s_add_u32 s54, s54, 4096
  s_waitcnt vmcnt(0)
  v_mfma_f32_32x32x16_bf16 v[112:127], v[152:155], v[40:43], 0
  v_mfma_f32_32x32x16_bf16 v[112:127], v[156:159], v[44:47], v[112:127]
  s_nop 11
  v_exp_f32 v112, v112
  v_exp_f32 v113, v113
  v_exp_f32 v114, v114
  v_exp_f32 v115, v115
  v_exp_f32 v116, v116
  v_exp_f32 v117, v117
  v_exp_f32 v118, v118
  v_exp_f32 v119, v119
  v_exp_f32 v120, v120
  v_exp_f32 v121, v121
  v_exp_f32 v122, v122
  v_exp_f32 v123, v123
  v_exp_f32 v124, v124
  v_exp_f32 v125, v125
  v_exp_f32 v126, v126
  v_exp_f32 v127, v127
  v_cvt_pk_bf16_f32 v144, v112, v113
  v_cvt_pk_bf16_f32 v145, v114, v115
  v_cvt_pk_bf16_f32 v146, v116, v117
  v_cvt_pk_bf16_f32 v147, v118, v119
  v_cvt_pk_bf16_f32 v148, v120, v121
  v_cvt_pk_bf16_f32 v149, v122, v123
  v_cvt_pk_bf16_f32 v150, v124, v125
  v_cvt_pk_bf16_f32 v151, v126, v127
  v_mfma_f32_32x32x16_bf16 v[96:111], v[160:163], v[144:147], v[96:111]
  s_nop 0
  v_mfma_f32_32x32x16_bf16 v[96:111], v[164:167], v[148:151], v[96:111]
  s_nop 7
  s_cmp_lt_u32 s54, s3
  s_cbranch_scc1 L_safe_pv
  s_nop 1
  v_mov_b32 v2, v108
  v_mov_b32 v4, v108
  s_nop 1
  v_permlane32_swap_b32 v2, v4
  s_branch L_safe_done
L_tail:
  s_mul_i32 s3, s4, 448
  s_and_b32 s56, s8, 3
  s_mul_i32 s56, s56, 28
  s_add_u32 s3, s3, s56
  s_lshl_b32 s3, s3, 12
  s_lshr_b32 s56, s8, 2
  s_lshl_b32 s56, s56, 9
  s_add_u32 s3, s3, s56
  s_waitcnt vmcnt(0)
  s_add_u32 s56, s3, 917504
  buffer_load_dword v5, v223, s[32:35], s56 offen
  s_add_u32 s56, s3, 966656
  buffer_load_dword v5, v223, s[32:35], s56 offen
  s_add_u32 s56, s3, 1376256
  buffer_load_dword v5, v223, s[32:35], s56 offen
  s_add_u32 s56, s3, 1425408
  buffer_load_dword v5, v223, s[32:35], s56 offen
  s_waitcnt vmcnt(0)
  s_branch L_fin
L_refo:
  s_sub_u32 s96, s96, 1
  s_cbranch_scc1 L_end
  s_waitcnt vmcnt(0)
  s_mov_b32 s3, s63
  s_mov_b64 exec, -1
  v_cmpx_eq_u32 vcc, -1, v112
  buffer_load_dwordx4 v[112:115], v7, s[12:15], s3 offen offset:0 sc1
  s_mov_b64 exec, -1
  v_cmpx_eq_u32 vcc, -1, v116
  buffer_load_dwordx4 v[116:119], v7, s[12:15], s3 offen offset:1024 sc1
  s_mov_b64 exec, -1
  v_cmpx_eq_u32 vcc, -1, v120
  buffer_load_dwordx4 v[120:123], v7, s[12:15], s3 offen offset:2048 sc1
  s_mov_b64 exec, -1
  v_cmpx_eq_u32 vcc, -1, v124
  buffer_load_dwordx4 v[124:127], v7, s[12:15], s3 offen offset:3072 sc1
  s_add_u32 s3, s3, 4096
  s_mov_b64 exec, -1
  v_cmpx_eq_u32 vcc, -1, v128
  buffer_load_dwordx4 v[128:131], v7, s[12:15], s3 offen offset:0 sc1
  s_mov_b64 exec, -1
  v_cmpx_eq_u32 vcc, -1, v132
  buffer_load_dwordx4 v[132:135], v7, s[12:15], s3 offen offset:1024 sc1
  s_mov_b64 exec, -1
  v_cmpx_eq_u32 vcc, -1, v136
  buffer_load_dwordx4 v[136:139], v7, s[12:15], s3 offen offset:2048 sc1
  s_mov_b64 exec, -1
  v_cmpx_eq_u32 vcc, -1, v140
  buffer_load_dwordx4 v[140:143], v7, s[12:15], s3 offen offset:3072 sc1
  s_add_u32 s3, s3, 4096
  s_mov_b64 exec, -1
  v_cmpx_eq_u32 vcc, -1, v144
  buffer_load_dwordx4 v[144:147], v7, s[12:15], s3 offen offset:0 sc1
  s_mov_b64 exec, -1
  v_cmpx_eq_u32 vcc, -1, v148
  buffer_load_dwordx4 v[148:151], v7, s[12:15], s3 offen offset:1024 sc1
  s_mov_b64 exec, -1
  v_cmpx_eq_u32 vcc, -1, v152
  buffer_load_dwordx4 v[152:155], v7, s[12:15], s3 offen offset:2048 sc1
  s_mov_b64 exec, -1
  v_cmpx_eq_u32 vcc, -1, v156
  buffer_load_dwordx4 v[156:159], v7, s[12:15], s3 offen offset:3072 sc1
  s_add_u32 s3, s3, 4096
  s_mov_b64 exec, -1
  v_cmpx_eq_u32 vcc, -1, v160
  buffer_load_dwordx4 v[160:163], v7, s[12:15], s3 offen offset:0 sc1
  s_mov_b64 exec, -1
  v_cmpx_eq_u32 vcc, -1, v164
  buffer_load_dwordx4 v[164:167], v7, s[12:15], s3 offen offset:1024 sc1
  s_mov_b64 exec, -1
  v_cmpx_eq_u32 vcc, -1, v168
  buffer_load_dwordx4 v[168:171], v7, s[12:15], s3 offen offset:2048 sc1
  s_mov_b64 exec, -1
  v_cmpx_eq_u32 vcc, -1, v172
  buffer_load_dwordx4 v[172:175], v7, s[12:15], s3 offen offset:3072 sc1
  s_mov_b64 exec, -1
  s_waitcnt vmcnt(0)
  s_setpc_b64 s[76:77]
L_ort_26:
  s_call_b64 s[76:77], L_refo
  v_max3_u32 v2, v112, v116, v120
  v_max_u32 v2, v2, v124
  v_cmp_eq_u32 vcc, -1, v2
  s_nop 4
  s_cbranch_vccnz L_ort_26
  s_branch L_ock_25
L_ort_28:
  s_call_b64 s[76:77], L_refo
  v_max3_u32 v2, v128, v132, v136
  v_max_u32 v2, v2, v140
  v_cmp_eq_u32 vcc, -1, v2
  s_nop 4
  s_cbranch_vccnz L_ort_28
  s_branch L_ock_27
L_ort_30:
  s_call_b64 s[76:77], L_refo
  v_max3_u32 v2, v144, v148, v152
  v_max_u32 v2, v2, v156
  v_cmp_eq_u32 vcc, -1, v2
  s_nop 4
  s_cbranch_vccnz L_ort_30
  s_branch L_ock_29
L_ort_32:
  s_call_b64 s[76:77], L_refo
  v_max3_u32 v2, v160, v164, v168
  v_max_u32 v2, v2, v172
  v_cmp_eq_u32 vcc, -1, v2
  s_nop 4
  s_cbranch_vccnz L_ort_32
  s_branch L_ock_31
L_s_35:
  s_sub_u32 s96, s96, 1
  s_cbranch_scc1 L_end
  s_mov_b64 exec, -1
  v_cmpx_eq_u32 vcc, -1, v113
  buffer_load_dwordx2 v[112:113], v245, s[12:15], s62 offen offset:0 sc1
  s_mov_b64 exec, -1
  v_cmpx_eq_u32 vcc, -1, v115
  buffer_load_dwordx2 v[114:115], v245, s[12:15], s62 offen offset:512 sc1
  s_mov_b64 exec, -1
  v_cmpx_eq_u32 vcc, -1, v117
  buffer_load_dwordx2 v[116:117], v245, s[12:15], s62 offen offset:1024 sc1
  s_mov_b64 exec, -1
  v_cmpx_eq_u32 vcc, -1, v119
  buffer_load_dwordx2 v[118:119], v245, s[12:15], s62 offen offset:1536 sc1
  s_mov_b64 exec, -1
  v_cmpx_eq_u32 vcc, -1, v121
  buffer_load_dwordx2 v[120:121], v245, s[12:15], s62 offen offset:2048 sc1
  s_mov_b64 exec, -1
  v_cmpx_eq_u32 vcc, -1, v123
  buffer_load_dwordx2 v[122:123], v245, s[12:15], s62 offen offset:2560 sc1
  s_mov_b64 exec, -1
  v_cmpx_eq_u32 vcc, -1, v125
  buffer_load_dwordx2 v[124:125], v245, s[12:15], s62 offen offset:3072 sc1
  s_mov_b64 exec, -1
  s_waitcnt vmcnt(0)
  v_max3_u32 v2, v113, v115, v117
  v_max3_u32 v2, v2, v119, v121
  v_max3_u32 v2, v2, v123, v125
  v_cmp_eq_u32 vcc, -1, v2
  s_nop 4
  s_cbranch_vccnz L_s_35
  s_branch L_so_36
L_refresh:
  s_sub_u32 s96, s96, 1
  s_cbranch_scc1 L_end
  s_waitcnt vmcnt(0)
  v_cmpx_eq_u32 vcc, -1, v112
  buffer_load_dwordx4 v[112:115], v7, s[12:15], s71 offen offset:0 sc1
  s_mov_b64 exec, -1
  v_cmpx_eq_u32 vcc, -1, v116
  buffer_load_dwordx4 v[116:119], v7, s[12:15], s71 offen offset:1024 sc1
  s_mov_b64 exec, -1
  v_cmpx_eq_u32 vcc, -1, v120
  buffer_load_dwordx4 v[120:123], v7, s[12:15], s71 offen offset:2048 sc1
  s_mov_b64 exec, -1
  v_cmpx_eq_u32 vcc, -1, v124
  buffer_load_dwordx4 v[124:127], v7, s[12:15], s71 offen offset:3072 sc1
  s_mov_b64 exec, -1
  v_cmpx_eq_u32 vcc, -1, v128
  buffer_load_dwordx4 v[128:131], v7, s[12:15], s72 offen offset:0 sc1
  s_mov_b64 exec, -1
  v_cmpx_eq_u32 vcc, -1, v132
  buffer_load_dwordx4 v[132:135], v7, s[12:15], s72 offen offset:1024 sc1
  s_mov_b64 exec, -1
  v_cmpx_eq_u32 vcc, -1, v136
  buffer_load_dwordx4 v[136:139], v7, s[12:15], s72 offen offset:2048 sc1
  s_mov_b64 exec, -1
  v_cmpx_eq_u32 vcc, -1, v140
  buffer_load_dwordx4 v[140:143], v7, s[12:15], s72 offen offset:3072 sc1
  s_mov_b64 exec, -1
  v_cmpx_eq_u32 vcc, -1, v144
  buffer_load_dwordx4 v[144:147], v7, s[12:15], s73 offen offset:0 sc1
  s_mov_b64 exec, -1
  v_cmpx_eq_u32 vcc, -1, v148
  buffer_load_dwordx4 v[148:151], v7, s[12:15], s73 offen offset:1024 sc1
  s_mov_b64 exec, -1
  v_cmpx_eq_u32 vcc, -1, v152
  buffer_load_dwordx4 v[152:155], v7, s[12:15], s73 offen offset:2048 sc1
  s_mov_b64 exec, -1
  v_cmpx_eq_u32 vcc, -1, v156
  buffer_load_dwordx4 v[156:159], v7, s[12:15], s73 offen offset:3072 sc1
  s_mov_b64 exec, -1
  s_waitcnt vmcnt(0)
  s_setpc_b64 s[76:77]
L_no4:
  s_add_u32 m0, s0, 16384
  s_add_u32 s59, s54, 1441792
  buffer_load_dwordx4 v8, s[32:35], s59 offen lds
  buffer_load_dwordx4 v9, s[32:35], s59 offen offset:1024 lds
  buffer_load_dwordx4 v10, s[32:35], s59 offen offset:2048 lds
  buffer_load_dwordx4 v11, s[32:35], s59 offen offset:3072 lds
  s_add_u32 m0, s61, 0
  s_add_u32 s59, s54, 1572864
  buffer_load_dwordx4 v8, s[32:35], s59 offen lds
  buffer_load_dwordx4 v9, s[32:35], s59 offen offset:1024 lds
  buffer_load_dwordx4 v10, s[32:35], s59 offen offset:2048 lds
  buffer_load_dwordx4 v11, s[32:35], s59 offen offset:3072 lds
  s_add_u32 m0, s0, 20480
  s_add_u32 s59, s54, 1703936
  buffer_load_dwordx4 v8, s[32:35], s59 offen lds
  buffer_load_dwordx4 v9, s[32:35], s59 offen offset:1024 lds
  buffer_load_dwordx4 v10, s[32:35], s59 offen offset:2048 lds
  buffer_load_dwordx4 v11, s[32:35], s59 offen offset:3072 lds
  s_lshl2_add_u32 s3, s7, s4
  s_lshl_b32 s3, s3, 10
  s_add_u32 s60, s3, 9142272
  s_add_u32 s3, s60, 65536
L_no4w:
  s_sub_u32 s96, s96, 1
  s_cbranch_scc1 L_end
  buffer_load_dword v3, v244, s[12:15], s3 offen sc1
  s_waitcnt vmcnt(0)
  v_cmp_eq_u32 vcc, -1, v3
  s_nop 4
  s_cbranch_vccnz L_no4w
  s_branch L_wait4
L_rt_40:
  s_call_b64 s[76:77], L_refresh
  v_max3_u32 v2, v112, v116, v120
  v_max_u32 v2, v2, v124
  v_cmp_eq_u32 vcc, -1, v2
  s_nop 4
  s_cbranch_vccnz L_rt_40
  s_branch L_ck_39
L_rt_42:
  s_call_b64 s[76:77], L_refresh
  v_max3_u32 v2, v128, v132, v136
  v_max_u32 v2, v2, v140
  v_cmp_eq_u32 vcc, -1, v2
  s_nop 4
  s_cbranch_vccnz L_rt_42
  s_branch L_ck_41
L_rt_44:
  s_call_b64 s[76:77], L_refresh
  v_max3_u32 v2, v144, v148, v152
  v_max_u32 v2, v2, v156
  v_cmp_eq_u32 vcc, -1, v2
  s_nop 4
  s_cbranch_vccnz L_rt_44
  s_branch L_ck_43
L_rt_46:
  s_call_b64 s[76:77], L_refresh
  v_max3_u32 v2, v112, v116, v120
  v_max_u32 v2, v2, v124
  v_cmp_eq_u32 vcc, -1, v2
  s_nop 4
  s_cbranch_vccnz L_rt_46
  s_branch L_ck_45
L_rt_48:
  s_call_b64 s[76:77], L_refresh
  v_max3_u32 v2, v128, v132, v136
  v_max_u32 v2, v2, v140
  v_cmp_eq_u32 vcc, -1, v2
  s_nop 4
  s_cbranch_vccnz L_rt_48
  s_branch L_ck_47
L_rt_50:
  s_call_b64 s[76:77], L_refresh
  v_max3_u32 v2, v144, v148, v152
  v_max_u32 v2, v2, v156
  v_cmp_eq_u32 vcc, -1, v2
  s_nop 4
  s_cbranch_vccnz L_rt_50
  s_branch L_ck_49
L_rt_52:
  s_call_b64 s[76:77], L_refresh
  v_max3_u32 v2, v112, v116, v120
  v_max_u32 v2, v2, v124
  v_cmp_eq_u32 vcc, -1, v2
  s_nop 4
  s_cbranch_vccnz L_rt_52
  s_branch L_ck_51
L_rt_54:
  s_call_b64 s[76:77], L_refresh
  v_max3_u32 v2, v128, v132, v136
  v_max_u32 v2, v2, v140
  v_cmp_eq_u32 vcc, -1, v2
  s_nop 4
  s_cbranch_vccnz L_rt_54
  s_branch L_ck_53
L_rt_56:
  s_call_b64 s[76:77], L_refresh
  v_max3_u32 v2, v144, v148, v152
  v_max_u32 v2, v2, v156
  v_cmp_eq_u32 vcc, -1, v2
  s_nop 4
  s_cbranch_vccnz L_rt_56
  s_branch L_ck_55
L_rt_58:
  s_call_b64 s[76:77], L_refresh
  v_max3_u32 v2, v112, v116, v120
  v_max_u32 v2, v2, v124
  v_cmp_eq_u32 vcc, -1, v2
  s_nop 4
  s_cbranch_vccnz L_rt_58
  s_branch L_ck_57
L_rt_60:
  s_call_b64 s[76:77], L_refresh
  v_max3_u32 v2, v128, v132, v136
  v_max_u32 v2, v2, v140
  v_cmp_eq_u32 vcc, -1, v2
  s_nop 4
  s_cbranch_vccnz L_rt_60
  s_branch L_ck_59
L_rt_62:
  s_call_b64 s[76:77], L_refresh
  v_max3_u32 v2, v144, v148, v152
  v_max_u32 v2, v2, v156
  v_cmp_eq_u32 vcc, -1, v2
  s_nop 4
  s_cbranch_vccnz L_rt_62
  s_branch L_ck_61
L_rt_64:
  s_call_b64 s[76:77], L_refresh
  v_max3_u32 v2, v112, v116, v120
  v_max_u32 v2, v2, v124
  v_cmp_eq_u32 vcc, -1, v2
  s_nop 4
  s_cbranch_vccnz L_rt_64
  s_branch L_ck_63
L_rt_66:
  s_call_b64 s[76:77], L_refresh
  v_max3_u32 v2, v128, v132, v136
  v_max_u32 v2, v2, v140
  v_cmp_eq_u32 vcc, -1, v2
  s_nop 4
  s_cbranch_vccnz L_rt_66
  s_branch L_ck_65
L_rt_68:
  s_call_b64 s[76:77], L_refresh
  v_max3_u32 v2, v144, v148, v152
  v_max_u32 v2, v2, v156
  v_cmp_eq_u32 vcc, -1, v2
  s_nop 4
  s_cbranch_vccnz L_rt_68
  s_branch L_ck_67
L_rt_70:
  s_call_b64 s[76:77], L_refresh
  v_max3_u32 v2, v112, v116, v120
  v_max_u32 v2, v2, v124
  v_cmp_eq_u32 vcc, -1, v2
  s_nop 4
  s_cbranch_vccnz L_rt_70
  s_branch L_ck_69
L_rt_75:
  s_call_b64 s[76:77], L_refresh
  v_max3_u32 v2, v128, v132, v136
  v_max_u32 v2, v2, v140
  v_cmp_eq_u32 vcc, -1, v2
  s_nop 4
  s_cbranch_vccnz L_rt_75
  s_branch L_ck_74
L_rt_77:
  s_call_b64 s[76:77], L_refresh
  v_max3_u32 v2, v144, v148, v152
  v_max_u32 v2, v2, v156
  v_cmp_eq_u32 vcc, -1, v2
  s_nop 4
  s_cbranch_vccnz L_rt_77
  s_branch L_ck_76
L_rt_79:
  s_call_b64 s[76:77], L_refresh
  v_max3_u32 v2, v112, v116, v120
  v_max_u32 v2, v2, v124
  v_cmp_eq_u32 vcc, -1, v2
  s_nop 4
  s_cbranch_vccnz L_rt_79
  s_branch L_ck_78
L_rt_81:
  s_call_b64 s[76:77], L_refresh
  v_max3_u32 v2, v128, v132, v136
  v_max_u32 v2, v2, v140
  v_cmp_eq_u32 vcc, -1, v2
  s_nop 4
  s_cbranch_vccnz L_rt_81
  s_branch L_ck_80
L_rt_83:
  s_call_b64 s[76:77], L_refresh
  v_max3_u32 v2, v144, v148, v152
  v_max_u32 v2, v2, v156
  v_cmp_eq_u32 vcc, -1, v2
  s_nop 4
  s_cbranch_vccnz L_rt_83
  s_branch L_ck_82
L_rt_85:
  s_call_b64 s[76:77], L_refresh
  v_max3_u32 v2, v112, v116, v120
  v_max_u32 v2, v2, v124
  v_cmp_eq_u32 vcc, -1, v2
  s_nop 4
  s_cbranch_vccnz L_rt_85
  s_branch L_ck_84
L_rt_87:
  s_call_b64 s[76:77], L_refresh
  v_max3_u32 v2, v128, v132, v136
  v_max_u32 v2, v2, v140
  v_cmp_eq_u32 vcc, -1, v2
  s_nop 4
  s_cbranch_vccnz L_rt_87
  s_branch L_ck_86
L_rt_89:
  s_call_b64 s[76:77], L_refresh
  v_max3_u32 v2, v144, v148, v152
  v_max_u32 v2, v2, v156
  v_cmp_eq_u32 vcc, -1, v2
  s_nop 4
  s_cbranch_vccnz L_rt_89
  s_branch L_ck_88
L_rt_93:
  s_call_b64 s[76:77], L_refresh
  v_max3_u32 v2, v112, v116, v120
  v_max_u32 v2, v2, v124
  v_cmp_eq_u32 vcc, -1, v2
  s_nop 4
  s_cbranch_vccnz L_rt_93
  s_branch L_ck_92
L_rt_95:
  s_call_b64 s[76:77], L_refresh
  v_max3_u32 v2, v128, v132, v136
  v_max_u32 v2, v2, v140
  v_cmp_eq_u32 vcc, -1, v2
  s_nop 4
  s_cbranch_vccnz L_rt_95
  s_branch L_ck_94
L_rt_97:
  s_call_b64 s[76:77], L_refresh
  v_max3_u32 v2, v144, v148, v152
  v_max_u32 v2, v2, v156
  v_cmp_eq_u32 vcc, -1, v2
  s_nop 4
  s_cbranch_vccnz L_rt_97
  s_branch L_ck_96
L_rt_99:
  s_call_b64 s[76:77], L_refresh
  v_max3_u32 v2, v112, v116, v120
  v_max_u32 v2, v2, v124
  v_cmp_eq_u32 vcc, -1, v2
  s_nop 4
  s_cbranch_vccnz L_rt_99
  s_branch L_ck_98
L_rt_101:
  s_call_b64 s[76:77], L_refresh
  v_max3_u32 v2, v128, v132, v136
  v_max_u32 v2, v2, v140
  v_cmp_eq_u32 vcc, -1, v2
  s_nop 4
  s_cbranch_vccnz L_rt_101
  s_branch L_ck_100
L_rt_103:
  s_call_b64 s[76:77], L_refresh
  v_max3_u32 v2, v144, v148, v152
  v_max_u32 v2, v2, v156
  v_cmp_eq_u32 vcc, -1, v2
  s_nop 4
  s_cbranch_vccnz L_rt_103
  s_branch L_ck_102
L_last:
  s_endpgm
.section .rodata,"a"
.p2align 6
.amdhsa_kernel sequential_preLN__softmax_full_mha__mixer_token_mlp__prompt_kernel
  .amdhsa_next_free_vgpr 512
  .amdhsa_next_free_sgpr 102
  .amdhsa_accum_offset 256
  .amdhsa_group_segment_fixed_size 0
  .amdhsa_kernarg_size 88
  .amdhsa_user_sgpr_count 2
  .amdhsa_user_sgpr_kernarg_segment_ptr 1
  .amdhsa_system_sgpr_workgroup_id_x 1
.end_amdhsa_kernel
```
